```python
import torch

def _softmax(x, axis=-1):
    return torch.softmax(x, dim=axis)
def _gelu(x):
    return torch.nn.functional.gelu(x, approximate="tanh")
def _silu(x):
    return torch.nn.functional.silu(x)
def _sigmoid(x):
    return torch.sigmoid(x)
def _layernorm(x, axis=-1, eps=1e-5):
    m = x.mean(dim=axis, keepdim=True)
    v = x.var(dim=axis, keepdim=True, unbiased=False)
    return (x - m) / torch.sqrt(v + eps)
def _scatter_add(tgt, idx, src, axis=0):
    return tgt.clone().index_add_(axis, idx, src)
def _segment_sum(src, seg, n):
    out = torch.zeros((n,) + src.shape[1:], dtype=src.dtype)
    return out.index_add_(0, seg, src)
def _pad(x, pw):
    flat = tuple(v for pair in reversed(pw) for v in pair)
    return torch.nn.functional.pad(x, flat)

kernel_name = 'parallel_sum__mha_block_cached__mixer_channel_mlp__decode'

def setup_inputs():

    _w = (lambda a: (lambda t: t.to(torch.bfloat16) if t.is_floating_point() else t)(torch.as_tensor(a)))
    def _A_setup():
        B, Sq, D = 8, 1, 1024
        H, Sk, Dh = 32, 4096, 128
        return {
            "x": _w((lambda *s: torch.randn(*s, dtype=torch.bfloat16) * 0.05)(B, Sq, D)),
            "k_cache": _w((lambda *s: torch.randn(*s, dtype=torch.bfloat16) * 3.2)(B, H, Sk, Dh)),
            "v_cache": _w((lambda *s: torch.randn(*s, dtype=torch.bfloat16) * 0.4)(B, H, Sk, Dh)),
            "wq": _w((lambda *s: torch.randn(*s, dtype=torch.bfloat16) * 3.2)(D, H * Dh) * (D ** -0.5)),
            "wo": _w((lambda *s: torch.randn(*s, dtype=torch.bfloat16) * 0.4)(H * Dh, D) * ((H * Dh) ** -0.5)),
        }
    _A_in = _A_setup()

    def _B_setup():
        B, S, D, F = 8, 1, 1024, 3584
        return {
            "x": _w((lambda *s: torch.randn(*s, dtype=torch.bfloat16) * 0.05)(B, S, D)),
            "w1": _w((lambda *s: torch.randn(*s, dtype=torch.bfloat16) * 3.2)(D, F) * (D ** -0.5)),
            "b1": _w((lambda *s: torch.randn(*s, dtype=torch.bfloat16) * 1.6)(F)),
            "w2": _w((lambda *s: torch.randn(*s, dtype=torch.bfloat16) * 0.1)(F, D) * (F ** -0.5)),
            "b2": _w((lambda *s: torch.randn(*s, dtype=torch.bfloat16) * 0.1)(D)),
        }
    _B_in = _B_setup()

    return {
        "A_x": _A_in["x"],
        "A_k_cache": _A_in["k_cache"],
        "A_v_cache": _A_in["v_cache"],
        "A_wq": _A_in["wq"],
        "A_wo": _A_in["wo"],
        "B_x": _B_in["x"],
        "B_w1": _B_in["w1"],
        "B_b1": _B_in["b1"],
        "B_w2": _B_in["w2"],
        "B_b2": _B_in["b2"],
    }

def reference(A_x, A_k_cache, A_v_cache, A_wq, A_wo, B_x, B_w1, B_b1, B_w2, B_b2):
    def _A_ref(x, k_cache, v_cache, wq, wo):
        B, Sq, D = x.shape
        H, Dh = 32, 128
        q = (lambda x, *d: x.permute(*d))((x @ wq).reshape(B, Sq, H, Dh), 0, 2, 1, 3)
        scores = torch.einsum("bhqd,bhkd->bhqk", q, k_cache) * (Dh ** -0.5)
        p = _softmax(scores, axis=-1)
        o = torch.einsum("bhqk,bhkd->bhqd", p, v_cache)
        return (lambda x, *d: x.permute(*d))(o, 0, 2, 1, 3).reshape(B, Sq, H * Dh) @ wo

    def _B_ref(x, w1, b1, w2, b2):
        y = _layernorm(x, axis=-1)
        h = _gelu(torch.einsum("bsd,df->bsf", y, w1) + b1)
        return torch.einsum("bsf,fd->bsd", h, w2) + b2

    x = A_x
    xn = _layernorm(x, axis=-1)
    return x + _A_ref(xn, A_k_cache, A_v_cache, A_wq, A_wo) + _B_ref(xn, B_w1, B_b1, B_w2, B_b2)
```

```asm
; @launch grid=(256,1,1) block=(256,1,1) lds=155648
.amdgcn_target "amdgcn-amd-amdhsa--gfx950"
.text
.globl parallel_sum__mha_block_cached__mixer_channel_mlp__decode_kernel
.p2align 8
.type parallel_sum__mha_block_cached__mixer_channel_mlp__decode_kernel,@function
parallel_sum__mha_block_cached__mixer_channel_mlp__decode_kernel:
    s_cmp_ge_u32 s2, 256
    s_cbranch_scc1 L_end
    s_load_dwordx16 s[4:19], s[0:1], 0
    s_load_dwordx8 s[20:27], s[0:1], 64
    s_load_dwordx2 s[28:29], s[0:1], 96
    v_and_b32 v1, 63, v0
    v_lshrrev_b32 v65, 6, v0
    v_and_b32 v2, 15, v0
    v_bfe_u32 v3, v0, 4, 2
    v_readfirstlane_b32 s3, v65
    s_lshr_b32 s30, s2, 5
    s_and_b32 s31, s2, 31
    s_lshl_b32 s90, s30, 5
    s_add_u32 s90, s90, s31
    v_lshlrev_b32 v4, 4, v1
    v_lshl_add_u32 v4, v65, 12, v4
    v_lshl_add_u32 v66, v65, 8, v3
    v_lshlrev_b32 v67, 4, v2
    s_lshl_b32 s69, s31, 8
    v_lshl_add_u32 v5, v66, 13, v67
    v_add_u32 v5, s69, v5
    s_mul_i32 s70, s31, 224
    s_movk_i32 s71, 7168
    v_mad_u32_u24 v6, v66, s71, v67
    v_add_u32 v6, s70, v6
    v_cmp_gt_u32 vcc, 14, v2
    v_mov_b32 v68, 0x40000000
    s_nop 0
    v_cndmask_b32 v6, v68, v6, vcc
    v_lshl_add_u32 v7, v3, 11, v67
    v_lshl_add_u32 v7, v65, 9, v7
    v_lshl_add_u32 v68, v2, 2, v3
    v_lshlrev_b32 v68, 1, v68
    v_lshl_add_u32 v69, v65, 9, v68
    v_lshlrev_b32 v70, 5, v1
    s_waitcnt lgkmcnt(0)
    s_lshl_b32 s72, s30, 11
    s_add_u32 s56, s4, s72
    s_addc_u32 s57, s5, 0
    s_mov_b32 s58, 2048
    s_mov_b32 s59, 0x00020000
    buffer_load_dwordx4 v[40:43], v70, s[56:59], 0 offen
    buffer_load_dwordx4 v[44:47], v70, s[56:59], 0 offen offset:16
    buffer_load_ushort v48, v69, s[56:59], 0 offen
    buffer_load_ushort v49, v69, s[56:59], 0 offen offset:128
    buffer_load_ushort v50, v69, s[56:59], 0 offen offset:256
    buffer_load_ushort v51, v69, s[56:59], 0 offen offset:384
    s_mov_b32 s40, s10
    s_mov_b32 s41, s11
    s_mov_b32 s42, 8388608
    s_mov_b32 s43, 0x00020000
    v_lshlrev_b32 v70, 4, v1
    s_lshl_b32 s72, s90, 20
    s_add_u32 s32, s6, s72
    s_addc_u32 s33, s7, 0
    s_mov_b32 s34, 1048576
    s_mov_b32 s35, 0x00020000
    s_add_u32 s36, s8, s72
    s_addc_u32 s37, s9, 0
    s_mov_b32 s38, 1048576
    s_mov_b32 s39, 0x00020000
    s_mul_i32 s93, s3, 36864
    s_add_u32 s93, s93, 8192
    v_add_u32 v57, s93, v70
    s_mov_b32 s68, 0
    buffer_load_dwordx4 a[0:3], v5, s[40:43], s68 offen
    s_mov_b32 s68, 0
    buffer_load_dwordx4 v[80:83], v4, s[32:35], s68 offen nt
    s_mov_b32 s68, 32768
    buffer_load_dwordx4 a[4:7], v5, s[40:43], s68 offen
    s_mov_b32 s68, 0
    buffer_load_dwordx4 v[84:87], v4, s[32:35], s68 offen offset:1024 nt
    s_mov_b32 s68, 65536
    buffer_load_dwordx4 a[8:11], v5, s[40:43], s68 offen
    s_mov_b32 s68, 0
    buffer_load_dwordx4 v[88:91], v4, s[32:35], s68 offen offset:2048 nt
    s_mov_b32 s68, 98304
    buffer_load_dwordx4 a[12:15], v5, s[40:43], s68 offen
    s_mov_b32 s68, 0
    buffer_load_dwordx4 v[92:95], v4, s[32:35], s68 offen offset:3072 nt
    s_mov_b32 s68, 131072
    buffer_load_dwordx4 a[16:19], v5, s[40:43], s68 offen
    s_mov_b32 s68, 16384
    buffer_load_dwordx4 v[96:99], v4, s[32:35], s68 offen nt
    s_mov_b32 s68, 163840
    buffer_load_dwordx4 a[20:23], v5, s[40:43], s68 offen
    s_mov_b32 s68, 16384
    buffer_load_dwordx4 v[100:103], v4, s[32:35], s68 offen offset:1024 nt
    s_mov_b32 s44, s16
    s_mov_b32 s45, s17
    s_mov_b32 s46, 7340032
    s_mov_b32 s47, 0x00020000
    s_mul_i32 s72, s31, 229376
    s_add_u32 s48, s20, s72
    s_addc_u32 s49, s21, 0
    s_mov_b32 s50, 229376
    s_mov_b32 s51, 0x00020000
    s_lshl_b32 s72, s31, 18
    s_add_u32 s52, s12, s72
    s_addc_u32 s53, s13, 0
    s_mov_b32 s54, 262144
    s_mov_b32 s55, 0x00020000
    s_add_u32 s60, s18, s70
    s_addc_u32 s61, s19, 0
    s_mov_b32 s62, 224
    s_mov_b32 s63, 0x00020000
    s_mov_b32 s64, s28
    s_mov_b32 s65, s29
    s_mov_b32 s66, 2097152
    s_mov_b32 s67, 0x00020000
    buffer_load_ushort v58, v68, s[60:63], 0 offen
    buffer_load_ushort v59, v68, s[60:63], 0 offen offset:128
    v_and_b32 v71, 1, v2
    v_lshlrev_b32 v71, 4, v71
    v_mov_b32 v72, 0xffff
    v_lshlrev_b32 v72, v71, v72
    v_lshrrev_b32 v73, 1, v2
    v_cmp_eq_u32 vcc, 0, v73
    s_nop 1
    v_cndmask_b32 v8, 0, v72, vcc
    v_cmp_eq_u32 vcc, 1, v73
    s_nop 1
    v_cndmask_b32 v9, 0, v72, vcc
    v_cmp_eq_u32 vcc, 2, v73
    s_nop 1
    v_cndmask_b32 v10, 0, v72, vcc
    v_cmp_eq_u32 vcc, 3, v73
    s_nop 1
    v_cndmask_b32 v11, 0, v72, vcc
    s_mov_b32 s80, 0xcccccccc
    s_mov_b32 s81, 0xcccccccc
    s_mov_b32 s82, 0xaaaaaaaa
    s_mov_b32 s83, 0xaaaaaaaa
    s_waitcnt vmcnt(14)
    v_mov_b32 v75, 0
    v_mov_b32 v73, 0
    v_lshlrev_b32 v71, 16, v40
    v_and_b32 v72, 0xffff0000, v40
    v_add_f32 v75, v75, v71
    v_add_f32 v73, v73, v72
    v_lshlrev_b32 v71, 16, v41
    v_and_b32 v72, 0xffff0000, v41
    v_add_f32 v75, v75, v71
    v_add_f32 v73, v73, v72
    v_lshlrev_b32 v71, 16, v42
    v_and_b32 v72, 0xffff0000, v42
    v_add_f32 v75, v75, v71
    v_add_f32 v73, v73, v72
    v_lshlrev_b32 v71, 16, v43
    v_and_b32 v72, 0xffff0000, v43
    v_add_f32 v75, v75, v71
    v_add_f32 v73, v73, v72
    v_lshlrev_b32 v71, 16, v44
    v_and_b32 v72, 0xffff0000, v44
    v_add_f32 v75, v75, v71
    v_add_f32 v73, v73, v72
    v_lshlrev_b32 v71, 16, v45
    v_and_b32 v72, 0xffff0000, v45
    v_add_f32 v75, v75, v71
    v_add_f32 v73, v73, v72
    v_lshlrev_b32 v71, 16, v46
    v_and_b32 v72, 0xffff0000, v46
    v_add_f32 v75, v75, v71
    v_add_f32 v73, v73, v72
    v_lshlrev_b32 v71, 16, v47
    v_and_b32 v72, 0xffff0000, v47
    v_add_f32 v75, v75, v71
    v_add_f32 v73, v73, v72
    v_add_f32 v75, v75, v73
    s_nop 1
    v_add_f32_dpp v75, v75, v75 row_ror:8 row_mask:0xf bank_mask:0xf
    s_nop 1
    v_add_f32_dpp v75, v75, v75 row_ror:4 row_mask:0xf bank_mask:0xf
    s_nop 1
    v_add_f32_dpp v75, v75, v75 row_ror:2 row_mask:0xf bank_mask:0xf
    s_nop 1
    v_add_f32_dpp v75, v75, v75 row_ror:1 row_mask:0xf bank_mask:0xf
    s_nop 0
    v_readlane_b32 s84, v75, 0
    v_readlane_b32 s85, v75, 16
    v_readlane_b32 s86, v75, 32
    v_readlane_b32 s87, v75, 48
    v_mov_b32 v75, s84
    v_add_f32 v75, s85, v75
    v_add_f32 v75, s86, v75
    v_add_f32 v75, s87, v75
    v_mul_f32 v76, 0x3a800000, v75
    v_mov_b32 v75, 0
    v_mov_b32 v73, 0
    v_lshlrev_b32 v71, 16, v40
    v_and_b32 v72, 0xffff0000, v40
    v_sub_f32 v71, v71, v76
    v_sub_f32 v72, v72, v76
    v_fmac_f32 v75, v71, v71
    v_fmac_f32 v73, v72, v72
    v_lshlrev_b32 v71, 16, v41
    v_and_b32 v72, 0xffff0000, v41
    v_sub_f32 v71, v71, v76
    v_sub_f32 v72, v72, v76
    v_fmac_f32 v75, v71, v71
    v_fmac_f32 v73, v72, v72
    v_lshlrev_b32 v71, 16, v42
    v_and_b32 v72, 0xffff0000, v42
    v_sub_f32 v71, v71, v76
    v_sub_f32 v72, v72, v76
    v_fmac_f32 v75, v71, v71
    v_fmac_f32 v73, v72, v72
    v_lshlrev_b32 v71, 16, v43
    v_and_b32 v72, 0xffff0000, v43
    v_sub_f32 v71, v71, v76
    v_sub_f32 v72, v72, v76
    v_fmac_f32 v75, v71, v71
    v_fmac_f32 v73, v72, v72
    v_lshlrev_b32 v71, 16, v44
    v_and_b32 v72, 0xffff0000, v44
    v_sub_f32 v71, v71, v76
    v_sub_f32 v72, v72, v76
    v_fmac_f32 v75, v71, v71
    v_fmac_f32 v73, v72, v72
    v_lshlrev_b32 v71, 16, v45
    v_and_b32 v72, 0xffff0000, v45
    v_sub_f32 v71, v71, v76
    v_sub_f32 v72, v72, v76
    v_fmac_f32 v75, v71, v71
    v_fmac_f32 v73, v72, v72
    v_lshlrev_b32 v71, 16, v46
    v_and_b32 v72, 0xffff0000, v46
    v_sub_f32 v71, v71, v76
    v_sub_f32 v72, v72, v76
    v_fmac_f32 v75, v71, v71
    v_fmac_f32 v73, v72, v72
    v_lshlrev_b32 v71, 16, v47
    v_and_b32 v72, 0xffff0000, v47
    v_sub_f32 v71, v71, v76
    v_sub_f32 v72, v72, v76
    v_fmac_f32 v75, v71, v71
    v_fmac_f32 v73, v72, v72
    v_add_f32 v75, v75, v73
    s_nop 1
    v_add_f32_dpp v75, v75, v75 row_ror:8 row_mask:0xf bank_mask:0xf
    s_nop 1
    v_add_f32_dpp v75, v75, v75 row_ror:4 row_mask:0xf bank_mask:0xf
    s_nop 1
    v_add_f32_dpp v75, v75, v75 row_ror:2 row_mask:0xf bank_mask:0xf
    s_nop 1
    v_add_f32_dpp v75, v75, v75 row_ror:1 row_mask:0xf bank_mask:0xf
    s_nop 0
    v_readlane_b32 s84, v75, 0
    v_readlane_b32 s85, v75, 16
    v_readlane_b32 s86, v75, 32
    v_readlane_b32 s87, v75, 48
    v_mov_b32 v75, s84
    v_add_f32 v75, s85, v75
    v_add_f32 v75, s86, v75
    v_add_f32 v75, s87, v75
    v_mul_f32 v75, 0x3a800000, v75
    v_cvt_pk_bf16_f32 v76, 0, v76
    v_cvt_pk_bf16_f32 v75, 0, v75
    v_add_f32 v75, 0x3727c5ac, v75
    v_cvt_pk_bf16_f32 v75, 0, v75
    v_sqrt_f32 v77, v75
    s_nop 0
    v_cvt_pk_bf16_f32 v77, 0, v77
    v_rcp_f32 v78, v77
    v_lshlrev_b32 v48, 16, v48
    v_sub_f32 v48, v48, v76
    v_cvt_pk_bf16_f32 v48, 0, v48
    v_mul_f32 v71, v48, v78
    v_fma_f32 v48, -v71, v77, v48
    v_fma_f32 v48, v48, v78, v71
    v_cvt_pk_bf16_f32 v48, v48, v48
    v_lshlrev_b32 v49, 16, v49
    v_sub_f32 v49, v49, v76
    v_cvt_pk_bf16_f32 v49, 0, v49
    v_mul_f32 v71, v49, v78
    v_fma_f32 v49, -v71, v77, v49
    v_fma_f32 v49, v49, v78, v71
    v_cvt_pk_bf16_f32 v49, v49, v49
    v_lshlrev_b32 v50, 16, v50
    v_sub_f32 v50, v50, v76
    v_cvt_pk_bf16_f32 v50, 0, v50
    v_mul_f32 v71, v50, v78
    v_fma_f32 v50, -v71, v77, v50
    v_fma_f32 v50, v50, v78, v71
    v_cvt_pk_bf16_f32 v50, v50, v50
    v_lshlrev_b32 v51, 16, v51
    v_sub_f32 v51, v51, v76
    v_cvt_pk_bf16_f32 v51, 0, v51
    v_mul_f32 v71, v51, v78
    v_fma_f32 v51, -v71, v77, v51
    v_fma_f32 v51, v51, v78, v71
    v_cvt_pk_bf16_f32 v51, v51, v51
    s_waitcnt vmcnt(13)
    v_and_b32_dpp v12, v48, v8 row_newbcast:0 row_mask:0xf bank_mask:0xf
    v_and_b32_dpp v13, v48, v9 row_newbcast:0 row_mask:0xf bank_mask:0xf
    v_and_b32_dpp v14, v48, v10 row_newbcast:0 row_mask:0xf bank_mask:0xf
    v_and_b32_dpp v15, v48, v11 row_newbcast:0 row_mask:0xf bank_mask:0xf
    s_nop 1
    v_mfma_f32_16x16x32_bf16 v[20:23], v[12:15], a[0:3], 0
    s_mov_b32 s68, 196608
    buffer_load_dwordx4 a[24:27], v5, s[40:43], s68 offen
    s_waitcnt vmcnt(12)
    v_and_b32_dpp v16, v48, v8 row_newbcast:1 row_mask:0xf bank_mask:0xf
    v_and_b32_dpp v17, v48, v9 row_newbcast:1 row_mask:0xf bank_mask:0xf
    v_and_b32_dpp v18, v48, v10 row_newbcast:1 row_mask:0xf bank_mask:0xf
    v_and_b32_dpp v19, v48, v11 row_newbcast:1 row_mask:0xf bank_mask:0xf
    s_nop 1
    v_mfma_f32_16x16x32_bf16 v[20:23], v[16:19], a[4:7], v[20:23]
    s_mov_b32 s68, 16384
    buffer_load_dwordx4 v[104:107], v4, s[32:35], s68 offen offset:2048 nt
    s_mov_b32 s68, 229376
    buffer_load_dwordx4 a[28:31], v5, s[40:43], s68 offen
    s_waitcnt vmcnt(12)
    v_and_b32_dpp v12, v48, v8 row_newbcast:2 row_mask:0xf bank_mask:0xf
    v_and_b32_dpp v13, v48, v9 row_newbcast:2 row_mask:0xf bank_mask:0xf
    v_and_b32_dpp v14, v48, v10 row_newbcast:2 row_mask:0xf bank_mask:0xf
    v_and_b32_dpp v15, v48, v11 row_newbcast:2 row_mask:0xf bank_mask:0xf
    s_nop 1
    v_mfma_f32_16x16x32_bf16 v[20:23], v[12:15], a[8:11], v[20:23]
    s_mov_b32 s68, 16384
    buffer_load_dwordx4 v[108:111], v4, s[32:35], s68 offen offset:3072 nt
    s_mov_b32 s68, 262144
    buffer_load_dwordx4 a[32:35], v5, s[40:43], s68 offen
    s_waitcnt vmcnt(12)
    v_and_b32_dpp v16, v48, v8 row_newbcast:3 row_mask:0xf bank_mask:0xf
    v_and_b32_dpp v17, v48, v9 row_newbcast:3 row_mask:0xf bank_mask:0xf
    v_and_b32_dpp v18, v48, v10 row_newbcast:3 row_mask:0xf bank_mask:0xf
    v_and_b32_dpp v19, v48, v11 row_newbcast:3 row_mask:0xf bank_mask:0xf
    s_nop 1
    v_mfma_f32_16x16x32_bf16 v[20:23], v[16:19], a[12:15], v[20:23]
    s_mov_b32 s68, 32768
    buffer_load_dwordx4 v[112:115], v4, s[32:35], s68 offen nt
    s_mov_b32 s68, 294912
    buffer_load_dwordx4 a[36:39], v5, s[40:43], s68 offen
    s_waitcnt vmcnt(12)
    v_and_b32_dpp v12, v48, v8 row_newbcast:4 row_mask:0xf bank_mask:0xf
    v_and_b32_dpp v13, v48, v9 row_newbcast:4 row_mask:0xf bank_mask:0xf
    v_and_b32_dpp v14, v48, v10 row_newbcast:4 row_mask:0xf bank_mask:0xf
    v_and_b32_dpp v15, v48, v11 row_newbcast:4 row_mask:0xf bank_mask:0xf
    s_nop 1
    v_mfma_f32_16x16x32_bf16 v[20:23], v[12:15], a[16:19], v[20:23]
    s_mov_b32 s68, 32768
    buffer_load_dwordx4 v[116:119], v4, s[32:35], s68 offen offset:1024 nt
    s_mov_b32 s68, 327680
    buffer_load_dwordx4 a[40:43], v5, s[40:43], s68 offen
    s_waitcnt vmcnt(12)
    v_and_b32_dpp v16, v48, v8 row_newbcast:5 row_mask:0xf bank_mask:0xf
    v_and_b32_dpp v17, v48, v9 row_newbcast:5 row_mask:0xf bank_mask:0xf
    v_and_b32_dpp v18, v48, v10 row_newbcast:5 row_mask:0xf bank_mask:0xf
    v_and_b32_dpp v19, v48, v11 row_newbcast:5 row_mask:0xf bank_mask:0xf
    s_nop 1
    v_mfma_f32_16x16x32_bf16 v[20:23], v[16:19], a[20:23], v[20:23]
    s_mov_b32 s68, 32768
    buffer_load_dwordx4 v[120:123], v4, s[32:35], s68 offen offset:2048 nt
    s_mov_b32 s68, 360448
    buffer_load_dwordx4 a[44:47], v5, s[40:43], s68 offen
    s_waitcnt vmcnt(10)
    v_and_b32_dpp v12, v48, v8 row_newbcast:6 row_mask:0xf bank_mask:0xf
    v_and_b32_dpp v13, v48, v9 row_newbcast:6 row_mask:0xf bank_mask:0xf
    v_and_b32_dpp v14, v48, v10 row_newbcast:6 row_mask:0xf bank_mask:0xf
    v_and_b32_dpp v15, v48, v11 row_newbcast:6 row_mask:0xf bank_mask:0xf
    s_nop 1
    v_mfma_f32_16x16x32_bf16 v[20:23], v[12:15], a[24:27], v[20:23]
    s_mov_b32 s68, 32768
    buffer_load_dwordx4 v[124:127], v4, s[32:35], s68 offen offset:3072 nt
    s_mov_b32 s68, 393216
    buffer_load_dwordx4 a[48:51], v5, s[40:43], s68 offen
    s_waitcnt vmcnt(10)
    v_and_b32_dpp v16, v48, v8 row_newbcast:7 row_mask:0xf bank_mask:0xf
    v_and_b32_dpp v17, v48, v9 row_newbcast:7 row_mask:0xf bank_mask:0xf
    v_and_b32_dpp v18, v48, v10 row_newbcast:7 row_mask:0xf bank_mask:0xf
    v_and_b32_dpp v19, v48, v11 row_newbcast:7 row_mask:0xf bank_mask:0xf
    s_nop 1
    v_mfma_f32_16x16x32_bf16 v[20:23], v[16:19], a[28:31], v[20:23]
    s_mov_b32 s68, 49152
    buffer_load_dwordx4 v[128:131], v4, s[32:35], s68 offen nt
    s_mov_b32 s68, 425984
    buffer_load_dwordx4 a[52:55], v5, s[40:43], s68 offen
    s_waitcnt vmcnt(10)
    v_and_b32_dpp v12, v48, v8 row_newbcast:8 row_mask:0xf bank_mask:0xf
    v_and_b32_dpp v13, v48, v9 row_newbcast:8 row_mask:0xf bank_mask:0xf
    v_and_b32_dpp v14, v48, v10 row_newbcast:8 row_mask:0xf bank_mask:0xf
    v_and_b32_dpp v15, v48, v11 row_newbcast:8 row_mask:0xf bank_mask:0xf
    s_nop 1
    v_mfma_f32_16x16x32_bf16 v[20:23], v[12:15], a[32:35], v[20:23]
    s_mov_b32 s68, 49152
    buffer_load_dwordx4 v[132:135], v4, s[32:35], s68 offen offset:1024 nt
    s_mov_b32 s68, 458752
    buffer_load_dwordx4 a[56:59], v5, s[40:43], s68 offen
    s_waitcnt vmcnt(10)
    v_and_b32_dpp v16, v48, v8 row_newbcast:9 row_mask:0xf bank_mask:0xf
    v_and_b32_dpp v17, v48, v9 row_newbcast:9 row_mask:0xf bank_mask:0xf
    v_and_b32_dpp v18, v48, v10 row_newbcast:9 row_mask:0xf bank_mask:0xf
    v_and_b32_dpp v19, v48, v11 row_newbcast:9 row_mask:0xf bank_mask:0xf
    s_nop 1
    v_mfma_f32_16x16x32_bf16 v[20:23], v[16:19], a[36:39], v[20:23]
    s_mov_b32 s68, 49152
    buffer_load_dwordx4 v[136:139], v4, s[32:35], s68 offen offset:2048 nt
    s_mov_b32 s68, 491520
    buffer_load_dwordx4 a[60:63], v5, s[40:43], s68 offen
    s_waitcnt vmcnt(10)
    v_and_b32_dpp v12, v48, v8 row_newbcast:10 row_mask:0xf bank_mask:0xf
    v_and_b32_dpp v13, v48, v9 row_newbcast:10 row_mask:0xf bank_mask:0xf
    v_and_b32_dpp v14, v48, v10 row_newbcast:10 row_mask:0xf bank_mask:0xf
    v_and_b32_dpp v15, v48, v11 row_newbcast:10 row_mask:0xf bank_mask:0xf
    s_nop 1
    v_mfma_f32_16x16x32_bf16 v[20:23], v[12:15], a[40:43], v[20:23]
    s_mov_b32 s68, 49152
    buffer_load_dwordx4 v[140:143], v4, s[32:35], s68 offen offset:3072 nt
    s_mov_b32 s68, 524288
    buffer_load_dwordx4 a[64:67], v5, s[40:43], s68 offen
    s_waitcnt vmcnt(10)
    v_and_b32_dpp v16, v48, v8 row_newbcast:11 row_mask:0xf bank_mask:0xf
    v_and_b32_dpp v17, v48, v9 row_newbcast:11 row_mask:0xf bank_mask:0xf
    v_and_b32_dpp v18, v48, v10 row_newbcast:11 row_mask:0xf bank_mask:0xf
    v_and_b32_dpp v19, v48, v11 row_newbcast:11 row_mask:0xf bank_mask:0xf
    s_nop 1
    v_mfma_f32_16x16x32_bf16 v[20:23], v[16:19], a[44:47], v[20:23]
    s_mov_b32 s68, 65536
    buffer_load_dwordx4 v[144:147], v4, s[32:35], s68 offen nt
    s_mov_b32 s68, 557056
    buffer_load_dwordx4 a[68:71], v5, s[40:43], s68 offen
    s_waitcnt vmcnt(10)
    v_and_b32_dpp v12, v48, v8 row_newbcast:12 row_mask:0xf bank_mask:0xf
    v_and_b32_dpp v13, v48, v9 row_newbcast:12 row_mask:0xf bank_mask:0xf
    v_and_b32_dpp v14, v48, v10 row_newbcast:12 row_mask:0xf bank_mask:0xf
    v_and_b32_dpp v15, v48, v11 row_newbcast:12 row_mask:0xf bank_mask:0xf
    s_nop 1
    v_mfma_f32_16x16x32_bf16 v[20:23], v[12:15], a[48:51], v[20:23]
    s_mov_b32 s68, 65536
    buffer_load_dwordx4 v[148:151], v4, s[32:35], s68 offen offset:1024 nt
    s_mov_b32 s68, 589824
    buffer_load_dwordx4 a[72:75], v5, s[40:43], s68 offen
    s_waitcnt vmcnt(10)
    v_and_b32_dpp v16, v48, v8 row_newbcast:13 row_mask:0xf bank_mask:0xf
    v_and_b32_dpp v17, v48, v9 row_newbcast:13 row_mask:0xf bank_mask:0xf
    v_and_b32_dpp v18, v48, v10 row_newbcast:13 row_mask:0xf bank_mask:0xf
    v_and_b32_dpp v19, v48, v11 row_newbcast:13 row_mask:0xf bank_mask:0xf
    s_nop 1
    v_mfma_f32_16x16x32_bf16 v[20:23], v[16:19], a[52:55], v[20:23]
    s_mov_b32 s68, 65536
    buffer_load_dwordx4 v[152:155], v4, s[32:35], s68 offen offset:2048 nt
    s_mov_b32 s68, 622592
    buffer_load_dwordx4 a[76:79], v5, s[40:43], s68 offen
    s_waitcnt vmcnt(10)
    v_and_b32_dpp v12, v48, v8 row_newbcast:14 row_mask:0xf bank_mask:0xf
    v_and_b32_dpp v13, v48, v9 row_newbcast:14 row_mask:0xf bank_mask:0xf
    v_and_b32_dpp v14, v48, v10 row_newbcast:14 row_mask:0xf bank_mask:0xf
    v_and_b32_dpp v15, v48, v11 row_newbcast:14 row_mask:0xf bank_mask:0xf
    s_nop 1
    v_mfma_f32_16x16x32_bf16 v[20:23], v[12:15], a[56:59], v[20:23]
    s_mov_b32 s68, 65536
    buffer_load_dwordx4 v[156:159], v4, s[32:35], s68 offen offset:3072 nt
    s_mov_b32 s68, 655360
    buffer_load_dwordx4 a[80:83], v5, s[40:43], s68 offen
    s_waitcnt vmcnt(10)
    v_and_b32_dpp v16, v48, v8 row_newbcast:15 row_mask:0xf bank_mask:0xf
    v_and_b32_dpp v17, v48, v9 row_newbcast:15 row_mask:0xf bank_mask:0xf
    v_and_b32_dpp v18, v48, v10 row_newbcast:15 row_mask:0xf bank_mask:0xf
    v_and_b32_dpp v19, v48, v11 row_newbcast:15 row_mask:0xf bank_mask:0xf
    s_nop 1
    v_mfma_f32_16x16x32_bf16 v[20:23], v[16:19], a[60:63], v[20:23]
    s_mov_b32 s68, 81920
    buffer_load_dwordx4 v[160:163], v4, s[32:35], s68 offen nt
    s_mov_b32 s68, 688128
    buffer_load_dwordx4 a[84:87], v5, s[40:43], s68 offen
    s_waitcnt vmcnt(10)
    v_and_b32_dpp v12, v49, v8 row_newbcast:0 row_mask:0xf bank_mask:0xf
    v_and_b32_dpp v13, v49, v9 row_newbcast:0 row_mask:0xf bank_mask:0xf
    v_and_b32_dpp v14, v49, v10 row_newbcast:0 row_mask:0xf bank_mask:0xf
    v_and_b32_dpp v15, v49, v11 row_newbcast:0 row_mask:0xf bank_mask:0xf
    s_nop 1
    v_mfma_f32_16x16x32_bf16 v[20:23], v[12:15], a[64:67], v[20:23]
    s_mov_b32 s68, 81920
    buffer_load_dwordx4 v[164:167], v4, s[32:35], s68 offen offset:1024 nt
    s_mov_b32 s68, 720896
    buffer_load_dwordx4 a[88:91], v5, s[40:43], s68 offen
    s_waitcnt vmcnt(10)
    v_and_b32_dpp v16, v49, v8 row_newbcast:1 row_mask:0xf bank_mask:0xf
    v_and_b32_dpp v17, v49, v9 row_newbcast:1 row_mask:0xf bank_mask:0xf
    v_and_b32_dpp v18, v49, v10 row_newbcast:1 row_mask:0xf bank_mask:0xf
    v_and_b32_dpp v19, v49, v11 row_newbcast:1 row_mask:0xf bank_mask:0xf
    s_nop 1
    v_mfma_f32_16x16x32_bf16 v[20:23], v[16:19], a[68:71], v[20:23]
    s_mov_b32 s68, 81920
    buffer_load_dwordx4 v[168:171], v4, s[32:35], s68 offen offset:2048 nt
    s_mov_b32 s68, 753664
    buffer_load_dwordx4 a[92:95], v5, s[40:43], s68 offen
    s_waitcnt vmcnt(10)
    v_and_b32_dpp v12, v49, v8 row_newbcast:2 row_mask:0xf bank_mask:0xf
    v_and_b32_dpp v13, v49, v9 row_newbcast:2 row_mask:0xf bank_mask:0xf
    v_and_b32_dpp v14, v49, v10 row_newbcast:2 row_mask:0xf bank_mask:0xf
    v_and_b32_dpp v15, v49, v11 row_newbcast:2 row_mask:0xf bank_mask:0xf
    s_nop 1
    v_mfma_f32_16x16x32_bf16 v[20:23], v[12:15], a[72:75], v[20:23]
    s_mov_b32 s68, 81920
    buffer_load_dwordx4 v[172:175], v4, s[32:35], s68 offen offset:3072 nt
    s_mov_b32 s68, 786432
    buffer_load_dwordx4 a[96:99], v5, s[40:43], s68 offen
    s_waitcnt vmcnt(10)
    v_and_b32_dpp v16, v49, v8 row_newbcast:3 row_mask:0xf bank_mask:0xf
    v_and_b32_dpp v17, v49, v9 row_newbcast:3 row_mask:0xf bank_mask:0xf
    v_and_b32_dpp v18, v49, v10 row_newbcast:3 row_mask:0xf bank_mask:0xf
    v_and_b32_dpp v19, v49, v11 row_newbcast:3 row_mask:0xf bank_mask:0xf
    s_nop 1
    v_mfma_f32_16x16x32_bf16 v[20:23], v[16:19], a[76:79], v[20:23]
    s_mov_b32 s68, 98304
    buffer_load_dwordx4 v[176:179], v4, s[32:35], s68 offen nt
    s_mov_b32 s68, 819200
    buffer_load_dwordx4 a[100:103], v5, s[40:43], s68 offen
    s_waitcnt vmcnt(10)
    v_and_b32_dpp v12, v49, v8 row_newbcast:4 row_mask:0xf bank_mask:0xf
    v_and_b32_dpp v13, v49, v9 row_newbcast:4 row_mask:0xf bank_mask:0xf
    v_and_b32_dpp v14, v49, v10 row_newbcast:4 row_mask:0xf bank_mask:0xf
    v_and_b32_dpp v15, v49, v11 row_newbcast:4 row_mask:0xf bank_mask:0xf
    s_nop 1
    v_mfma_f32_16x16x32_bf16 v[20:23], v[12:15], a[80:83], v[20:23]
    s_mov_b32 s68, 98304
    buffer_load_dwordx4 v[180:183], v4, s[32:35], s68 offen offset:1024 nt
    s_mov_b32 s68, 851968
    buffer_load_dwordx4 a[104:107], v5, s[40:43], s68 offen
    s_waitcnt vmcnt(10)
    v_and_b32_dpp v16, v49, v8 row_newbcast:5 row_mask:0xf bank_mask:0xf
    v_and_b32_dpp v17, v49, v9 row_newbcast:5 row_mask:0xf bank_mask:0xf
    v_and_b32_dpp v18, v49, v10 row_newbcast:5 row_mask:0xf bank_mask:0xf
    v_and_b32_dpp v19, v49, v11 row_newbcast:5 row_mask:0xf bank_mask:0xf
    s_nop 1
    v_mfma_f32_16x16x32_bf16 v[20:23], v[16:19], a[84:87], v[20:23]
    s_mov_b32 s68, 98304
    buffer_load_dwordx4 v[184:187], v4, s[32:35], s68 offen offset:2048 nt
    s_mov_b32 s68, 884736
    buffer_load_dwordx4 a[108:111], v5, s[40:43], s68 offen
    s_waitcnt vmcnt(10)
    v_and_b32_dpp v12, v49, v8 row_newbcast:6 row_mask:0xf bank_mask:0xf
    v_and_b32_dpp v13, v49, v9 row_newbcast:6 row_mask:0xf bank_mask:0xf
    v_and_b32_dpp v14, v49, v10 row_newbcast:6 row_mask:0xf bank_mask:0xf
    v_and_b32_dpp v15, v49, v11 row_newbcast:6 row_mask:0xf bank_mask:0xf
    s_nop 1
    v_mfma_f32_16x16x32_bf16 v[20:23], v[12:15], a[88:91], v[20:23]
    s_mov_b32 s68, 98304
    buffer_load_dwordx4 v[188:191], v4, s[32:35], s68 offen offset:3072 nt
    s_mov_b32 s68, 917504
    buffer_load_dwordx4 a[112:115], v5, s[40:43], s68 offen
    s_waitcnt vmcnt(10)
    v_and_b32_dpp v16, v49, v8 row_newbcast:7 row_mask:0xf bank_mask:0xf
    v_and_b32_dpp v17, v49, v9 row_newbcast:7 row_mask:0xf bank_mask:0xf
    v_and_b32_dpp v18, v49, v10 row_newbcast:7 row_mask:0xf bank_mask:0xf
    v_and_b32_dpp v19, v49, v11 row_newbcast:7 row_mask:0xf bank_mask:0xf
    s_nop 1
    v_mfma_f32_16x16x32_bf16 v[20:23], v[16:19], a[92:95], v[20:23]
    s_mov_b32 s68, 114688
    buffer_load_dwordx4 v[192:195], v4, s[32:35], s68 offen nt
    s_mov_b32 s68, 950272
    buffer_load_dwordx4 a[116:119], v5, s[40:43], s68 offen
    s_waitcnt vmcnt(10)
    v_and_b32_dpp v12, v49, v8 row_newbcast:8 row_mask:0xf bank_mask:0xf
    v_and_b32_dpp v13, v49, v9 row_newbcast:8 row_mask:0xf bank_mask:0xf
    v_and_b32_dpp v14, v49, v10 row_newbcast:8 row_mask:0xf bank_mask:0xf
    v_and_b32_dpp v15, v49, v11 row_newbcast:8 row_mask:0xf bank_mask:0xf
    s_nop 1
    v_mfma_f32_16x16x32_bf16 v[20:23], v[12:15], a[96:99], v[20:23]
    s_mov_b32 s68, 114688
    buffer_load_dwordx4 v[196:199], v4, s[32:35], s68 offen offset:1024 nt
    s_mov_b32 s68, 983040
    buffer_load_dwordx4 a[120:123], v5, s[40:43], s68 offen
    s_waitcnt vmcnt(10)
    v_and_b32_dpp v16, v49, v8 row_newbcast:9 row_mask:0xf bank_mask:0xf
    v_and_b32_dpp v17, v49, v9 row_newbcast:9 row_mask:0xf bank_mask:0xf
    v_and_b32_dpp v18, v49, v10 row_newbcast:9 row_mask:0xf bank_mask:0xf
    v_and_b32_dpp v19, v49, v11 row_newbcast:9 row_mask:0xf bank_mask:0xf
    s_nop 1
    v_mfma_f32_16x16x32_bf16 v[20:23], v[16:19], a[100:103], v[20:23]
    s_mov_b32 s68, 114688
    buffer_load_dwordx4 v[200:203], v4, s[32:35], s68 offen offset:2048 nt
    s_mov_b32 s68, 1015808
    buffer_load_dwordx4 a[124:127], v5, s[40:43], s68 offen
    s_waitcnt vmcnt(10)
    v_and_b32_dpp v12, v49, v8 row_newbcast:10 row_mask:0xf bank_mask:0xf
    v_and_b32_dpp v13, v49, v9 row_newbcast:10 row_mask:0xf bank_mask:0xf
    v_and_b32_dpp v14, v49, v10 row_newbcast:10 row_mask:0xf bank_mask:0xf
    v_and_b32_dpp v15, v49, v11 row_newbcast:10 row_mask:0xf bank_mask:0xf
    s_nop 1
    v_mfma_f32_16x16x32_bf16 v[20:23], v[12:15], a[104:107], v[20:23]
    s_mov_b32 s68, 114688
    buffer_load_dwordx4 v[204:207], v4, s[32:35], s68 offen offset:3072 nt
    s_mov_b32 s68, 1048576
    buffer_load_dwordx4 a[128:131], v5, s[40:43], s68 offen
    s_waitcnt vmcnt(10)
    v_and_b32_dpp v16, v49, v8 row_newbcast:11 row_mask:0xf bank_mask:0xf
    v_and_b32_dpp v17, v49, v9 row_newbcast:11 row_mask:0xf bank_mask:0xf
    v_and_b32_dpp v18, v49, v10 row_newbcast:11 row_mask:0xf bank_mask:0xf
    v_and_b32_dpp v19, v49, v11 row_newbcast:11 row_mask:0xf bank_mask:0xf
    s_nop 1
    v_mfma_f32_16x16x32_bf16 v[20:23], v[16:19], a[108:111], v[20:23]
    s_mov_b32 s68, 131072
    buffer_load_dwordx4 v[208:211], v4, s[32:35], s68 offen nt
    s_mov_b32 s68, 1081344
    buffer_load_dwordx4 a[132:135], v5, s[40:43], s68 offen
    s_waitcnt vmcnt(10)
    v_and_b32_dpp v12, v49, v8 row_newbcast:12 row_mask:0xf bank_mask:0xf
    v_and_b32_dpp v13, v49, v9 row_newbcast:12 row_mask:0xf bank_mask:0xf
    v_and_b32_dpp v14, v49, v10 row_newbcast:12 row_mask:0xf bank_mask:0xf
    v_and_b32_dpp v15, v49, v11 row_newbcast:12 row_mask:0xf bank_mask:0xf
    s_nop 1
    v_mfma_f32_16x16x32_bf16 v[20:23], v[12:15], a[112:115], v[20:23]
    s_mov_b32 s68, 131072
    buffer_load_dwordx4 v[212:215], v4, s[32:35], s68 offen offset:1024 nt
    s_mov_b32 s68, 1114112
    buffer_load_dwordx4 a[136:139], v5, s[40:43], s68 offen
    s_waitcnt vmcnt(10)
    v_and_b32_dpp v16, v49, v8 row_newbcast:13 row_mask:0xf bank_mask:0xf
    v_and_b32_dpp v17, v49, v9 row_newbcast:13 row_mask:0xf bank_mask:0xf
    v_and_b32_dpp v18, v49, v10 row_newbcast:13 row_mask:0xf bank_mask:0xf
    v_and_b32_dpp v19, v49, v11 row_newbcast:13 row_mask:0xf bank_mask:0xf
    s_nop 1
    v_mfma_f32_16x16x32_bf16 v[20:23], v[16:19], a[116:119], v[20:23]
    s_mov_b32 s68, 131072
    buffer_load_dwordx4 v[216:219], v4, s[32:35], s68 offen offset:2048 nt
    s_mov_b32 s68, 1146880
    buffer_load_dwordx4 a[140:143], v5, s[40:43], s68 offen
    s_waitcnt vmcnt(10)
    v_and_b32_dpp v12, v49, v8 row_newbcast:14 row_mask:0xf bank_mask:0xf
    v_and_b32_dpp v13, v49, v9 row_newbcast:14 row_mask:0xf bank_mask:0xf
    v_and_b32_dpp v14, v49, v10 row_newbcast:14 row_mask:0xf bank_mask:0xf
    v_and_b32_dpp v15, v49, v11 row_newbcast:14 row_mask:0xf bank_mask:0xf
    s_nop 1
    v_mfma_f32_16x16x32_bf16 v[20:23], v[12:15], a[120:123], v[20:23]
    s_mov_b32 s68, 131072
    buffer_load_dwordx4 v[220:223], v4, s[32:35], s68 offen offset:3072 nt
    s_mov_b32 s68, 1179648
    buffer_load_dwordx4 a[144:147], v5, s[40:43], s68 offen
    s_waitcnt vmcnt(10)
    v_and_b32_dpp v16, v49, v8 row_newbcast:15 row_mask:0xf bank_mask:0xf
    v_and_b32_dpp v17, v49, v9 row_newbcast:15 row_mask:0xf bank_mask:0xf
    v_and_b32_dpp v18, v49, v10 row_newbcast:15 row_mask:0xf bank_mask:0xf
    v_and_b32_dpp v19, v49, v11 row_newbcast:15 row_mask:0xf bank_mask:0xf
    s_nop 1
    v_mfma_f32_16x16x32_bf16 v[20:23], v[16:19], a[124:127], v[20:23]
    s_mov_b32 s68, 147456
    buffer_load_dwordx4 v[224:227], v4, s[32:35], s68 offen nt
    s_mov_b32 s68, 1212416
    buffer_load_dwordx4 a[148:151], v5, s[40:43], s68 offen
    s_waitcnt vmcnt(10)
    v_and_b32_dpp v12, v50, v8 row_newbcast:0 row_mask:0xf bank_mask:0xf
    v_and_b32_dpp v13, v50, v9 row_newbcast:0 row_mask:0xf bank_mask:0xf
    v_and_b32_dpp v14, v50, v10 row_newbcast:0 row_mask:0xf bank_mask:0xf
    v_and_b32_dpp v15, v50, v11 row_newbcast:0 row_mask:0xf bank_mask:0xf
    s_nop 1
    v_mfma_f32_16x16x32_bf16 v[20:23], v[12:15], a[128:131], v[20:23]
    s_mov_b32 s68, 147456
    buffer_load_dwordx4 v[228:231], v4, s[32:35], s68 offen offset:1024 nt
    s_mov_b32 s68, 1245184
    buffer_load_dwordx4 a[152:155], v5, s[40:43], s68 offen
    s_waitcnt vmcnt(10)
    v_and_b32_dpp v16, v50, v8 row_newbcast:1 row_mask:0xf bank_mask:0xf
    v_and_b32_dpp v17, v50, v9 row_newbcast:1 row_mask:0xf bank_mask:0xf
    v_and_b32_dpp v18, v50, v10 row_newbcast:1 row_mask:0xf bank_mask:0xf
    v_and_b32_dpp v19, v50, v11 row_newbcast:1 row_mask:0xf bank_mask:0xf
    s_nop 1
    v_mfma_f32_16x16x32_bf16 v[20:23], v[16:19], a[132:135], v[20:23]
    s_mov_b32 s68, 147456
    buffer_load_dwordx4 v[232:235], v4, s[32:35], s68 offen offset:2048 nt
    s_mov_b32 s68, 1277952
    buffer_load_dwordx4 a[156:159], v5, s[40:43], s68 offen
    s_waitcnt vmcnt(10)
    v_and_b32_dpp v12, v50, v8 row_newbcast:2 row_mask:0xf bank_mask:0xf
    v_and_b32_dpp v13, v50, v9 row_newbcast:2 row_mask:0xf bank_mask:0xf
    v_and_b32_dpp v14, v50, v10 row_newbcast:2 row_mask:0xf bank_mask:0xf
    v_and_b32_dpp v15, v50, v11 row_newbcast:2 row_mask:0xf bank_mask:0xf
    s_nop 1
    v_mfma_f32_16x16x32_bf16 v[20:23], v[12:15], a[136:139], v[20:23]
    s_mov_b32 s68, 147456
    buffer_load_dwordx4 v[236:239], v4, s[32:35], s68 offen offset:3072 nt
    s_mov_b32 s68, 1310720
    buffer_load_dwordx4 a[160:163], v5, s[40:43], s68 offen
    s_waitcnt vmcnt(10)
    v_and_b32_dpp v16, v50, v8 row_newbcast:3 row_mask:0xf bank_mask:0xf
    v_and_b32_dpp v17, v50, v9 row_newbcast:3 row_mask:0xf bank_mask:0xf
    v_and_b32_dpp v18, v50, v10 row_newbcast:3 row_mask:0xf bank_mask:0xf
    v_and_b32_dpp v19, v50, v11 row_newbcast:3 row_mask:0xf bank_mask:0xf
    s_nop 1
    v_mfma_f32_16x16x32_bf16 v[20:23], v[16:19], a[140:143], v[20:23]
    s_mov_b32 s68, 163840
    s_add_u32 m0, s93, 0
    s_nop 0
    buffer_load_dwordx4 v4, s[32:35], s68 offen offset:0 nt lds
    s_mov_b32 s68, 1343488
    buffer_load_dwordx4 a[164:167], v5, s[40:43], s68 offen
    s_waitcnt vmcnt(10)
    v_and_b32_dpp v12, v50, v8 row_newbcast:4 row_mask:0xf bank_mask:0xf
    v_and_b32_dpp v13, v50, v9 row_newbcast:4 row_mask:0xf bank_mask:0xf
    v_and_b32_dpp v14, v50, v10 row_newbcast:4 row_mask:0xf bank_mask:0xf
    v_and_b32_dpp v15, v50, v11 row_newbcast:4 row_mask:0xf bank_mask:0xf
    s_nop 1
    v_mfma_f32_16x16x32_bf16 v[20:23], v[12:15], a[144:147], v[20:23]
    s_mov_b32 s68, 163840
    s_add_u32 m0, s93, 0
    s_nop 0
    buffer_load_dwordx4 v4, s[32:35], s68 offen offset:1024 nt lds
    s_mov_b32 s68, 1376256
    buffer_load_dwordx4 a[168:171], v5, s[40:43], s68 offen
    s_waitcnt vmcnt(10)
    v_and_b32_dpp v16, v50, v8 row_newbcast:5 row_mask:0xf bank_mask:0xf
    v_and_b32_dpp v17, v50, v9 row_newbcast:5 row_mask:0xf bank_mask:0xf
    v_and_b32_dpp v18, v50, v10 row_newbcast:5 row_mask:0xf bank_mask:0xf
    v_and_b32_dpp v19, v50, v11 row_newbcast:5 row_mask:0xf bank_mask:0xf
    s_nop 1
    v_mfma_f32_16x16x32_bf16 v[20:23], v[16:19], a[148:151], v[20:23]
    s_mov_b32 s68, 163840
    s_add_u32 m0, s93, 0
    s_nop 0
    buffer_load_dwordx4 v4, s[32:35], s68 offen offset:2048 nt lds
    s_mov_b32 s68, 1409024
    buffer_load_dwordx4 a[172:175], v5, s[40:43], s68 offen
    s_waitcnt vmcnt(10)
    v_and_b32_dpp v12, v50, v8 row_newbcast:6 row_mask:0xf bank_mask:0xf
    v_and_b32_dpp v13, v50, v9 row_newbcast:6 row_mask:0xf bank_mask:0xf
    v_and_b32_dpp v14, v50, v10 row_newbcast:6 row_mask:0xf bank_mask:0xf
    v_and_b32_dpp v15, v50, v11 row_newbcast:6 row_mask:0xf bank_mask:0xf
    s_nop 1
    v_mfma_f32_16x16x32_bf16 v[20:23], v[12:15], a[152:155], v[20:23]
    s_mov_b32 s68, 163840
    s_add_u32 m0, s93, 0
    s_nop 0
    buffer_load_dwordx4 v4, s[32:35], s68 offen offset:3072 nt lds
    s_mov_b32 s68, 1441792
    buffer_load_dwordx4 a[176:179], v5, s[40:43], s68 offen
    s_waitcnt vmcnt(10)
    v_and_b32_dpp v16, v50, v8 row_newbcast:7 row_mask:0xf bank_mask:0xf
    v_and_b32_dpp v17, v50, v9 row_newbcast:7 row_mask:0xf bank_mask:0xf
    v_and_b32_dpp v18, v50, v10 row_newbcast:7 row_mask:0xf bank_mask:0xf
    v_and_b32_dpp v19, v50, v11 row_newbcast:7 row_mask:0xf bank_mask:0xf
    s_nop 1
    v_mfma_f32_16x16x32_bf16 v[20:23], v[16:19], a[156:159], v[20:23]
    s_mov_b32 s68, 180224
    s_add_u32 m0, s93, 4096
    s_nop 0
    buffer_load_dwordx4 v4, s[32:35], s68 offen offset:0 nt lds
    s_mov_b32 s68, 1474560
    buffer_load_dwordx4 a[180:183], v5, s[40:43], s68 offen
    s_waitcnt vmcnt(10)
    v_and_b32_dpp v12, v50, v8 row_newbcast:8 row_mask:0xf bank_mask:0xf
    v_and_b32_dpp v13, v50, v9 row_newbcast:8 row_mask:0xf bank_mask:0xf
    v_and_b32_dpp v14, v50, v10 row_newbcast:8 row_mask:0xf bank_mask:0xf
    v_and_b32_dpp v15, v50, v11 row_newbcast:8 row_mask:0xf bank_mask:0xf
    s_nop 1
    v_mfma_f32_16x16x32_bf16 v[20:23], v[12:15], a[160:163], v[20:23]
    s_mov_b32 s68, 180224
    s_add_u32 m0, s93, 4096
    s_nop 0
    buffer_load_dwordx4 v4, s[32:35], s68 offen offset:1024 nt lds
    s_mov_b32 s68, 1507328
    buffer_load_dwordx4 a[184:187], v5, s[40:43], s68 offen
    s_waitcnt vmcnt(10)
    v_and_b32_dpp v16, v50, v8 row_newbcast:9 row_mask:0xf bank_mask:0xf
    v_and_b32_dpp v17, v50, v9 row_newbcast:9 row_mask:0xf bank_mask:0xf
    v_and_b32_dpp v18, v50, v10 row_newbcast:9 row_mask:0xf bank_mask:0xf
    v_and_b32_dpp v19, v50, v11 row_newbcast:9 row_mask:0xf bank_mask:0xf
    s_nop 1
    v_mfma_f32_16x16x32_bf16 v[20:23], v[16:19], a[164:167], v[20:23]
    s_mov_b32 s68, 180224
    s_add_u32 m0, s93, 4096
    s_nop 0
    buffer_load_dwordx4 v4, s[32:35], s68 offen offset:2048 nt lds
    s_mov_b32 s68, 1540096
    buffer_load_dwordx4 a[188:191], v5, s[40:43], s68 offen
    s_waitcnt vmcnt(10)
    v_and_b32_dpp v12, v50, v8 row_newbcast:10 row_mask:0xf bank_mask:0xf
    v_and_b32_dpp v13, v50, v9 row_newbcast:10 row_mask:0xf bank_mask:0xf
    v_and_b32_dpp v14, v50, v10 row_newbcast:10 row_mask:0xf bank_mask:0xf
    v_and_b32_dpp v15, v50, v11 row_newbcast:10 row_mask:0xf bank_mask:0xf
    s_nop 1
    v_mfma_f32_16x16x32_bf16 v[20:23], v[12:15], a[168:171], v[20:23]
    s_mov_b32 s68, 180224
    s_add_u32 m0, s93, 4096
    s_nop 0
    buffer_load_dwordx4 v4, s[32:35], s68 offen offset:3072 nt lds
    s_mov_b32 s68, 1572864
    buffer_load_dwordx4 a[192:195], v5, s[40:43], s68 offen
    s_waitcnt vmcnt(10)
    v_and_b32_dpp v16, v50, v8 row_newbcast:11 row_mask:0xf bank_mask:0xf
    v_and_b32_dpp v17, v50, v9 row_newbcast:11 row_mask:0xf bank_mask:0xf
    v_and_b32_dpp v18, v50, v10 row_newbcast:11 row_mask:0xf bank_mask:0xf
    v_and_b32_dpp v19, v50, v11 row_newbcast:11 row_mask:0xf bank_mask:0xf
    s_nop 1
    v_mfma_f32_16x16x32_bf16 v[20:23], v[16:19], a[172:175], v[20:23]
    s_mov_b32 s68, 196608
    s_add_u32 m0, s93, 8192
    s_nop 0
    buffer_load_dwordx4 v4, s[32:35], s68 offen offset:0 nt lds
    s_mov_b32 s68, 1605632
    buffer_load_dwordx4 a[196:199], v5, s[40:43], s68 offen
    s_waitcnt vmcnt(10)
    v_and_b32_dpp v12, v50, v8 row_newbcast:12 row_mask:0xf bank_mask:0xf
    v_and_b32_dpp v13, v50, v9 row_newbcast:12 row_mask:0xf bank_mask:0xf
    v_and_b32_dpp v14, v50, v10 row_newbcast:12 row_mask:0xf bank_mask:0xf
    v_and_b32_dpp v15, v50, v11 row_newbcast:12 row_mask:0xf bank_mask:0xf
    s_nop 1
    v_mfma_f32_16x16x32_bf16 v[20:23], v[12:15], a[176:179], v[20:23]
    s_mov_b32 s68, 196608
    s_add_u32 m0, s93, 8192
    s_nop 0
    buffer_load_dwordx4 v4, s[32:35], s68 offen offset:1024 nt lds
    s_mov_b32 s68, 1638400
    buffer_load_dwordx4 a[200:203], v5, s[40:43], s68 offen
    s_waitcnt vmcnt(10)
    v_and_b32_dpp v16, v50, v8 row_newbcast:13 row_mask:0xf bank_mask:0xf
    v_and_b32_dpp v17, v50, v9 row_newbcast:13 row_mask:0xf bank_mask:0xf
    v_and_b32_dpp v18, v50, v10 row_newbcast:13 row_mask:0xf bank_mask:0xf
    v_and_b32_dpp v19, v50, v11 row_newbcast:13 row_mask:0xf bank_mask:0xf
    s_nop 1
    v_mfma_f32_16x16x32_bf16 v[20:23], v[16:19], a[180:183], v[20:23]
    s_mov_b32 s68, 196608
    s_add_u32 m0, s93, 8192
    s_nop 0
    buffer_load_dwordx4 v4, s[32:35], s68 offen offset:2048 nt lds
    s_mov_b32 s68, 1671168
    buffer_load_dwordx4 a[204:207], v5, s[40:43], s68 offen
    s_waitcnt vmcnt(10)
    v_and_b32_dpp v12, v50, v8 row_newbcast:14 row_mask:0xf bank_mask:0xf
    v_and_b32_dpp v13, v50, v9 row_newbcast:14 row_mask:0xf bank_mask:0xf
    v_and_b32_dpp v14, v50, v10 row_newbcast:14 row_mask:0xf bank_mask:0xf
    v_and_b32_dpp v15, v50, v11 row_newbcast:14 row_mask:0xf bank_mask:0xf
    s_nop 1
    v_mfma_f32_16x16x32_bf16 v[20:23], v[12:15], a[184:187], v[20:23]
    s_mov_b32 s68, 196608
    s_add_u32 m0, s93, 8192
    s_nop 0
    buffer_load_dwordx4 v4, s[32:35], s68 offen offset:3072 nt lds
    s_mov_b32 s68, 1703936
    buffer_load_dwordx4 a[208:211], v5, s[40:43], s68 offen
    s_waitcnt vmcnt(10)
    v_and_b32_dpp v16, v50, v8 row_newbcast:15 row_mask:0xf bank_mask:0xf
    v_and_b32_dpp v17, v50, v9 row_newbcast:15 row_mask:0xf bank_mask:0xf
    v_and_b32_dpp v18, v50, v10 row_newbcast:15 row_mask:0xf bank_mask:0xf
    v_and_b32_dpp v19, v50, v11 row_newbcast:15 row_mask:0xf bank_mask:0xf
    s_nop 1
    v_mfma_f32_16x16x32_bf16 v[20:23], v[16:19], a[188:191], v[20:23]
    s_mov_b32 s68, 212992
    s_add_u32 m0, s93, 12288
    s_nop 0
    buffer_load_dwordx4 v4, s[32:35], s68 offen offset:0 nt lds
    s_mov_b32 s68, 1736704
    buffer_load_dwordx4 a[212:215], v5, s[40:43], s68 offen
    s_waitcnt vmcnt(10)
    v_and_b32_dpp v12, v51, v8 row_newbcast:0 row_mask:0xf bank_mask:0xf
    v_and_b32_dpp v13, v51, v9 row_newbcast:0 row_mask:0xf bank_mask:0xf
    v_and_b32_dpp v14, v51, v10 row_newbcast:0 row_mask:0xf bank_mask:0xf
    v_and_b32_dpp v15, v51, v11 row_newbcast:0 row_mask:0xf bank_mask:0xf
    s_nop 1
    v_mfma_f32_16x16x32_bf16 v[20:23], v[12:15], a[192:195], v[20:23]
    s_mov_b32 s68, 212992
    s_add_u32 m0, s93, 12288
    s_nop 0
    buffer_load_dwordx4 v4, s[32:35], s68 offen offset:1024 nt lds
    s_mov_b32 s68, 1769472
    buffer_load_dwordx4 a[216:219], v5, s[40:43], s68 offen
    s_waitcnt vmcnt(10)
    v_and_b32_dpp v16, v51, v8 row_newbcast:1 row_mask:0xf bank_mask:0xf
    v_and_b32_dpp v17, v51, v9 row_newbcast:1 row_mask:0xf bank_mask:0xf
    v_and_b32_dpp v18, v51, v10 row_newbcast:1 row_mask:0xf bank_mask:0xf
    v_and_b32_dpp v19, v51, v11 row_newbcast:1 row_mask:0xf bank_mask:0xf
    s_nop 1
    v_mfma_f32_16x16x32_bf16 v[20:23], v[16:19], a[196:199], v[20:23]
    s_mov_b32 s68, 212992
    s_add_u32 m0, s93, 12288
    s_nop 0
    buffer_load_dwordx4 v4, s[32:35], s68 offen offset:2048 nt lds
    s_mov_b32 s68, 1802240
    buffer_load_dwordx4 a[220:223], v5, s[40:43], s68 offen
    s_waitcnt vmcnt(10)
    v_and_b32_dpp v12, v51, v8 row_newbcast:2 row_mask:0xf bank_mask:0xf
    v_and_b32_dpp v13, v51, v9 row_newbcast:2 row_mask:0xf bank_mask:0xf
    v_and_b32_dpp v14, v51, v10 row_newbcast:2 row_mask:0xf bank_mask:0xf
    v_and_b32_dpp v15, v51, v11 row_newbcast:2 row_mask:0xf bank_mask:0xf
    s_nop 1
    v_mfma_f32_16x16x32_bf16 v[20:23], v[12:15], a[200:203], v[20:23]
    s_mov_b32 s68, 212992
    s_add_u32 m0, s93, 12288
    s_nop 0
    buffer_load_dwordx4 v4, s[32:35], s68 offen offset:3072 nt lds
    s_mov_b32 s68, 1835008
    buffer_load_dwordx4 a[224:227], v5, s[40:43], s68 offen
    s_waitcnt vmcnt(10)
    v_and_b32_dpp v16, v51, v8 row_newbcast:3 row_mask:0xf bank_mask:0xf
    v_and_b32_dpp v17, v51, v9 row_newbcast:3 row_mask:0xf bank_mask:0xf
    v_and_b32_dpp v18, v51, v10 row_newbcast:3 row_mask:0xf bank_mask:0xf
    v_and_b32_dpp v19, v51, v11 row_newbcast:3 row_mask:0xf bank_mask:0xf
    s_nop 1
    v_mfma_f32_16x16x32_bf16 v[20:23], v[16:19], a[204:207], v[20:23]
    s_mov_b32 s68, 229376
    s_add_u32 m0, s93, 16384
    s_nop 0
    buffer_load_dwordx4 v4, s[32:35], s68 offen offset:0 nt lds
    s_mov_b32 s68, 1867776
    buffer_load_dwordx4 a[228:231], v5, s[40:43], s68 offen
    s_waitcnt vmcnt(10)
    v_and_b32_dpp v12, v51, v8 row_newbcast:4 row_mask:0xf bank_mask:0xf
    v_and_b32_dpp v13, v51, v9 row_newbcast:4 row_mask:0xf bank_mask:0xf
    v_and_b32_dpp v14, v51, v10 row_newbcast:4 row_mask:0xf bank_mask:0xf
    v_and_b32_dpp v15, v51, v11 row_newbcast:4 row_mask:0xf bank_mask:0xf
    s_nop 1
    v_mfma_f32_16x16x32_bf16 v[20:23], v[12:15], a[208:211], v[20:23]
    s_mov_b32 s68, 229376
    s_add_u32 m0, s93, 16384
    s_nop 0
    buffer_load_dwordx4 v4, s[32:35], s68 offen offset:1024 nt lds
    s_mov_b32 s68, 1900544
    buffer_load_dwordx4 a[232:235], v5, s[40:43], s68 offen
    s_waitcnt vmcnt(10)
    v_and_b32_dpp v16, v51, v8 row_newbcast:5 row_mask:0xf bank_mask:0xf
    v_and_b32_dpp v17, v51, v9 row_newbcast:5 row_mask:0xf bank_mask:0xf
    v_and_b32_dpp v18, v51, v10 row_newbcast:5 row_mask:0xf bank_mask:0xf
    v_and_b32_dpp v19, v51, v11 row_newbcast:5 row_mask:0xf bank_mask:0xf
    s_nop 1
    v_mfma_f32_16x16x32_bf16 v[20:23], v[16:19], a[212:215], v[20:23]
    s_mov_b32 s68, 229376
    s_add_u32 m0, s93, 16384
    s_nop 0
    buffer_load_dwordx4 v4, s[32:35], s68 offen offset:2048 nt lds
    s_mov_b32 s68, 1933312
    buffer_load_dwordx4 a[236:239], v5, s[40:43], s68 offen
    s_waitcnt vmcnt(10)
    v_and_b32_dpp v12, v51, v8 row_newbcast:6 row_mask:0xf bank_mask:0xf
    v_and_b32_dpp v13, v51, v9 row_newbcast:6 row_mask:0xf bank_mask:0xf
    v_and_b32_dpp v14, v51, v10 row_newbcast:6 row_mask:0xf bank_mask:0xf
    v_and_b32_dpp v15, v51, v11 row_newbcast:6 row_mask:0xf bank_mask:0xf
    s_nop 1
    v_mfma_f32_16x16x32_bf16 v[20:23], v[12:15], a[216:219], v[20:23]
    s_mov_b32 s68, 229376
    s_add_u32 m0, s93, 16384
    s_nop 0
    buffer_load_dwordx4 v4, s[32:35], s68 offen offset:3072 nt lds
    s_mov_b32 s68, 1966080
    buffer_load_dwordx4 a[240:243], v5, s[40:43], s68 offen
    s_waitcnt vmcnt(10)
    v_and_b32_dpp v16, v51, v8 row_newbcast:7 row_mask:0xf bank_mask:0xf
    v_and_b32_dpp v17, v51, v9 row_newbcast:7 row_mask:0xf bank_mask:0xf
    v_and_b32_dpp v18, v51, v10 row_newbcast:7 row_mask:0xf bank_mask:0xf
    v_and_b32_dpp v19, v51, v11 row_newbcast:7 row_mask:0xf bank_mask:0xf
    s_nop 1
    v_mfma_f32_16x16x32_bf16 v[20:23], v[16:19], a[220:223], v[20:23]
    s_mov_b32 s68, 245760
    s_add_u32 m0, s93, 20480
    s_nop 0
    buffer_load_dwordx4 v4, s[32:35], s68 offen offset:0 nt lds
    s_mov_b32 s68, 1998848
    buffer_load_dwordx4 a[244:247], v5, s[40:43], s68 offen
    s_waitcnt vmcnt(10)
    v_and_b32_dpp v12, v51, v8 row_newbcast:8 row_mask:0xf bank_mask:0xf
    v_and_b32_dpp v13, v51, v9 row_newbcast:8 row_mask:0xf bank_mask:0xf
    v_and_b32_dpp v14, v51, v10 row_newbcast:8 row_mask:0xf bank_mask:0xf
    v_and_b32_dpp v15, v51, v11 row_newbcast:8 row_mask:0xf bank_mask:0xf
    s_nop 1
    v_mfma_f32_16x16x32_bf16 v[20:23], v[12:15], a[224:227], v[20:23]
    s_mov_b32 s68, 245760
    s_add_u32 m0, s93, 20480
    s_nop 0
    buffer_load_dwordx4 v4, s[32:35], s68 offen offset:1024 nt lds
    s_mov_b32 s68, 2031616
    buffer_load_dwordx4 a[248:251], v5, s[40:43], s68 offen
    s_waitcnt vmcnt(10)
    v_and_b32_dpp v16, v51, v8 row_newbcast:9 row_mask:0xf bank_mask:0xf
    v_and_b32_dpp v17, v51, v9 row_newbcast:9 row_mask:0xf bank_mask:0xf
    v_and_b32_dpp v18, v51, v10 row_newbcast:9 row_mask:0xf bank_mask:0xf
    v_and_b32_dpp v19, v51, v11 row_newbcast:9 row_mask:0xf bank_mask:0xf
    s_nop 1
    v_mfma_f32_16x16x32_bf16 v[20:23], v[16:19], a[228:231], v[20:23]
    s_mov_b32 s68, 245760
    s_add_u32 m0, s93, 20480
    s_nop 0
    buffer_load_dwordx4 v4, s[32:35], s68 offen offset:2048 nt lds
    s_mov_b32 s68, 2064384
    buffer_load_dwordx4 a[252:255], v5, s[40:43], s68 offen
    s_waitcnt vmcnt(10)
    v_and_b32_dpp v12, v51, v8 row_newbcast:10 row_mask:0xf bank_mask:0xf
    v_and_b32_dpp v13, v51, v9 row_newbcast:10 row_mask:0xf bank_mask:0xf
    v_and_b32_dpp v14, v51, v10 row_newbcast:10 row_mask:0xf bank_mask:0xf
    v_and_b32_dpp v15, v51, v11 row_newbcast:10 row_mask:0xf bank_mask:0xf
    s_nop 1
    v_mfma_f32_16x16x32_bf16 v[20:23], v[12:15], a[232:235], v[20:23]
    s_mov_b32 s68, 245760
    s_add_u32 m0, s93, 20480
    s_nop 0
    buffer_load_dwordx4 v4, s[32:35], s68 offen offset:3072 nt lds
    s_mov_b32 s68, 262144
    s_add_u32 m0, s93, 24576
    s_nop 0
    buffer_load_dwordx4 v4, s[32:35], s68 offen offset:0 nt lds
    s_waitcnt vmcnt(10)
    v_and_b32_dpp v16, v51, v8 row_newbcast:11 row_mask:0xf bank_mask:0xf
    v_and_b32_dpp v17, v51, v9 row_newbcast:11 row_mask:0xf bank_mask:0xf
    v_and_b32_dpp v18, v51, v10 row_newbcast:11 row_mask:0xf bank_mask:0xf
    v_and_b32_dpp v19, v51, v11 row_newbcast:11 row_mask:0xf bank_mask:0xf
    s_nop 1
    v_mfma_f32_16x16x32_bf16 v[20:23], v[16:19], a[236:239], v[20:23]
    s_mov_b32 s68, 262144
    s_add_u32 m0, s93, 24576
    s_nop 0
    buffer_load_dwordx4 v4, s[32:35], s68 offen offset:1024 nt lds
    s_mov_b32 s68, 262144
    s_add_u32 m0, s93, 24576
    s_nop 0
    buffer_load_dwordx4 v4, s[32:35], s68 offen offset:2048 nt lds
    s_waitcnt vmcnt(10)
    v_and_b32_dpp v12, v51, v8 row_newbcast:12 row_mask:0xf bank_mask:0xf
    v_and_b32_dpp v13, v51, v9 row_newbcast:12 row_mask:0xf bank_mask:0xf
    v_and_b32_dpp v14, v51, v10 row_newbcast:12 row_mask:0xf bank_mask:0xf
    v_and_b32_dpp v15, v51, v11 row_newbcast:12 row_mask:0xf bank_mask:0xf
    s_nop 1
    v_mfma_f32_16x16x32_bf16 v[20:23], v[12:15], a[240:243], v[20:23]
    s_mov_b32 s68, 262144
    s_add_u32 m0, s93, 24576
    s_nop 0
    buffer_load_dwordx4 v4, s[32:35], s68 offen offset:3072 nt lds
    s_mov_b32 s68, 278528
    s_add_u32 m0, s93, 28672
    s_nop 0
    buffer_load_dwordx4 v4, s[32:35], s68 offen offset:0 nt lds
    s_waitcnt vmcnt(10)
    v_and_b32_dpp v16, v51, v8 row_newbcast:13 row_mask:0xf bank_mask:0xf
    v_and_b32_dpp v17, v51, v9 row_newbcast:13 row_mask:0xf bank_mask:0xf
    v_and_b32_dpp v18, v51, v10 row_newbcast:13 row_mask:0xf bank_mask:0xf
    v_and_b32_dpp v19, v51, v11 row_newbcast:13 row_mask:0xf bank_mask:0xf
    s_nop 1
    v_mfma_f32_16x16x32_bf16 v[20:23], v[16:19], a[244:247], v[20:23]
    s_mov_b32 s68, 278528
    s_add_u32 m0, s93, 28672
    s_nop 0
    buffer_load_dwordx4 v4, s[32:35], s68 offen offset:1024 nt lds
    s_mov_b32 s68, 278528
    s_add_u32 m0, s93, 28672
    s_nop 0
    buffer_load_dwordx4 v4, s[32:35], s68 offen offset:2048 nt lds
    s_waitcnt vmcnt(10)
    v_and_b32_dpp v12, v51, v8 row_newbcast:14 row_mask:0xf bank_mask:0xf
    v_and_b32_dpp v13, v51, v9 row_newbcast:14 row_mask:0xf bank_mask:0xf
    v_and_b32_dpp v14, v51, v10 row_newbcast:14 row_mask:0xf bank_mask:0xf
    v_and_b32_dpp v15, v51, v11 row_newbcast:14 row_mask:0xf bank_mask:0xf
    s_nop 1
    v_mfma_f32_16x16x32_bf16 v[20:23], v[12:15], a[248:251], v[20:23]
    s_mov_b32 s68, 278528
    s_add_u32 m0, s93, 28672
    s_nop 0
    buffer_load_dwordx4 v4, s[32:35], s68 offen offset:3072 nt lds
    s_mov_b32 s68, 294912
    s_add_u32 m0, s93, 32768
    s_nop 0
    buffer_load_dwordx4 v4, s[32:35], s68 offen offset:0 nt lds
    s_waitcnt vmcnt(10)
    v_and_b32_dpp v16, v51, v8 row_newbcast:15 row_mask:0xf bank_mask:0xf
    v_and_b32_dpp v17, v51, v9 row_newbcast:15 row_mask:0xf bank_mask:0xf
    v_and_b32_dpp v18, v51, v10 row_newbcast:15 row_mask:0xf bank_mask:0xf
    v_and_b32_dpp v19, v51, v11 row_newbcast:15 row_mask:0xf bank_mask:0xf
    s_nop 1
    v_mfma_f32_16x16x32_bf16 v[20:23], v[16:19], a[252:255], v[20:23]
    s_mov_b32 s68, 294912
    s_add_u32 m0, s93, 32768
    s_nop 0
    buffer_load_dwordx4 v4, s[32:35], s68 offen offset:1024 nt lds
    s_mov_b32 s68, 294912
    s_add_u32 m0, s93, 32768
    s_nop 0
    buffer_load_dwordx4 v4, s[32:35], s68 offen offset:2048 nt lds
    v_and_b32 v65, 1, v3
    v_lshlrev_b32 v65, 6, v65
    v_lshl_add_u32 v65, v2, 7, v65
    s_lshl_b32 s72, s3, 2
    v_add_u32 v65, s72, v65
    s_mov_b32 exec_hi, 0
    ds_write_b32 v65, v20
    ds_write_b32 v65, v21 offset:16
    ds_write_b32 v65, v22 offset:32
    ds_write_b32 v65, v23 offset:48
    s_mov_b32 exec_hi, -1
    s_waitcnt lgkmcnt(0)
    s_barrier
    v_lshlrev_b32 v65, 5, v1
    ds_read_b128 v[12:15], v65
    ds_read_b128 v[16:19], v65 offset:16
    s_mov_b32 s68, 294912
    s_add_u32 m0, s93, 32768
    s_nop 0
    buffer_load_dwordx4 v4, s[32:35], s68 offen offset:3072 nt lds
    s_waitcnt lgkmcnt(0)
    v_add_f32 v12, v12, v13
    v_add_f32 v14, v14, v15
    v_add_f32 v66, v12, v14
    v_add_f32 v16, v16, v17
    v_add_f32 v18, v18, v19
    v_add_f32 v67, v16, v18
    v_cvt_pk_bf16_f32 v66, v66, v67
    s_lshl_b32 s72, s3, 8
    v_lshlrev_b32 v65, 2, v1
    v_add_u32 v65, s72, v65
    ds_write_b32 v65, v66 offset:6144
    v_lshlrev_b32 v65, 4, v2
    v_add_u32 v65, s72, v65
    s_waitcnt lgkmcnt(0)
    ds_read_b128 v[28:31], v65 offset:6144
    s_waitcnt lgkmcnt(0)
    v_dot2_f32_bf16 v60, v80, v28, 0
    v_dot2_f32_bf16 v60, v81, v29, v60
    v_dot2_f32_bf16 v60, v82, v30, v60
    v_dot2_f32_bf16 v60, v83, v31, v60
    v_dot2_f32_bf16 v61, v84, v28, 0
    v_dot2_f32_bf16 v61, v85, v29, v61
    v_dot2_f32_bf16 v61, v86, v30, v61
    v_dot2_f32_bf16 v61, v87, v31, v61
    v_add_f32_dpp v62, v60, v60 row_ror:8 row_mask:0xf bank_mask:0x3
    s_nop 1
    v_add_f32_dpp v62, v61, v61 row_ror:8 row_mask:0xf bank_mask:0xc
    v_dot2_f32_bf16 v60, v88, v28, 0
    v_dot2_f32_bf16 v60, v89, v29, v60
    v_dot2_f32_bf16 v60, v90, v30, v60
    v_dot2_f32_bf16 v60, v91, v31, v60
    s_mov_b32 s68, 311296
    buffer_load_dwordx4 v[80:83], v4, s[32:35], s68 offen nt
    v_dot2_f32_bf16 v61, v92, v28, 0
    v_dot2_f32_bf16 v61, v93, v29, v61
    v_dot2_f32_bf16 v61, v94, v30, v61
    v_dot2_f32_bf16 v61, v95, v31, v61
    v_add_f32_dpp v60, v60, v60 row_ror:8 row_mask:0xf bank_mask:0x3
    s_nop 1
    v_add_f32_dpp v60, v61, v61 row_ror:8 row_mask:0xf bank_mask:0xc
    v_add_f32_dpp v63, v62, v62 row_ror:12 row_mask:0xf bank_mask:0x5
    s_nop 1
    v_add_f32_dpp v63, v60, v60 row_ror:4 row_mask:0xf bank_mask:0xa
    v_dot2_f32_bf16 v60, v96, v28, 0
    v_dot2_f32_bf16 v60, v97, v29, v60
    v_dot2_f32_bf16 v60, v98, v30, v60
    v_dot2_f32_bf16 v60, v99, v31, v60
    v_dot2_f32_bf16 v61, v100, v28, 0
    v_dot2_f32_bf16 v61, v101, v29, v61
    v_dot2_f32_bf16 v61, v102, v30, v61
    v_dot2_f32_bf16 v61, v103, v31, v61
    s_mov_b32 s68, 311296
    buffer_load_dwordx4 v[84:87], v4, s[32:35], s68 offen offset:1024 nt
    v_add_f32_dpp v62, v60, v60 row_ror:8 row_mask:0xf bank_mask:0x3
    s_nop 1
    v_add_f32_dpp v62, v61, v61 row_ror:8 row_mask:0xf bank_mask:0xc
    v_dot2_f32_bf16 v60, v104, v28, 0
    v_dot2_f32_bf16 v60, v105, v29, v60
    v_dot2_f32_bf16 v60, v106, v30, v60
    v_dot2_f32_bf16 v60, v107, v31, v60
    v_dot2_f32_bf16 v61, v108, v28, 0
    v_dot2_f32_bf16 v61, v109, v29, v61
    v_dot2_f32_bf16 v61, v110, v30, v61
    v_dot2_f32_bf16 v61, v111, v31, v61
    v_add_f32_dpp v60, v60, v60 row_ror:8 row_mask:0xf bank_mask:0x3
    s_nop 1
    v_add_f32_dpp v60, v61, v61 row_ror:8 row_mask:0xf bank_mask:0xc
    v_add_f32_dpp v62, v62, v62 row_ror:12 row_mask:0xf bank_mask:0x5
    s_nop 1
    v_add_f32_dpp v62, v60, v60 row_ror:4 row_mask:0xf bank_mask:0xa
    v_add_f32_dpp v60, v63, v63 quad_perm:[2,3,0,1] row_mask:0xf bank_mask:0xf
    s_nop 0
    v_add_f32_dpp v61, v62, v62 quad_perm:[2,3,0,1] row_mask:0xf bank_mask:0xf
    v_cndmask_b32 v64, v60, v61, s[80:81]
    v_dot2_f32_bf16 v60, v112, v28, 0
    v_dot2_f32_bf16 v60, v113, v29, v60
    v_dot2_f32_bf16 v60, v114, v30, v60
    v_dot2_f32_bf16 v60, v115, v31, v60
    s_mov_b32 s68, 311296
    buffer_load_dwordx4 v[88:91], v4, s[32:35], s68 offen offset:2048 nt
    v_dot2_f32_bf16 v61, v116, v28, 0
    v_dot2_f32_bf16 v61, v117, v29, v61
    v_dot2_f32_bf16 v61, v118, v30, v61
    v_dot2_f32_bf16 v61, v119, v31, v61
    v_add_f32_dpp v62, v60, v60 row_ror:8 row_mask:0xf bank_mask:0x3
    s_nop 1
    v_add_f32_dpp v62, v61, v61 row_ror:8 row_mask:0xf bank_mask:0xc
    v_dot2_f32_bf16 v60, v120, v28, 0
    v_dot2_f32_bf16 v60, v121, v29, v60
    v_dot2_f32_bf16 v60, v122, v30, v60
    v_dot2_f32_bf16 v60, v123, v31, v60
    v_dot2_f32_bf16 v61, v124, v28, 0
    v_dot2_f32_bf16 v61, v125, v29, v61
    v_dot2_f32_bf16 v61, v126, v30, v61
    v_dot2_f32_bf16 v61, v127, v31, v61
    s_mov_b32 s68, 311296
    buffer_load_dwordx4 v[92:95], v4, s[32:35], s68 offen offset:3072 nt
    v_add_f32_dpp v60, v60, v60 row_ror:8 row_mask:0xf bank_mask:0x3
    s_nop 1
    v_add_f32_dpp v60, v61, v61 row_ror:8 row_mask:0xf bank_mask:0xc
    v_add_f32_dpp v63, v62, v62 row_ror:12 row_mask:0xf bank_mask:0x5
    s_nop 1
    v_add_f32_dpp v63, v60, v60 row_ror:4 row_mask:0xf bank_mask:0xa
    v_dot2_f32_bf16 v60, v128, v28, 0
    v_dot2_f32_bf16 v60, v129, v29, v60
    v_dot2_f32_bf16 v60, v130, v30, v60
    v_dot2_f32_bf16 v60, v131, v31, v60
    v_dot2_f32_bf16 v61, v132, v28, 0
    v_dot2_f32_bf16 v61, v133, v29, v61
    v_dot2_f32_bf16 v61, v134, v30, v61
    v_dot2_f32_bf16 v61, v135, v31, v61
    v_add_f32_dpp v62, v60, v60 row_ror:8 row_mask:0xf bank_mask:0x3
    s_nop 1
    v_add_f32_dpp v62, v61, v61 row_ror:8 row_mask:0xf bank_mask:0xc
    v_dot2_f32_bf16 v60, v136, v28, 0
    v_dot2_f32_bf16 v60, v137, v29, v60
    v_dot2_f32_bf16 v60, v138, v30, v60
    v_dot2_f32_bf16 v60, v139, v31, v60
    s_mov_b32 s68, 327680
    buffer_load_dwordx4 v[96:99], v4, s[32:35], s68 offen nt
    v_dot2_f32_bf16 v61, v140, v28, 0
    v_dot2_f32_bf16 v61, v141, v29, v61
    v_dot2_f32_bf16 v61, v142, v30, v61
    v_dot2_f32_bf16 v61, v143, v31, v61
    v_add_f32_dpp v60, v60, v60 row_ror:8 row_mask:0xf bank_mask:0x3
    s_nop 1
    v_add_f32_dpp v60, v61, v61 row_ror:8 row_mask:0xf bank_mask:0xc
    v_add_f32_dpp v62, v62, v62 row_ror:12 row_mask:0xf bank_mask:0x5
    s_nop 1
    v_add_f32_dpp v62, v60, v60 row_ror:4 row_mask:0xf bank_mask:0xa
    v_add_f32_dpp v60, v63, v63 quad_perm:[2,3,0,1] row_mask:0xf bank_mask:0xf
    s_nop 0
    v_add_f32_dpp v61, v62, v62 quad_perm:[2,3,0,1] row_mask:0xf bank_mask:0xf
    v_cndmask_b32 v63, v60, v61, s[80:81]
    v_add_f32_dpp v60, v64, v64 quad_perm:[1,0,3,2] row_mask:0xf bank_mask:0xf
    s_nop 0
    v_add_f32_dpp v61, v63, v63 quad_perm:[1,0,3,2] row_mask:0xf bank_mask:0xf
    v_cndmask_b32 v32, v60, v61, s[82:83]
    v_cvt_pk_bf16_f32 v32, 0, v32
    v_mul_f32 v32, 0x3db504f3, v32
    v_cvt_pk_bf16_f32 v32, 0, v32
    v_dot2_f32_bf16 v60, v144, v28, 0
    v_dot2_f32_bf16 v60, v145, v29, v60
    v_dot2_f32_bf16 v60, v146, v30, v60
    v_dot2_f32_bf16 v60, v147, v31, v60
    v_dot2_f32_bf16 v61, v148, v28, 0
    v_dot2_f32_bf16 v61, v149, v29, v61
    v_dot2_f32_bf16 v61, v150, v30, v61
    v_dot2_f32_bf16 v61, v151, v31, v61
    s_mov_b32 s68, 327680
    buffer_load_dwordx4 v[100:103], v4, s[32:35], s68 offen offset:1024 nt
    v_add_f32_dpp v62, v60, v60 row_ror:8 row_mask:0xf bank_mask:0x3
    s_nop 1
    v_add_f32_dpp v62, v61, v61 row_ror:8 row_mask:0xf bank_mask:0xc
    v_dot2_f32_bf16 v60, v152, v28, 0
    v_dot2_f32_bf16 v60, v153, v29, v60
    v_dot2_f32_bf16 v60, v154, v30, v60
    v_dot2_f32_bf16 v60, v155, v31, v60
    v_dot2_f32_bf16 v61, v156, v28, 0
    v_dot2_f32_bf16 v61, v157, v29, v61
    v_dot2_f32_bf16 v61, v158, v30, v61
    v_dot2_f32_bf16 v61, v159, v31, v61
    v_add_f32_dpp v60, v60, v60 row_ror:8 row_mask:0xf bank_mask:0x3
    s_nop 1
    v_add_f32_dpp v60, v61, v61 row_ror:8 row_mask:0xf bank_mask:0xc
    v_add_f32_dpp v63, v62, v62 row_ror:12 row_mask:0xf bank_mask:0x5
    s_nop 1
    v_add_f32_dpp v63, v60, v60 row_ror:4 row_mask:0xf bank_mask:0xa
    v_dot2_f32_bf16 v60, v160, v28, 0
    v_dot2_f32_bf16 v60, v161, v29, v60
    v_dot2_f32_bf16 v60, v162, v30, v60
    v_dot2_f32_bf16 v60, v163, v31, v60
    s_mov_b32 s68, 327680
    buffer_load_dwordx4 v[104:107], v4, s[32:35], s68 offen offset:2048 nt
    v_dot2_f32_bf16 v61, v164, v28, 0
    v_dot2_f32_bf16 v61, v165, v29, v61
    v_dot2_f32_bf16 v61, v166, v30, v61
    v_dot2_f32_bf16 v61, v167, v31, v61
    v_add_f32_dpp v62, v60, v60 row_ror:8 row_mask:0xf bank_mask:0x3
    s_nop 1
    v_add_f32_dpp v62, v61, v61 row_ror:8 row_mask:0xf bank_mask:0xc
    v_dot2_f32_bf16 v60, v168, v28, 0
    v_dot2_f32_bf16 v60, v169, v29, v60
    v_dot2_f32_bf16 v60, v170, v30, v60
    v_dot2_f32_bf16 v60, v171, v31, v60
    v_dot2_f32_bf16 v61, v172, v28, 0
    v_dot2_f32_bf16 v61, v173, v29, v61
    v_dot2_f32_bf16 v61, v174, v30, v61
    v_dot2_f32_bf16 v61, v175, v31, v61
    s_mov_b32 s68, 327680
    buffer_load_dwordx4 v[108:111], v4, s[32:35], s68 offen offset:3072 nt
    v_add_f32_dpp v60, v60, v60 row_ror:8 row_mask:0xf bank_mask:0x3
    s_nop 1
    v_add_f32_dpp v60, v61, v61 row_ror:8 row_mask:0xf bank_mask:0xc
    v_add_f32_dpp v62, v62, v62 row_ror:12 row_mask:0xf bank_mask:0x5
    s_nop 1
    v_add_f32_dpp v62, v60, v60 row_ror:4 row_mask:0xf bank_mask:0xa
    v_add_f32_dpp v60, v63, v63 quad_perm:[2,3,0,1] row_mask:0xf bank_mask:0xf
    s_nop 0
    v_add_f32_dpp v61, v62, v62 quad_perm:[2,3,0,1] row_mask:0xf bank_mask:0xf
    v_cndmask_b32 v64, v60, v61, s[80:81]
    v_dot2_f32_bf16 v60, v176, v28, 0
    v_dot2_f32_bf16 v60, v177, v29, v60
    v_dot2_f32_bf16 v60, v178, v30, v60
    v_dot2_f32_bf16 v60, v179, v31, v60
    v_dot2_f32_bf16 v61, v180, v28, 0
    v_dot2_f32_bf16 v61, v181, v29, v61
    v_dot2_f32_bf16 v61, v182, v30, v61
    v_dot2_f32_bf16 v61, v183, v31, v61
    v_add_f32_dpp v62, v60, v60 row_ror:8 row_mask:0xf bank_mask:0x3
    s_nop 1
    v_add_f32_dpp v62, v61, v61 row_ror:8 row_mask:0xf bank_mask:0xc
    v_dot2_f32_bf16 v60, v184, v28, 0
    v_dot2_f32_bf16 v60, v185, v29, v60
    v_dot2_f32_bf16 v60, v186, v30, v60
    v_dot2_f32_bf16 v60, v187, v31, v60
    s_mov_b32 s68, 344064
    buffer_load_dwordx4 v[112:115], v4, s[32:35], s68 offen nt
    v_dot2_f32_bf16 v61, v188, v28, 0
    v_dot2_f32_bf16 v61, v189, v29, v61
    v_dot2_f32_bf16 v61, v190, v30, v61
    v_dot2_f32_bf16 v61, v191, v31, v61
    v_add_f32_dpp v60, v60, v60 row_ror:8 row_mask:0xf bank_mask:0x3
    s_nop 1
    v_add_f32_dpp v60, v61, v61 row_ror:8 row_mask:0xf bank_mask:0xc
    v_add_f32_dpp v63, v62, v62 row_ror:12 row_mask:0xf bank_mask:0x5
    s_nop 1
    v_add_f32_dpp v63, v60, v60 row_ror:4 row_mask:0xf bank_mask:0xa
    v_dot2_f32_bf16 v60, v192, v28, 0
    v_dot2_f32_bf16 v60, v193, v29, v60
    v_dot2_f32_bf16 v60, v194, v30, v60
    v_dot2_f32_bf16 v60, v195, v31, v60
    v_dot2_f32_bf16 v61, v196, v28, 0
    v_dot2_f32_bf16 v61, v197, v29, v61
    v_dot2_f32_bf16 v61, v198, v30, v61
    v_dot2_f32_bf16 v61, v199, v31, v61
    s_mov_b32 s68, 344064
    buffer_load_dwordx4 v[116:119], v4, s[32:35], s68 offen offset:1024 nt
    v_add_f32_dpp v62, v60, v60 row_ror:8 row_mask:0xf bank_mask:0x3
    s_nop 1
    v_add_f32_dpp v62, v61, v61 row_ror:8 row_mask:0xf bank_mask:0xc
    v_dot2_f32_bf16 v60, v200, v28, 0
    v_dot2_f32_bf16 v60, v201, v29, v60
    v_dot2_f32_bf16 v60, v202, v30, v60
    v_dot2_f32_bf16 v60, v203, v31, v60
    v_dot2_f32_bf16 v61, v204, v28, 0
    v_dot2_f32_bf16 v61, v205, v29, v61
    v_dot2_f32_bf16 v61, v206, v30, v61
    v_dot2_f32_bf16 v61, v207, v31, v61
    v_add_f32_dpp v60, v60, v60 row_ror:8 row_mask:0xf bank_mask:0x3
    s_nop 1
    v_add_f32_dpp v60, v61, v61 row_ror:8 row_mask:0xf bank_mask:0xc
    v_add_f32_dpp v62, v62, v62 row_ror:12 row_mask:0xf bank_mask:0x5
    s_nop 1
    v_add_f32_dpp v62, v60, v60 row_ror:4 row_mask:0xf bank_mask:0xa
    v_add_f32_dpp v60, v63, v63 quad_perm:[2,3,0,1] row_mask:0xf bank_mask:0xf
    s_nop 0
    v_add_f32_dpp v61, v62, v62 quad_perm:[2,3,0,1] row_mask:0xf bank_mask:0xf
    v_cndmask_b32 v63, v60, v61, s[80:81]
    v_add_f32_dpp v60, v64, v64 quad_perm:[1,0,3,2] row_mask:0xf bank_mask:0xf
    s_nop 0
    v_add_f32_dpp v61, v63, v63 quad_perm:[1,0,3,2] row_mask:0xf bank_mask:0xf
    v_cndmask_b32 v33, v60, v61, s[82:83]
    v_cvt_pk_bf16_f32 v33, 0, v33
    v_mul_f32 v33, 0x3db504f3, v33
    v_cvt_pk_bf16_f32 v33, 0, v33
    v_dot2_f32_bf16 v60, v208, v28, 0
    v_dot2_f32_bf16 v60, v209, v29, v60
    v_dot2_f32_bf16 v60, v210, v30, v60
    v_dot2_f32_bf16 v60, v211, v31, v60
    s_mov_b32 s68, 344064
    buffer_load_dwordx4 v[120:123], v4, s[32:35], s68 offen offset:2048 nt
    v_dot2_f32_bf16 v61, v212, v28, 0
    v_dot2_f32_bf16 v61, v213, v29, v61
    v_dot2_f32_bf16 v61, v214, v30, v61
    v_dot2_f32_bf16 v61, v215, v31, v61
    v_add_f32_dpp v62, v60, v60 row_ror:8 row_mask:0xf bank_mask:0x3
    s_nop 1
    v_add_f32_dpp v62, v61, v61 row_ror:8 row_mask:0xf bank_mask:0xc
    v_dot2_f32_bf16 v60, v216, v28, 0
    v_dot2_f32_bf16 v60, v217, v29, v60
    v_dot2_f32_bf16 v60, v218, v30, v60
    v_dot2_f32_bf16 v60, v219, v31, v60
    v_dot2_f32_bf16 v61, v220, v28, 0
    v_dot2_f32_bf16 v61, v221, v29, v61
    v_dot2_f32_bf16 v61, v222, v30, v61
    v_dot2_f32_bf16 v61, v223, v31, v61
    s_mov_b32 s68, 344064
    buffer_load_dwordx4 v[124:127], v4, s[32:35], s68 offen offset:3072 nt
    v_add_f32_dpp v60, v60, v60 row_ror:8 row_mask:0xf bank_mask:0x3
    s_nop 1
    v_add_f32_dpp v60, v61, v61 row_ror:8 row_mask:0xf bank_mask:0xc
    v_add_f32_dpp v63, v62, v62 row_ror:12 row_mask:0xf bank_mask:0x5
    s_nop 1
    v_add_f32_dpp v63, v60, v60 row_ror:4 row_mask:0xf bank_mask:0xa
    v_dot2_f32_bf16 v60, v224, v28, 0
    v_dot2_f32_bf16 v60, v225, v29, v60
    v_dot2_f32_bf16 v60, v226, v30, v60
    v_dot2_f32_bf16 v60, v227, v31, v60
    v_dot2_f32_bf16 v61, v228, v28, 0
    v_dot2_f32_bf16 v61, v229, v29, v61
    v_dot2_f32_bf16 v61, v230, v30, v61
    v_dot2_f32_bf16 v61, v231, v31, v61
    v_add_f32_dpp v62, v60, v60 row_ror:8 row_mask:0xf bank_mask:0x3
    s_nop 1
    v_add_f32_dpp v62, v61, v61 row_ror:8 row_mask:0xf bank_mask:0xc
    ds_read_b128 v[240:243], v57
    v_dot2_f32_bf16 v60, v232, v28, 0
    v_dot2_f32_bf16 v60, v233, v29, v60
    v_dot2_f32_bf16 v60, v234, v30, v60
    v_dot2_f32_bf16 v60, v235, v31, v60
    s_mov_b32 s68, 360448
    buffer_load_dwordx4 v[128:131], v4, s[32:35], s68 offen nt
    ds_read_b128 v[244:247], v57 offset:1024
    v_dot2_f32_bf16 v61, v236, v28, 0
    v_dot2_f32_bf16 v61, v237, v29, v61
    v_dot2_f32_bf16 v61, v238, v30, v61
    v_dot2_f32_bf16 v61, v239, v31, v61
    v_add_f32_dpp v60, v60, v60 row_ror:8 row_mask:0xf bank_mask:0x3
    s_nop 1
    v_add_f32_dpp v60, v61, v61 row_ror:8 row_mask:0xf bank_mask:0xc
    v_add_f32_dpp v62, v62, v62 row_ror:12 row_mask:0xf bank_mask:0x5
    s_nop 1
    v_add_f32_dpp v62, v60, v60 row_ror:4 row_mask:0xf bank_mask:0xa
    v_add_f32_dpp v60, v63, v63 quad_perm:[2,3,0,1] row_mask:0xf bank_mask:0xf
    s_nop 0
    v_add_f32_dpp v61, v62, v62 quad_perm:[2,3,0,1] row_mask:0xf bank_mask:0xf
    v_cndmask_b32 v64, v60, v61, s[80:81]
    ds_read_b128 v[248:251], v57 offset:2048
    s_waitcnt lgkmcnt(2)
    v_dot2_f32_bf16 v60, v240, v28, 0
    v_dot2_f32_bf16 v60, v241, v29, v60
    v_dot2_f32_bf16 v60, v242, v30, v60
    v_dot2_f32_bf16 v60, v243, v31, v60
    ds_read_b128 v[252:255], v57 offset:3072
    s_waitcnt lgkmcnt(2)
    v_dot2_f32_bf16 v61, v244, v28, 0
    v_dot2_f32_bf16 v61, v245, v29, v61
    v_dot2_f32_bf16 v61, v246, v30, v61
    v_dot2_f32_bf16 v61, v247, v31, v61
    s_mov_b32 s68, 360448
    buffer_load_dwordx4 v[132:135], v4, s[32:35], s68 offen offset:1024 nt
    v_add_f32_dpp v62, v60, v60 row_ror:8 row_mask:0xf bank_mask:0x3
    s_nop 1
    v_add_f32_dpp v62, v61, v61 row_ror:8 row_mask:0xf bank_mask:0xc
    ds_read_b128 v[240:243], v57 offset:4096
    s_waitcnt lgkmcnt(2)
    v_dot2_f32_bf16 v60, v248, v28, 0
    v_dot2_f32_bf16 v60, v249, v29, v60
    v_dot2_f32_bf16 v60, v250, v30, v60
    v_dot2_f32_bf16 v60, v251, v31, v60
    ds_read_b128 v[244:247], v57 offset:5120
    s_waitcnt lgkmcnt(2)
    v_dot2_f32_bf16 v61, v252, v28, 0
    v_dot2_f32_bf16 v61, v253, v29, v61
    v_dot2_f32_bf16 v61, v254, v30, v61
    v_dot2_f32_bf16 v61, v255, v31, v61
    v_add_f32_dpp v60, v60, v60 row_ror:8 row_mask:0xf bank_mask:0x3
    s_nop 1
    v_add_f32_dpp v60, v61, v61 row_ror:8 row_mask:0xf bank_mask:0xc
    v_add_f32_dpp v63, v62, v62 row_ror:12 row_mask:0xf bank_mask:0x5
    s_nop 1
    v_add_f32_dpp v63, v60, v60 row_ror:4 row_mask:0xf bank_mask:0xa
    ds_read_b128 v[248:251], v57 offset:6144
    s_waitcnt lgkmcnt(2)
    v_dot2_f32_bf16 v60, v240, v28, 0
    v_dot2_f32_bf16 v60, v241, v29, v60
    v_dot2_f32_bf16 v60, v242, v30, v60
    v_dot2_f32_bf16 v60, v243, v31, v60
    s_mov_b32 s68, 360448
    buffer_load_dwordx4 v[136:139], v4, s[32:35], s68 offen offset:2048 nt
    ds_read_b128 v[252:255], v57 offset:7168
    s_waitcnt lgkmcnt(2)
    v_dot2_f32_bf16 v61, v244, v28, 0
    v_dot2_f32_bf16 v61, v245, v29, v61
    v_dot2_f32_bf16 v61, v246, v30, v61
    v_dot2_f32_bf16 v61, v247, v31, v61
    v_add_f32_dpp v62, v60, v60 row_ror:8 row_mask:0xf bank_mask:0x3
    s_nop 1
    v_add_f32_dpp v62, v61, v61 row_ror:8 row_mask:0xf bank_mask:0xc
    ds_read_b128 v[240:243], v57 offset:8192
    s_waitcnt lgkmcnt(2)
    v_dot2_f32_bf16 v60, v248, v28, 0
    v_dot2_f32_bf16 v60, v249, v29, v60
    v_dot2_f32_bf16 v60, v250, v30, v60
    v_dot2_f32_bf16 v60, v251, v31, v60
    ds_read_b128 v[244:247], v57 offset:9216
    s_waitcnt lgkmcnt(2)
    v_dot2_f32_bf16 v61, v252, v28, 0
    v_dot2_f32_bf16 v61, v253, v29, v61
    v_dot2_f32_bf16 v61, v254, v30, v61
    v_dot2_f32_bf16 v61, v255, v31, v61
    s_mov_b32 s68, 360448
    buffer_load_dwordx4 v[140:143], v4, s[32:35], s68 offen offset:3072 nt
    v_add_f32_dpp v60, v60, v60 row_ror:8 row_mask:0xf bank_mask:0x3
    s_nop 1
    v_add_f32_dpp v60, v61, v61 row_ror:8 row_mask:0xf bank_mask:0xc
    v_add_f32_dpp v62, v62, v62 row_ror:12 row_mask:0xf bank_mask:0x5
    s_nop 1
    v_add_f32_dpp v62, v60, v60 row_ror:4 row_mask:0xf bank_mask:0xa
    v_add_f32_dpp v60, v63, v63 quad_perm:[2,3,0,1] row_mask:0xf bank_mask:0xf
    s_nop 0
    v_add_f32_dpp v61, v62, v62 quad_perm:[2,3,0,1] row_mask:0xf bank_mask:0xf
    v_cndmask_b32 v63, v60, v61, s[80:81]
    v_add_f32_dpp v60, v64, v64 quad_perm:[1,0,3,2] row_mask:0xf bank_mask:0xf
    s_nop 0
    v_add_f32_dpp v61, v63, v63 quad_perm:[1,0,3,2] row_mask:0xf bank_mask:0xf
    v_cndmask_b32 v34, v60, v61, s[82:83]
    v_cvt_pk_bf16_f32 v34, 0, v34
    v_mul_f32 v34, 0x3db504f3, v34
    v_cvt_pk_bf16_f32 v34, 0, v34
    ds_read_b128 v[248:251], v57 offset:10240
    s_waitcnt lgkmcnt(2)
    v_dot2_f32_bf16 v60, v240, v28, 0
    v_dot2_f32_bf16 v60, v241, v29, v60
    v_dot2_f32_bf16 v60, v242, v30, v60
    v_dot2_f32_bf16 v60, v243, v31, v60
    ds_read_b128 v[252:255], v57 offset:11264
    s_waitcnt lgkmcnt(2)
    v_dot2_f32_bf16 v61, v244, v28, 0
    v_dot2_f32_bf16 v61, v245, v29, v61
    v_dot2_f32_bf16 v61, v246, v30, v61
    v_dot2_f32_bf16 v61, v247, v31, v61
    v_add_f32_dpp v62, v60, v60 row_ror:8 row_mask:0xf bank_mask:0x3
    s_nop 1
    v_add_f32_dpp v62, v61, v61 row_ror:8 row_mask:0xf bank_mask:0xc
    ds_read_b128 v[240:243], v57 offset:12288
    s_waitcnt lgkmcnt(2)
    v_dot2_f32_bf16 v60, v248, v28, 0
    v_dot2_f32_bf16 v60, v249, v29, v60
    v_dot2_f32_bf16 v60, v250, v30, v60
    v_dot2_f32_bf16 v60, v251, v31, v60
    s_mov_b32 s68, 376832
    buffer_load_dwordx4 v[144:147], v4, s[32:35], s68 offen nt
    ds_read_b128 v[244:247], v57 offset:13312
    s_waitcnt lgkmcnt(2)
    v_dot2_f32_bf16 v61, v252, v28, 0
    v_dot2_f32_bf16 v61, v253, v29, v61
    v_dot2_f32_bf16 v61, v254, v30, v61
    v_dot2_f32_bf16 v61, v255, v31, v61
    v_add_f32_dpp v60, v60, v60 row_ror:8 row_mask:0xf bank_mask:0x3
    s_nop 1
    v_add_f32_dpp v60, v61, v61 row_ror:8 row_mask:0xf bank_mask:0xc
    v_add_f32_dpp v63, v62, v62 row_ror:12 row_mask:0xf bank_mask:0x5
    s_nop 1
    v_add_f32_dpp v63, v60, v60 row_ror:4 row_mask:0xf bank_mask:0xa
    ds_read_b128 v[248:251], v57 offset:14336
    s_waitcnt lgkmcnt(2)
    v_dot2_f32_bf16 v60, v240, v28, 0
    v_dot2_f32_bf16 v60, v241, v29, v60
    v_dot2_f32_bf16 v60, v242, v30, v60
    v_dot2_f32_bf16 v60, v243, v31, v60
    ds_read_b128 v[252:255], v57 offset:15360
    s_waitcnt lgkmcnt(2)
    v_dot2_f32_bf16 v61, v244, v28, 0
    v_dot2_f32_bf16 v61, v245, v29, v61
    v_dot2_f32_bf16 v61, v246, v30, v61
    v_dot2_f32_bf16 v61, v247, v31, v61
    s_mov_b32 s68, 376832
    buffer_load_dwordx4 v[148:151], v4, s[32:35], s68 offen offset:1024 nt
    v_add_f32_dpp v62, v60, v60 row_ror:8 row_mask:0xf bank_mask:0x3
    s_nop 1
    v_add_f32_dpp v62, v61, v61 row_ror:8 row_mask:0xf bank_mask:0xc
    ds_read_b128 v[240:243], v57 offset:16384
    s_waitcnt lgkmcnt(2)
    v_dot2_f32_bf16 v60, v248, v28, 0
    v_dot2_f32_bf16 v60, v249, v29, v60
    v_dot2_f32_bf16 v60, v250, v30, v60
    v_dot2_f32_bf16 v60, v251, v31, v60
    ds_read_b128 v[244:247], v57 offset:17408
    s_waitcnt lgkmcnt(2)
    v_dot2_f32_bf16 v61, v252, v28, 0
    v_dot2_f32_bf16 v61, v253, v29, v61
    v_dot2_f32_bf16 v61, v254, v30, v61
    v_dot2_f32_bf16 v61, v255, v31, v61
    v_add_f32_dpp v60, v60, v60 row_ror:8 row_mask:0xf bank_mask:0x3
    s_nop 1
    v_add_f32_dpp v60, v61, v61 row_ror:8 row_mask:0xf bank_mask:0xc
    v_add_f32_dpp v62, v62, v62 row_ror:12 row_mask:0xf bank_mask:0x5
    s_nop 1
    v_add_f32_dpp v62, v60, v60 row_ror:4 row_mask:0xf bank_mask:0xa
    v_add_f32_dpp v60, v63, v63 quad_perm:[2,3,0,1] row_mask:0xf bank_mask:0xf
    s_nop 0
    v_add_f32_dpp v61, v62, v62 quad_perm:[2,3,0,1] row_mask:0xf bank_mask:0xf
    v_cndmask_b32 v64, v60, v61, s[80:81]
    ds_read_b128 v[248:251], v57 offset:18432
    s_waitcnt lgkmcnt(2)
    v_dot2_f32_bf16 v60, v240, v28, 0
    v_dot2_f32_bf16 v60, v241, v29, v60
    v_dot2_f32_bf16 v60, v242, v30, v60
    v_dot2_f32_bf16 v60, v243, v31, v60
    s_mov_b32 s68, 376832
    buffer_load_dwordx4 v[152:155], v4, s[32:35], s68 offen offset:2048 nt
    ds_read_b128 v[252:255], v57 offset:19456
    s_waitcnt lgkmcnt(2)
    v_dot2_f32_bf16 v61, v244, v28, 0
    v_dot2_f32_bf16 v61, v245, v29, v61
    v_dot2_f32_bf16 v61, v246, v30, v61
    v_dot2_f32_bf16 v61, v247, v31, v61
    v_add_f32_dpp v62, v60, v60 row_ror:8 row_mask:0xf bank_mask:0x3
    s_nop 1
    v_add_f32_dpp v62, v61, v61 row_ror:8 row_mask:0xf bank_mask:0xc
    ds_read_b128 v[240:243], v57 offset:20480
    s_waitcnt lgkmcnt(2)
    v_dot2_f32_bf16 v60, v248, v28, 0
    v_dot2_f32_bf16 v60, v249, v29, v60
    v_dot2_f32_bf16 v60, v250, v30, v60
    v_dot2_f32_bf16 v60, v251, v31, v60
    ds_read_b128 v[244:247], v57 offset:21504
    s_waitcnt lgkmcnt(2)
    v_dot2_f32_bf16 v61, v252, v28, 0
    v_dot2_f32_bf16 v61, v253, v29, v61
    v_dot2_f32_bf16 v61, v254, v30, v61
    v_dot2_f32_bf16 v61, v255, v31, v61
    s_mov_b32 s68, 376832
    buffer_load_dwordx4 v[156:159], v4, s[32:35], s68 offen offset:3072 nt
    v_add_f32_dpp v60, v60, v60 row_ror:8 row_mask:0xf bank_mask:0x3
    s_nop 1
    v_add_f32_dpp v60, v61, v61 row_ror:8 row_mask:0xf bank_mask:0xc
    v_add_f32_dpp v63, v62, v62 row_ror:12 row_mask:0xf bank_mask:0x5
    s_nop 1
    v_add_f32_dpp v63, v60, v60 row_ror:4 row_mask:0xf bank_mask:0xa
    ds_read_b128 v[248:251], v57 offset:22528
    s_waitcnt lgkmcnt(2)
    v_dot2_f32_bf16 v60, v240, v28, 0
    v_dot2_f32_bf16 v60, v241, v29, v60
    v_dot2_f32_bf16 v60, v242, v30, v60
    v_dot2_f32_bf16 v60, v243, v31, v60
    s_waitcnt vmcnt(32)
    ds_read_b128 v[252:255], v57 offset:23552
    s_waitcnt lgkmcnt(2)
    v_dot2_f32_bf16 v61, v244, v28, 0
    v_dot2_f32_bf16 v61, v245, v29, v61
    v_dot2_f32_bf16 v61, v246, v30, v61
    v_dot2_f32_bf16 v61, v247, v31, v61
    v_add_f32_dpp v62, v60, v60 row_ror:8 row_mask:0xf bank_mask:0x3
    s_nop 1
    v_add_f32_dpp v62, v61, v61 row_ror:8 row_mask:0xf bank_mask:0xc
    s_waitcnt vmcnt(31)
    ds_read_b128 v[240:243], v57 offset:24576
    s_waitcnt lgkmcnt(2)
    v_dot2_f32_bf16 v60, v248, v28, 0
    v_dot2_f32_bf16 v60, v249, v29, v60
    v_dot2_f32_bf16 v60, v250, v30, v60
    v_dot2_f32_bf16 v60, v251, v31, v60
    s_mov_b32 s68, 393216
    buffer_load_dwordx4 v[160:163], v4, s[32:35], s68 offen nt
    s_waitcnt vmcnt(31)
    ds_read_b128 v[244:247], v57 offset:25600
    s_waitcnt lgkmcnt(2)
    v_dot2_f32_bf16 v61, v252, v28, 0
    v_dot2_f32_bf16 v61, v253, v29, v61
    v_dot2_f32_bf16 v61, v254, v30, v61
    v_dot2_f32_bf16 v61, v255, v31, v61
    v_add_f32_dpp v60, v60, v60 row_ror:8 row_mask:0xf bank_mask:0x3
    s_nop 1
    v_add_f32_dpp v60, v61, v61 row_ror:8 row_mask:0xf bank_mask:0xc
    v_add_f32_dpp v62, v62, v62 row_ror:12 row_mask:0xf bank_mask:0x5
    s_nop 1
    v_add_f32_dpp v62, v60, v60 row_ror:4 row_mask:0xf bank_mask:0xa
    v_add_f32_dpp v60, v63, v63 quad_perm:[2,3,0,1] row_mask:0xf bank_mask:0xf
    s_nop 0
    v_add_f32_dpp v61, v62, v62 quad_perm:[2,3,0,1] row_mask:0xf bank_mask:0xf
    v_cndmask_b32 v63, v60, v61, s[80:81]
    v_add_f32_dpp v60, v64, v64 quad_perm:[1,0,3,2] row_mask:0xf bank_mask:0xf
    s_nop 0
    v_add_f32_dpp v61, v63, v63 quad_perm:[1,0,3,2] row_mask:0xf bank_mask:0xf
    v_cndmask_b32 v35, v60, v61, s[82:83]
    v_cvt_pk_bf16_f32 v35, 0, v35
    v_mul_f32 v35, 0x3db504f3, v35
    v_cvt_pk_bf16_f32 v35, 0, v35
    s_waitcnt vmcnt(30)
    ds_read_b128 v[248:251], v57 offset:26624
    s_waitcnt lgkmcnt(2)
    v_dot2_f32_bf16 v60, v240, v28, 0
    v_dot2_f32_bf16 v60, v241, v29, v60
    v_dot2_f32_bf16 v60, v242, v30, v60
    v_dot2_f32_bf16 v60, v243, v31, v60
    s_waitcnt vmcnt(29)
    ds_read_b128 v[252:255], v57 offset:27648
    s_waitcnt lgkmcnt(2)
    v_dot2_f32_bf16 v61, v244, v28, 0
    v_dot2_f32_bf16 v61, v245, v29, v61
    v_dot2_f32_bf16 v61, v246, v30, v61
    v_dot2_f32_bf16 v61, v247, v31, v61
    s_mov_b32 s68, 393216
    buffer_load_dwordx4 v[164:167], v4, s[32:35], s68 offen offset:1024 nt
    v_add_f32_dpp v62, v60, v60 row_ror:8 row_mask:0xf bank_mask:0x3
    s_nop 1
    v_add_f32_dpp v62, v61, v61 row_ror:8 row_mask:0xf bank_mask:0xc
    s_waitcnt vmcnt(29)
    ds_read_b128 v[240:243], v57 offset:28672
    s_waitcnt lgkmcnt(2)
    v_dot2_f32_bf16 v60, v248, v28, 0
    v_dot2_f32_bf16 v60, v249, v29, v60
    v_dot2_f32_bf16 v60, v250, v30, v60
    v_dot2_f32_bf16 v60, v251, v31, v60
    s_waitcnt vmcnt(28)
    ds_read_b128 v[244:247], v57 offset:29696
    s_waitcnt lgkmcnt(2)
    v_dot2_f32_bf16 v61, v252, v28, 0
    v_dot2_f32_bf16 v61, v253, v29, v61
    v_dot2_f32_bf16 v61, v254, v30, v61
    v_dot2_f32_bf16 v61, v255, v31, v61
    v_add_f32_dpp v60, v60, v60 row_ror:8 row_mask:0xf bank_mask:0x3
    s_nop 1
    v_add_f32_dpp v60, v61, v61 row_ror:8 row_mask:0xf bank_mask:0xc
    v_add_f32_dpp v63, v62, v62 row_ror:12 row_mask:0xf bank_mask:0x5
    s_nop 1
    v_add_f32_dpp v63, v60, v60 row_ror:4 row_mask:0xf bank_mask:0xa
    s_waitcnt vmcnt(27)
    ds_read_b128 v[248:251], v57 offset:30720
    s_waitcnt lgkmcnt(2)
    v_dot2_f32_bf16 v60, v240, v28, 0
    v_dot2_f32_bf16 v60, v241, v29, v60
    v_dot2_f32_bf16 v60, v242, v30, v60
    v_dot2_f32_bf16 v60, v243, v31, v60
    s_mov_b32 s68, 393216
    buffer_load_dwordx4 v[168:171], v4, s[32:35], s68 offen offset:2048 nt
    s_waitcnt vmcnt(27)
    ds_read_b128 v[252:255], v57 offset:31744
    s_waitcnt lgkmcnt(2)
    v_dot2_f32_bf16 v61, v244, v28, 0
    v_dot2_f32_bf16 v61, v245, v29, v61
    v_dot2_f32_bf16 v61, v246, v30, v61
    v_dot2_f32_bf16 v61, v247, v31, v61
    v_add_f32_dpp v62, v60, v60 row_ror:8 row_mask:0xf bank_mask:0x3
    s_nop 1
    v_add_f32_dpp v62, v61, v61 row_ror:8 row_mask:0xf bank_mask:0xc
    s_waitcnt vmcnt(26)
    ds_read_b128 v[240:243], v57 offset:32768
    s_waitcnt lgkmcnt(2)
    v_dot2_f32_bf16 v60, v248, v28, 0
    v_dot2_f32_bf16 v60, v249, v29, v60
    v_dot2_f32_bf16 v60, v250, v30, v60
    v_dot2_f32_bf16 v60, v251, v31, v60
    s_waitcnt vmcnt(25)
    ds_read_b128 v[244:247], v57 offset:33792
    s_waitcnt lgkmcnt(2)
    v_dot2_f32_bf16 v61, v252, v28, 0
    v_dot2_f32_bf16 v61, v253, v29, v61
    v_dot2_f32_bf16 v61, v254, v30, v61
    v_dot2_f32_bf16 v61, v255, v31, v61
    s_mov_b32 s68, 393216
    buffer_load_dwordx4 v[172:175], v4, s[32:35], s68 offen offset:3072 nt
    v_add_f32_dpp v60, v60, v60 row_ror:8 row_mask:0xf bank_mask:0x3
    s_nop 1
    v_add_f32_dpp v60, v61, v61 row_ror:8 row_mask:0xf bank_mask:0xc
    v_add_f32_dpp v62, v62, v62 row_ror:12 row_mask:0xf bank_mask:0x5
    s_nop 1
    v_add_f32_dpp v62, v60, v60 row_ror:4 row_mask:0xf bank_mask:0xa
    v_add_f32_dpp v60, v63, v63 quad_perm:[2,3,0,1] row_mask:0xf bank_mask:0xf
    s_nop 0
    v_add_f32_dpp v61, v62, v62 quad_perm:[2,3,0,1] row_mask:0xf bank_mask:0xf
    v_cndmask_b32 v64, v60, v61, s[80:81]
    s_waitcnt vmcnt(25)
    ds_read_b128 v[248:251], v57 offset:34816
    s_waitcnt lgkmcnt(2)
    v_dot2_f32_bf16 v60, v240, v28, 0
    v_dot2_f32_bf16 v60, v241, v29, v60
    v_dot2_f32_bf16 v60, v242, v30, v60
    v_dot2_f32_bf16 v60, v243, v31, v60
    s_waitcnt vmcnt(24)
    ds_read_b128 v[252:255], v57 offset:35840
    s_waitcnt lgkmcnt(2)
    v_dot2_f32_bf16 v61, v244, v28, 0
    v_dot2_f32_bf16 v61, v245, v29, v61
    v_dot2_f32_bf16 v61, v246, v30, v61
    v_dot2_f32_bf16 v61, v247, v31, v61
    v_add_f32_dpp v62, v60, v60 row_ror:8 row_mask:0xf bank_mask:0x3
    s_nop 1
    v_add_f32_dpp v62, v61, v61 row_ror:8 row_mask:0xf bank_mask:0xc
    s_waitcnt lgkmcnt(1)
    v_dot2_f32_bf16 v60, v248, v28, 0
    v_dot2_f32_bf16 v60, v249, v29, v60
    v_dot2_f32_bf16 v60, v250, v30, v60
    v_dot2_f32_bf16 v60, v251, v31, v60
    s_mov_b32 s68, 409600
    buffer_load_dwordx4 v[176:179], v4, s[32:35], s68 offen nt
    s_waitcnt lgkmcnt(0)
    v_dot2_f32_bf16 v61, v252, v28, 0
    v_dot2_f32_bf16 v61, v253, v29, v61
    v_dot2_f32_bf16 v61, v254, v30, v61
    v_dot2_f32_bf16 v61, v255, v31, v61
    v_add_f32_dpp v60, v60, v60 row_ror:8 row_mask:0xf bank_mask:0x3
    s_nop 1
    v_add_f32_dpp v60, v61, v61 row_ror:8 row_mask:0xf bank_mask:0xc
    v_add_f32_dpp v63, v62, v62 row_ror:12 row_mask:0xf bank_mask:0x5
    s_nop 1
    v_add_f32_dpp v63, v60, v60 row_ror:4 row_mask:0xf bank_mask:0xa
    s_waitcnt vmcnt(24)
    v_dot2_f32_bf16 v60, v80, v28, 0
    v_dot2_f32_bf16 v60, v81, v29, v60
    v_dot2_f32_bf16 v60, v82, v30, v60
    v_dot2_f32_bf16 v60, v83, v31, v60
    s_waitcnt vmcnt(23)
    v_dot2_f32_bf16 v61, v84, v28, 0
    v_dot2_f32_bf16 v61, v85, v29, v61
    v_dot2_f32_bf16 v61, v86, v30, v61
    v_dot2_f32_bf16 v61, v87, v31, v61
    s_mov_b32 s68, 409600
    buffer_load_dwordx4 v[180:183], v4, s[32:35], s68 offen offset:1024 nt
    v_add_f32_dpp v62, v60, v60 row_ror:8 row_mask:0xf bank_mask:0x3
    s_nop 1
    v_add_f32_dpp v62, v61, v61 row_ror:8 row_mask:0xf bank_mask:0xc
    s_waitcnt vmcnt(23)
    v_dot2_f32_bf16 v60, v88, v28, 0
    v_dot2_f32_bf16 v60, v89, v29, v60
    v_dot2_f32_bf16 v60, v90, v30, v60
    v_dot2_f32_bf16 v60, v91, v31, v60
    s_waitcnt vmcnt(22)
    v_dot2_f32_bf16 v61, v92, v28, 0
    v_dot2_f32_bf16 v61, v93, v29, v61
    v_dot2_f32_bf16 v61, v94, v30, v61
    v_dot2_f32_bf16 v61, v95, v31, v61
    v_add_f32_dpp v60, v60, v60 row_ror:8 row_mask:0xf bank_mask:0x3
    s_nop 1
    v_add_f32_dpp v60, v61, v61 row_ror:8 row_mask:0xf bank_mask:0xc
    v_add_f32_dpp v62, v62, v62 row_ror:12 row_mask:0xf bank_mask:0x5
    s_nop 1
    v_add_f32_dpp v62, v60, v60 row_ror:4 row_mask:0xf bank_mask:0xa
    v_add_f32_dpp v60, v63, v63 quad_perm:[2,3,0,1] row_mask:0xf bank_mask:0xf
    s_nop 0
    v_add_f32_dpp v61, v62, v62 quad_perm:[2,3,0,1] row_mask:0xf bank_mask:0xf
    v_cndmask_b32 v63, v60, v61, s[80:81]
    v_add_f32_dpp v60, v64, v64 quad_perm:[1,0,3,2] row_mask:0xf bank_mask:0xf
    s_nop 0
    v_add_f32_dpp v61, v63, v63 quad_perm:[1,0,3,2] row_mask:0xf bank_mask:0xf
    v_cndmask_b32 v36, v60, v61, s[82:83]
    v_cvt_pk_bf16_f32 v36, 0, v36
    v_mul_f32 v36, 0x3db504f3, v36
    v_cvt_pk_bf16_f32 v36, 0, v36
    s_waitcnt vmcnt(21)
    v_dot2_f32_bf16 v60, v96, v28, 0
    v_dot2_f32_bf16 v60, v97, v29, v60
    v_dot2_f32_bf16 v60, v98, v30, v60
    v_dot2_f32_bf16 v60, v99, v31, v60
    s_mov_b32 s68, 409600
    buffer_load_dwordx4 v[184:187], v4, s[32:35], s68 offen offset:2048 nt
    v_lshlrev_b32 v71, 16, v40
    v_and_b32 v72, 0xffff0000, v40
    v_sub_f32 v71, v71, v76
    v_cvt_pk_bf16_f32 v71, 0, v71
    v_mul_f32 v73, v71, v78
    v_fma_f32 v71, -v73, v77, v71
    v_fma_f32 v71, v71, v78, v73
    v_sub_f32 v72, v72, v76
    v_cvt_pk_bf16_f32 v72, 0, v72
    v_mul_f32 v74, v72, v78
    v_fma_f32 v72, -v74, v77, v72
    v_fma_f32 v72, v72, v78, v74
    v_cvt_pk_bf16_f32 v40, v71, v72
    v_lshlrev_b32 v71, 16, v41
    v_and_b32 v72, 0xffff0000, v41
    v_sub_f32 v71, v71, v76
    v_cvt_pk_bf16_f32 v71, 0, v71
    v_mul_f32 v73, v71, v78
    v_fma_f32 v71, -v73, v77, v71
    v_fma_f32 v71, v71, v78, v73
    v_sub_f32 v72, v72, v76
    v_cvt_pk_bf16_f32 v72, 0, v72
    v_mul_f32 v74, v72, v78
    v_fma_f32 v72, -v74, v77, v72
    v_fma_f32 v72, v72, v78, v74
    v_cvt_pk_bf16_f32 v41, v71, v72
    v_lshlrev_b32 v71, 16, v42
    v_and_b32 v72, 0xffff0000, v42
    v_sub_f32 v71, v71, v76
    v_cvt_pk_bf16_f32 v71, 0, v71
    v_mul_f32 v73, v71, v78
    v_fma_f32 v71, -v73, v77, v71
    v_fma_f32 v71, v71, v78, v73
    v_sub_f32 v72, v72, v76
    v_cvt_pk_bf16_f32 v72, 0, v72
    v_mul_f32 v74, v72, v78
    v_fma_f32 v72, -v74, v77, v72
    v_fma_f32 v72, v72, v78, v74
    v_cvt_pk_bf16_f32 v42, v71, v72
    v_lshlrev_b32 v71, 16, v43
    v_and_b32 v72, 0xffff0000, v43
    v_sub_f32 v71, v71, v76
    v_cvt_pk_bf16_f32 v71, 0, v71
    v_mul_f32 v73, v71, v78
    v_fma_f32 v71, -v73, v77, v71
    v_fma_f32 v71, v71, v78, v73
    v_sub_f32 v72, v72, v76
    v_cvt_pk_bf16_f32 v72, 0, v72
    v_mul_f32 v74, v72, v78
    v_fma_f32 v72, -v74, v77, v72
    v_fma_f32 v72, v72, v78, v74
    v_cvt_pk_bf16_f32 v43, v71, v72
    v_lshlrev_b32 v71, 16, v44
    v_and_b32 v72, 0xffff0000, v44
    v_sub_f32 v71, v71, v76
    v_cvt_pk_bf16_f32 v71, 0, v71
    v_mul_f32 v73, v71, v78
    v_fma_f32 v71, -v73, v77, v71
    v_fma_f32 v71, v71, v78, v73
    v_sub_f32 v72, v72, v76
    v_cvt_pk_bf16_f32 v72, 0, v72
    v_mul_f32 v74, v72, v78
    v_fma_f32 v72, -v74, v77, v72
    v_fma_f32 v72, v72, v78, v74
    v_cvt_pk_bf16_f32 v44, v71, v72
    v_lshlrev_b32 v71, 16, v45
    v_and_b32 v72, 0xffff0000, v45
    v_sub_f32 v71, v71, v76
    v_cvt_pk_bf16_f32 v71, 0, v71
    v_mul_f32 v73, v71, v78
    v_fma_f32 v71, -v73, v77, v71
    v_fma_f32 v71, v71, v78, v73
    v_sub_f32 v72, v72, v76
    v_cvt_pk_bf16_f32 v72, 0, v72
    v_mul_f32 v74, v72, v78
    v_fma_f32 v72, -v74, v77, v72
    v_fma_f32 v72, v72, v78, v74
    v_cvt_pk_bf16_f32 v45, v71, v72
    v_lshlrev_b32 v71, 16, v46
    v_and_b32 v72, 0xffff0000, v46
    v_sub_f32 v71, v71, v76
    v_cvt_pk_bf16_f32 v71, 0, v71
    v_mul_f32 v73, v71, v78
    v_fma_f32 v71, -v73, v77, v71
    v_fma_f32 v71, v71, v78, v73
    v_sub_f32 v72, v72, v76
    v_cvt_pk_bf16_f32 v72, 0, v72
    v_mul_f32 v74, v72, v78
    v_fma_f32 v72, -v74, v77, v72
    v_fma_f32 v72, v72, v78, v74
    v_cvt_pk_bf16_f32 v46, v71, v72
    v_lshlrev_b32 v71, 16, v47
    v_and_b32 v72, 0xffff0000, v47
    v_sub_f32 v71, v71, v76
    v_cvt_pk_bf16_f32 v71, 0, v71
    v_mul_f32 v73, v71, v78
    v_fma_f32 v71, -v73, v77, v71
    v_fma_f32 v71, v71, v78, v73
    v_sub_f32 v72, v72, v76
    v_cvt_pk_bf16_f32 v72, 0, v72
    v_mul_f32 v74, v72, v78
    v_fma_f32 v72, -v74, v77, v72
    v_fma_f32 v72, v72, v78, v74
    v_cvt_pk_bf16_f32 v47, v71, v72
    v_mov_b32 v75, 0
    v_mov_b32 v73, 0
    v_lshlrev_b32 v71, 16, v40
    v_and_b32 v72, 0xffff0000, v40
    v_add_f32 v75, v75, v71
    v_add_f32 v73, v73, v72
    v_lshlrev_b32 v71, 16, v41
    v_and_b32 v72, 0xffff0000, v41
    v_add_f32 v75, v75, v71
    v_add_f32 v73, v73, v72
    v_lshlrev_b32 v71, 16, v42
    v_and_b32 v72, 0xffff0000, v42
    v_add_f32 v75, v75, v71
    v_add_f32 v73, v73, v72
    v_lshlrev_b32 v71, 16, v43
    v_and_b32 v72, 0xffff0000, v43
    v_add_f32 v75, v75, v71
    v_add_f32 v73, v73, v72
    v_lshlrev_b32 v71, 16, v44
    v_and_b32 v72, 0xffff0000, v44
    v_add_f32 v75, v75, v71
    v_add_f32 v73, v73, v72
    v_lshlrev_b32 v71, 16, v45
    v_and_b32 v72, 0xffff0000, v45
    v_add_f32 v75, v75, v71
    v_add_f32 v73, v73, v72
    v_lshlrev_b32 v71, 16, v46
    v_and_b32 v72, 0xffff0000, v46
    v_add_f32 v75, v75, v71
    v_add_f32 v73, v73, v72
    v_lshlrev_b32 v71, 16, v47
    v_and_b32 v72, 0xffff0000, v47
    v_add_f32 v75, v75, v71
    v_add_f32 v73, v73, v72
    v_add_f32 v75, v75, v73
    s_nop 1
    v_add_f32_dpp v75, v75, v75 row_ror:8 row_mask:0xf bank_mask:0xf
    s_nop 1
    v_add_f32_dpp v75, v75, v75 row_ror:4 row_mask:0xf bank_mask:0xf
    s_nop 1
    v_add_f32_dpp v75, v75, v75 row_ror:2 row_mask:0xf bank_mask:0xf
    s_nop 1
    v_add_f32_dpp v75, v75, v75 row_ror:1 row_mask:0xf bank_mask:0xf
    s_nop 0
    v_readlane_b32 s84, v75, 0
    v_readlane_b32 s85, v75, 16
    v_readlane_b32 s86, v75, 32
    v_readlane_b32 s87, v75, 48
    v_mov_b32 v75, s84
    v_add_f32 v75, s85, v75
    v_add_f32 v75, s86, v75
    v_add_f32 v75, s87, v75
    v_mul_f32 v76, 0x3a800000, v75
    v_mov_b32 v75, 0
    v_mov_b32 v73, 0
    v_lshlrev_b32 v71, 16, v40
    v_and_b32 v72, 0xffff0000, v40
    v_sub_f32 v71, v71, v76
    v_sub_f32 v72, v72, v76
    v_fmac_f32 v75, v71, v71
    v_fmac_f32 v73, v72, v72
    v_lshlrev_b32 v71, 16, v41
    v_and_b32 v72, 0xffff0000, v41
    v_sub_f32 v71, v71, v76
    v_sub_f32 v72, v72, v76
    v_fmac_f32 v75, v71, v71
    v_fmac_f32 v73, v72, v72
    v_lshlrev_b32 v71, 16, v42
    v_and_b32 v72, 0xffff0000, v42
    v_sub_f32 v71, v71, v76
    v_sub_f32 v72, v72, v76
    v_fmac_f32 v75, v71, v71
    v_fmac_f32 v73, v72, v72
    v_lshlrev_b32 v71, 16, v43
    v_and_b32 v72, 0xffff0000, v43
    v_sub_f32 v71, v71, v76
    v_sub_f32 v72, v72, v76
    v_fmac_f32 v75, v71, v71
    v_fmac_f32 v73, v72, v72
    v_lshlrev_b32 v71, 16, v44
    v_and_b32 v72, 0xffff0000, v44
    v_sub_f32 v71, v71, v76
    v_sub_f32 v72, v72, v76
    v_fmac_f32 v75, v71, v71
    v_fmac_f32 v73, v72, v72
    v_lshlrev_b32 v71, 16, v45
    v_and_b32 v72, 0xffff0000, v45
    v_sub_f32 v71, v71, v76
    v_sub_f32 v72, v72, v76
    v_fmac_f32 v75, v71, v71
    v_fmac_f32 v73, v72, v72
    v_lshlrev_b32 v71, 16, v46
    v_and_b32 v72, 0xffff0000, v46
    v_sub_f32 v71, v71, v76
    v_sub_f32 v72, v72, v76
    v_fmac_f32 v75, v71, v71
    v_fmac_f32 v73, v72, v72
    v_lshlrev_b32 v71, 16, v47
    v_and_b32 v72, 0xffff0000, v47
    v_sub_f32 v71, v71, v76
    v_sub_f32 v72, v72, v76
    v_fmac_f32 v75, v71, v71
    v_fmac_f32 v73, v72, v72
    v_add_f32 v75, v75, v73
    s_nop 1
    v_add_f32_dpp v75, v75, v75 row_ror:8 row_mask:0xf bank_mask:0xf
    s_nop 1
    v_add_f32_dpp v75, v75, v75 row_ror:4 row_mask:0xf bank_mask:0xf
    s_nop 1
    v_add_f32_dpp v75, v75, v75 row_ror:2 row_mask:0xf bank_mask:0xf
    s_nop 1
    v_add_f32_dpp v75, v75, v75 row_ror:1 row_mask:0xf bank_mask:0xf
    s_nop 0
    v_readlane_b32 s84, v75, 0
    v_readlane_b32 s85, v75, 16
    v_readlane_b32 s86, v75, 32
    v_readlane_b32 s87, v75, 48
    v_mov_b32 v75, s84
    v_add_f32 v75, s85, v75
    v_add_f32 v75, s86, v75
    v_add_f32 v75, s87, v75
    v_mul_f32 v75, 0x3a800000, v75
    v_cvt_pk_bf16_f32 v76, 0, v76
    v_cvt_pk_bf16_f32 v75, 0, v75
    v_add_f32 v75, 0x3727c5ac, v75
    v_cvt_pk_bf16_f32 v75, 0, v75
    v_sqrt_f32 v77, v75
    s_nop 0
    v_cvt_pk_bf16_f32 v77, 0, v77
    v_rcp_f32 v78, v77
    v_and_b32 v52, 0xffff0000, v48
    v_sub_f32 v52, v52, v76
    v_cvt_pk_bf16_f32 v52, 0, v52
    v_mul_f32 v71, v52, v78
    v_fma_f32 v52, -v71, v77, v52
    v_fma_f32 v52, v52, v78, v71
    v_cvt_pk_bf16_f32 v52, v52, v52
    v_and_b32 v53, 0xffff0000, v49
    v_sub_f32 v53, v53, v76
    v_cvt_pk_bf16_f32 v53, 0, v53
    v_mul_f32 v71, v53, v78
    v_fma_f32 v53, -v71, v77, v53
    v_fma_f32 v53, v53, v78, v71
    v_cvt_pk_bf16_f32 v53, v53, v53
    v_and_b32 v54, 0xffff0000, v50
    v_sub_f32 v54, v54, v76
    v_cvt_pk_bf16_f32 v54, 0, v54
    v_mul_f32 v71, v54, v78
    v_fma_f32 v54, -v71, v77, v54
    v_fma_f32 v54, v54, v78, v71
    v_cvt_pk_bf16_f32 v54, v54, v54
    v_and_b32 v55, 0xffff0000, v51
    v_sub_f32 v55, v55, v76
    v_cvt_pk_bf16_f32 v55, 0, v55
    v_mul_f32 v71, v55, v78
    v_fma_f32 v55, -v71, v77, v55
    v_fma_f32 v55, v55, v78, v71
    v_cvt_pk_bf16_f32 v55, v55, v55
    s_mov_b32 s68, 0
    buffer_load_dwordx4 a[0:3], v6, s[44:47], s68 offen
    s_waitcnt vmcnt(22)
    v_dot2_f32_bf16 v61, v100, v28, 0
    v_dot2_f32_bf16 v61, v101, v29, v61
    v_dot2_f32_bf16 v61, v102, v30, v61
    v_dot2_f32_bf16 v61, v103, v31, v61
    v_add_f32_dpp v62, v60, v60 row_ror:8 row_mask:0xf bank_mask:0x3
    s_nop 1
    v_add_f32_dpp v62, v61, v61 row_ror:8 row_mask:0xf bank_mask:0xc
    s_waitcnt vmcnt(21)
    v_dot2_f32_bf16 v60, v104, v28, 0
    v_dot2_f32_bf16 v60, v105, v29, v60
    v_dot2_f32_bf16 v60, v106, v30, v60
    v_dot2_f32_bf16 v60, v107, v31, v60
    s_mov_b32 s68, 28672
    buffer_load_dwordx4 a[4:7], v6, s[44:47], s68 offen
    s_waitcnt vmcnt(21)
    v_dot2_f32_bf16 v61, v108, v28, 0
    v_dot2_f32_bf16 v61, v109, v29, v61
    v_dot2_f32_bf16 v61, v110, v30, v61
    v_dot2_f32_bf16 v61, v111, v31, v61
    s_mov_b32 s68, 409600
    buffer_load_dwordx4 v[188:191], v4, s[32:35], s68 offen offset:3072 nt
    v_add_f32_dpp v60, v60, v60 row_ror:8 row_mask:0xf bank_mask:0x3
    s_nop 1
    v_add_f32_dpp v60, v61, v61 row_ror:8 row_mask:0xf bank_mask:0xc
    v_add_f32_dpp v63, v62, v62 row_ror:12 row_mask:0xf bank_mask:0x5
    s_nop 1
    v_add_f32_dpp v63, v60, v60 row_ror:4 row_mask:0xf bank_mask:0xa
    s_waitcnt vmcnt(21)
    v_dot2_f32_bf16 v60, v112, v28, 0
    v_dot2_f32_bf16 v60, v113, v29, v60
    v_dot2_f32_bf16 v60, v114, v30, v60
    v_dot2_f32_bf16 v60, v115, v31, v60
    s_mov_b32 s68, 57344
    buffer_load_dwordx4 a[8:11], v6, s[44:47], s68 offen
    s_waitcnt vmcnt(21)
    v_dot2_f32_bf16 v61, v116, v28, 0
    v_dot2_f32_bf16 v61, v117, v29, v61
    v_dot2_f32_bf16 v61, v118, v30, v61
    v_dot2_f32_bf16 v61, v119, v31, v61
    v_add_f32_dpp v62, v60, v60 row_ror:8 row_mask:0xf bank_mask:0x3
    s_nop 1
    v_add_f32_dpp v62, v61, v61 row_ror:8 row_mask:0xf bank_mask:0xc
    s_waitcnt vmcnt(20)
    v_dot2_f32_bf16 v60, v120, v28, 0
    v_dot2_f32_bf16 v60, v121, v29, v60
    v_dot2_f32_bf16 v60, v122, v30, v60
    v_dot2_f32_bf16 v60, v123, v31, v60
    s_mov_b32 s68, 425984
    buffer_load_dwordx4 v[192:195], v4, s[32:35], s68 offen nt
    s_mov_b32 s68, 86016
    buffer_load_dwordx4 a[12:15], v6, s[44:47], s68 offen
    s_waitcnt vmcnt(21)
    v_dot2_f32_bf16 v61, v124, v28, 0
    v_dot2_f32_bf16 v61, v125, v29, v61
    v_dot2_f32_bf16 v61, v126, v30, v61
    v_dot2_f32_bf16 v61, v127, v31, v61
    v_add_f32_dpp v60, v60, v60 row_ror:8 row_mask:0xf bank_mask:0x3
    s_nop 1
    v_add_f32_dpp v60, v61, v61 row_ror:8 row_mask:0xf bank_mask:0xc
    v_add_f32_dpp v62, v62, v62 row_ror:12 row_mask:0xf bank_mask:0x5
    s_nop 1
    v_add_f32_dpp v62, v60, v60 row_ror:4 row_mask:0xf bank_mask:0xa
    v_add_f32_dpp v60, v63, v63 quad_perm:[2,3,0,1] row_mask:0xf bank_mask:0xf
    s_nop 0
    v_add_f32_dpp v61, v62, v62 quad_perm:[2,3,0,1] row_mask:0xf bank_mask:0xf
    v_cndmask_b32 v64, v60, v61, s[80:81]
    s_waitcnt vmcnt(20)
    v_dot2_f32_bf16 v60, v128, v28, 0
    v_dot2_f32_bf16 v60, v129, v29, v60
    v_dot2_f32_bf16 v60, v130, v30, v60
    v_dot2_f32_bf16 v60, v131, v31, v60
    s_mov_b32 s68, 114688
    buffer_load_dwordx4 a[16:19], v6, s[44:47], s68 offen
    s_waitcnt vmcnt(20)
    v_dot2_f32_bf16 v61, v132, v28, 0
    v_dot2_f32_bf16 v61, v133, v29, v61
    v_dot2_f32_bf16 v61, v134, v30, v61
    v_dot2_f32_bf16 v61, v135, v31, v61
    s_mov_b32 s68, 425984
    buffer_load_dwordx4 v[196:199], v4, s[32:35], s68 offen offset:1024 nt
    v_add_f32_dpp v62, v60, v60 row_ror:8 row_mask:0xf bank_mask:0x3
    s_nop 1
    v_add_f32_dpp v62, v61, v61 row_ror:8 row_mask:0xf bank_mask:0xc
    s_waitcnt vmcnt(7)
    v_and_b32_dpp v12, v52, v8 row_newbcast:0 row_mask:0xf bank_mask:0xf
    v_and_b32_dpp v13, v52, v9 row_newbcast:0 row_mask:0xf bank_mask:0xf
    v_and_b32_dpp v14, v52, v10 row_newbcast:0 row_mask:0xf bank_mask:0xf
    v_and_b32_dpp v15, v52, v11 row_newbcast:0 row_mask:0xf bank_mask:0xf
    s_nop 1
    v_mfma_f32_16x16x32_bf16 v[24:27], v[12:15], a[0:3], 0
    v_dot2_f32_bf16 v60, v136, v28, 0
    v_dot2_f32_bf16 v60, v137, v29, v60
    v_dot2_f32_bf16 v60, v138, v30, v60
    v_dot2_f32_bf16 v60, v139, v31, v60
    s_mov_b32 s68, 143360
    buffer_load_dwordx4 a[20:23], v6, s[44:47], s68 offen
    v_dot2_f32_bf16 v61, v140, v28, 0
    v_dot2_f32_bf16 v61, v141, v29, v61
    v_dot2_f32_bf16 v61, v142, v30, v61
    v_dot2_f32_bf16 v61, v143, v31, v61
    v_add_f32_dpp v60, v60, v60 row_ror:8 row_mask:0xf bank_mask:0x3
    s_nop 1
    v_add_f32_dpp v60, v61, v61 row_ror:8 row_mask:0xf bank_mask:0xc
    v_add_f32_dpp v63, v62, v62 row_ror:12 row_mask:0xf bank_mask:0x5
    s_nop 1
    v_add_f32_dpp v63, v60, v60 row_ror:4 row_mask:0xf bank_mask:0xa
    s_waitcnt vmcnt(7)
    v_and_b32_dpp v16, v52, v8 row_newbcast:1 row_mask:0xf bank_mask:0xf
    v_and_b32_dpp v17, v52, v9 row_newbcast:1 row_mask:0xf bank_mask:0xf
    v_and_b32_dpp v18, v52, v10 row_newbcast:1 row_mask:0xf bank_mask:0xf
    v_and_b32_dpp v19, v52, v11 row_newbcast:1 row_mask:0xf bank_mask:0xf
    s_nop 1
    v_mfma_f32_16x16x32_bf16 v[24:27], v[16:19], a[4:7], v[24:27]
    v_dot2_f32_bf16 v60, v144, v28, 0
    v_dot2_f32_bf16 v60, v145, v29, v60
    v_dot2_f32_bf16 v60, v146, v30, v60
    v_dot2_f32_bf16 v60, v147, v31, v60
    s_mov_b32 s68, 425984
    buffer_load_dwordx4 v[200:203], v4, s[32:35], s68 offen offset:2048 nt
    s_mov_b32 s68, 172032
    buffer_load_dwordx4 a[24:27], v6, s[44:47], s68 offen
    v_dot2_f32_bf16 v61, v148, v28, 0
    v_dot2_f32_bf16 v61, v149, v29, v61
    v_dot2_f32_bf16 v61, v150, v30, v61
    v_dot2_f32_bf16 v61, v151, v31, v61
    v_add_f32_dpp v62, v60, v60 row_ror:8 row_mask:0xf bank_mask:0x3
    s_nop 1
    v_add_f32_dpp v62, v61, v61 row_ror:8 row_mask:0xf bank_mask:0xc
    s_waitcnt vmcnt(7)
    v_and_b32_dpp v12, v52, v8 row_newbcast:2 row_mask:0xf bank_mask:0xf
    v_and_b32_dpp v13, v52, v9 row_newbcast:2 row_mask:0xf bank_mask:0xf
    v_and_b32_dpp v14, v52, v10 row_newbcast:2 row_mask:0xf bank_mask:0xf
    v_and_b32_dpp v15, v52, v11 row_newbcast:2 row_mask:0xf bank_mask:0xf
    s_nop 1
    v_mfma_f32_16x16x32_bf16 v[24:27], v[12:15], a[8:11], v[24:27]
    v_dot2_f32_bf16 v60, v152, v28, 0
    v_dot2_f32_bf16 v60, v153, v29, v60
    v_dot2_f32_bf16 v60, v154, v30, v60
    v_dot2_f32_bf16 v60, v155, v31, v60
    s_mov_b32 s68, 200704
    buffer_load_dwordx4 a[28:31], v6, s[44:47], s68 offen
    v_dot2_f32_bf16 v61, v156, v28, 0
    v_dot2_f32_bf16 v61, v157, v29, v61
    v_dot2_f32_bf16 v61, v158, v30, v61
    v_dot2_f32_bf16 v61, v159, v31, v61
    s_mov_b32 s68, 425984
    buffer_load_dwordx4 v[204:207], v4, s[32:35], s68 offen offset:3072 nt
    v_add_f32_dpp v60, v60, v60 row_ror:8 row_mask:0xf bank_mask:0x3
    s_nop 1
    v_add_f32_dpp v60, v61, v61 row_ror:8 row_mask:0xf bank_mask:0xc
    v_add_f32_dpp v62, v62, v62 row_ror:12 row_mask:0xf bank_mask:0x5
    s_nop 1
    v_add_f32_dpp v62, v60, v60 row_ror:4 row_mask:0xf bank_mask:0xa
    v_add_f32_dpp v60, v63, v63 quad_perm:[2,3,0,1] row_mask:0xf bank_mask:0xf
    s_nop 0
    v_add_f32_dpp v61, v62, v62 quad_perm:[2,3,0,1] row_mask:0xf bank_mask:0xf
    v_cndmask_b32 v63, v60, v61, s[80:81]
    v_add_f32_dpp v60, v64, v64 quad_perm:[1,0,3,2] row_mask:0xf bank_mask:0xf
    s_nop 0
    v_add_f32_dpp v61, v63, v63 quad_perm:[1,0,3,2] row_mask:0xf bank_mask:0xf
    v_cndmask_b32 v37, v60, v61, s[82:83]
    v_cvt_pk_bf16_f32 v37, 0, v37
    v_mul_f32 v37, 0x3db504f3, v37
    v_cvt_pk_bf16_f32 v37, 0, v37
    s_waitcnt vmcnt(7)
    v_and_b32_dpp v16, v52, v8 row_newbcast:3 row_mask:0xf bank_mask:0xf
    v_and_b32_dpp v17, v52, v9 row_newbcast:3 row_mask:0xf bank_mask:0xf
    v_and_b32_dpp v18, v52, v10 row_newbcast:3 row_mask:0xf bank_mask:0xf
    v_and_b32_dpp v19, v52, v11 row_newbcast:3 row_mask:0xf bank_mask:0xf
    s_nop 1
    v_mfma_f32_16x16x32_bf16 v[24:27], v[16:19], a[12:15], v[24:27]
    v_dot2_f32_bf16 v60, v160, v28, 0
    v_dot2_f32_bf16 v60, v161, v29, v60
    v_dot2_f32_bf16 v60, v162, v30, v60
    v_dot2_f32_bf16 v60, v163, v31, v60
    s_mov_b32 s68, 229376
    buffer_load_dwordx4 a[32:35], v6, s[44:47], s68 offen
    v_dot2_f32_bf16 v61, v164, v28, 0
    v_dot2_f32_bf16 v61, v165, v29, v61
    v_dot2_f32_bf16 v61, v166, v30, v61
    v_dot2_f32_bf16 v61, v167, v31, v61
    v_add_f32_dpp v62, v60, v60 row_ror:8 row_mask:0xf bank_mask:0x3
    s_nop 1
    v_add_f32_dpp v62, v61, v61 row_ror:8 row_mask:0xf bank_mask:0xc
    s_waitcnt vmcnt(7)
    v_and_b32_dpp v12, v52, v8 row_newbcast:4 row_mask:0xf bank_mask:0xf
    v_and_b32_dpp v13, v52, v9 row_newbcast:4 row_mask:0xf bank_mask:0xf
    v_and_b32_dpp v14, v52, v10 row_newbcast:4 row_mask:0xf bank_mask:0xf
    v_and_b32_dpp v15, v52, v11 row_newbcast:4 row_mask:0xf bank_mask:0xf
    s_nop 1
    v_mfma_f32_16x16x32_bf16 v[24:27], v[12:15], a[16:19], v[24:27]
    v_dot2_f32_bf16 v60, v168, v28, 0
    v_dot2_f32_bf16 v60, v169, v29, v60
    v_dot2_f32_bf16 v60, v170, v30, v60
    v_dot2_f32_bf16 v60, v171, v31, v60
    s_mov_b32 s68, 442368
    buffer_load_dwordx4 v[208:211], v4, s[32:35], s68 offen nt
    s_mov_b32 s68, 258048
    buffer_load_dwordx4 a[36:39], v6, s[44:47], s68 offen
    v_dot2_f32_bf16 v61, v172, v28, 0
    v_dot2_f32_bf16 v61, v173, v29, v61
    v_dot2_f32_bf16 v61, v174, v30, v61
    v_dot2_f32_bf16 v61, v175, v31, v61
    v_add_f32_dpp v60, v60, v60 row_ror:8 row_mask:0xf bank_mask:0x3
    s_nop 1
    v_add_f32_dpp v60, v61, v61 row_ror:8 row_mask:0xf bank_mask:0xc
    v_add_f32_dpp v63, v62, v62 row_ror:12 row_mask:0xf bank_mask:0x5
    s_nop 1
    v_add_f32_dpp v63, v60, v60 row_ror:4 row_mask:0xf bank_mask:0xa
    s_waitcnt vmcnt(7)
    v_and_b32_dpp v16, v52, v8 row_newbcast:5 row_mask:0xf bank_mask:0xf
    v_and_b32_dpp v17, v52, v9 row_newbcast:5 row_mask:0xf bank_mask:0xf
    v_and_b32_dpp v18, v52, v10 row_newbcast:5 row_mask:0xf bank_mask:0xf
    v_and_b32_dpp v19, v52, v11 row_newbcast:5 row_mask:0xf bank_mask:0xf
    s_nop 1
    v_mfma_f32_16x16x32_bf16 v[24:27], v[16:19], a[20:23], v[24:27]
    v_dot2_f32_bf16 v60, v176, v28, 0
    v_dot2_f32_bf16 v60, v177, v29, v60
    v_dot2_f32_bf16 v60, v178, v30, v60
    v_dot2_f32_bf16 v60, v179, v31, v60
    s_mov_b32 s68, 286720
    buffer_load_dwordx4 a[40:43], v6, s[44:47], s68 offen
    v_dot2_f32_bf16 v61, v180, v28, 0
    v_dot2_f32_bf16 v61, v181, v29, v61
    v_dot2_f32_bf16 v61, v182, v30, v61
    v_dot2_f32_bf16 v61, v183, v31, v61
    s_mov_b32 s68, 442368
    buffer_load_dwordx4 v[212:215], v4, s[32:35], s68 offen offset:1024 nt
    v_add_f32_dpp v62, v60, v60 row_ror:8 row_mask:0xf bank_mask:0x3
    s_nop 1
    v_add_f32_dpp v62, v61, v61 row_ror:8 row_mask:0xf bank_mask:0xc
    s_waitcnt vmcnt(7)
    v_and_b32_dpp v12, v52, v8 row_newbcast:6 row_mask:0xf bank_mask:0xf
    v_and_b32_dpp v13, v52, v9 row_newbcast:6 row_mask:0xf bank_mask:0xf
    v_and_b32_dpp v14, v52, v10 row_newbcast:6 row_mask:0xf bank_mask:0xf
    v_and_b32_dpp v15, v52, v11 row_newbcast:6 row_mask:0xf bank_mask:0xf
    s_nop 1
    v_mfma_f32_16x16x32_bf16 v[24:27], v[12:15], a[24:27], v[24:27]
    v_dot2_f32_bf16 v60, v184, v28, 0
    v_dot2_f32_bf16 v60, v185, v29, v60
    v_dot2_f32_bf16 v60, v186, v30, v60
    v_dot2_f32_bf16 v60, v187, v31, v60
    s_mov_b32 s68, 315392
    buffer_load_dwordx4 a[44:47], v6, s[44:47], s68 offen
    v_dot2_f32_bf16 v61, v188, v28, 0
    v_dot2_f32_bf16 v61, v189, v29, v61
    v_dot2_f32_bf16 v61, v190, v30, v61
    v_dot2_f32_bf16 v61, v191, v31, v61
    v_add_f32_dpp v60, v60, v60 row_ror:8 row_mask:0xf bank_mask:0x3
    s_nop 1
    v_add_f32_dpp v60, v61, v61 row_ror:8 row_mask:0xf bank_mask:0xc
    v_add_f32_dpp v62, v62, v62 row_ror:12 row_mask:0xf bank_mask:0x5
    s_nop 1
    v_add_f32_dpp v62, v60, v60 row_ror:4 row_mask:0xf bank_mask:0xa
    v_add_f32_dpp v60, v63, v63 quad_perm:[2,3,0,1] row_mask:0xf bank_mask:0xf
    s_nop 0
    v_add_f32_dpp v61, v62, v62 quad_perm:[2,3,0,1] row_mask:0xf bank_mask:0xf
    v_cndmask_b32 v64, v60, v61, s[80:81]
    s_waitcnt vmcnt(7)
    v_and_b32_dpp v16, v52, v8 row_newbcast:7 row_mask:0xf bank_mask:0xf
    v_and_b32_dpp v17, v52, v9 row_newbcast:7 row_mask:0xf bank_mask:0xf
    v_and_b32_dpp v18, v52, v10 row_newbcast:7 row_mask:0xf bank_mask:0xf
    v_and_b32_dpp v19, v52, v11 row_newbcast:7 row_mask:0xf bank_mask:0xf
    s_nop 1
    v_mfma_f32_16x16x32_bf16 v[24:27], v[16:19], a[28:31], v[24:27]
    v_dot2_f32_bf16 v60, v192, v28, 0
    v_dot2_f32_bf16 v60, v193, v29, v60
    v_dot2_f32_bf16 v60, v194, v30, v60
    v_dot2_f32_bf16 v60, v195, v31, v60
    s_mov_b32 s68, 442368
    buffer_load_dwordx4 v[216:219], v4, s[32:35], s68 offen offset:2048 nt
    s_mov_b32 s68, 344064
    buffer_load_dwordx4 a[48:51], v6, s[44:47], s68 offen
    v_dot2_f32_bf16 v61, v196, v28, 0
    v_dot2_f32_bf16 v61, v197, v29, v61
    v_dot2_f32_bf16 v61, v198, v30, v61
    v_dot2_f32_bf16 v61, v199, v31, v61
    v_add_f32_dpp v62, v60, v60 row_ror:8 row_mask:0xf bank_mask:0x3
    s_nop 1
    v_add_f32_dpp v62, v61, v61 row_ror:8 row_mask:0xf bank_mask:0xc
    s_waitcnt vmcnt(7)
    v_and_b32_dpp v12, v52, v8 row_newbcast:8 row_mask:0xf bank_mask:0xf
    v_and_b32_dpp v13, v52, v9 row_newbcast:8 row_mask:0xf bank_mask:0xf
    v_and_b32_dpp v14, v52, v10 row_newbcast:8 row_mask:0xf bank_mask:0xf
    v_and_b32_dpp v15, v52, v11 row_newbcast:8 row_mask:0xf bank_mask:0xf
    s_nop 1
    v_mfma_f32_16x16x32_bf16 v[24:27], v[12:15], a[32:35], v[24:27]
    v_dot2_f32_bf16 v60, v200, v28, 0
    v_dot2_f32_bf16 v60, v201, v29, v60
    v_dot2_f32_bf16 v60, v202, v30, v60
    v_dot2_f32_bf16 v60, v203, v31, v60
    s_mov_b32 s68, 442368
    buffer_load_dwordx4 v[220:223], v4, s[32:35], s68 offen offset:3072 nt
    s_mov_b32 s68, 372736
    buffer_load_dwordx4 a[52:55], v6, s[44:47], s68 offen
    v_dot2_f32_bf16 v61, v204, v28, 0
    v_dot2_f32_bf16 v61, v205, v29, v61
    v_dot2_f32_bf16 v61, v206, v30, v61
    v_dot2_f32_bf16 v61, v207, v31, v61
    s_mov_b32 s68, 458752
    buffer_load_dwordx4 v[224:227], v4, s[32:35], s68 offen nt
    v_add_f32_dpp v60, v60, v60 row_ror:8 row_mask:0xf bank_mask:0x3
    s_nop 1
    v_add_f32_dpp v60, v61, v61 row_ror:8 row_mask:0xf bank_mask:0xc
    v_add_f32_dpp v63, v62, v62 row_ror:12 row_mask:0xf bank_mask:0x5
    s_nop 1
    v_add_f32_dpp v63, v60, v60 row_ror:4 row_mask:0xf bank_mask:0xa
    s_waitcnt vmcnt(8)
    v_and_b32_dpp v16, v52, v8 row_newbcast:9 row_mask:0xf bank_mask:0xf
    v_and_b32_dpp v17, v52, v9 row_newbcast:9 row_mask:0xf bank_mask:0xf
    v_and_b32_dpp v18, v52, v10 row_newbcast:9 row_mask:0xf bank_mask:0xf
    v_and_b32_dpp v19, v52, v11 row_newbcast:9 row_mask:0xf bank_mask:0xf
    s_nop 1
    v_mfma_f32_16x16x32_bf16 v[24:27], v[16:19], a[36:39], v[24:27]
    v_dot2_f32_bf16 v60, v208, v28, 0
    v_dot2_f32_bf16 v60, v209, v29, v60
    v_dot2_f32_bf16 v60, v210, v30, v60
    v_dot2_f32_bf16 v60, v211, v31, v60
    s_mov_b32 s68, 458752
    buffer_load_dwordx4 v[228:231], v4, s[32:35], s68 offen offset:1024 nt
    s_mov_b32 s68, 401408
    buffer_load_dwordx4 a[56:59], v6, s[44:47], s68 offen
    s_waitcnt vmcnt(8)
    v_dot2_f32_bf16 v61, v212, v28, 0
    v_dot2_f32_bf16 v61, v213, v29, v61
    v_dot2_f32_bf16 v61, v214, v30, v61
    v_dot2_f32_bf16 v61, v215, v31, v61
    s_mov_b32 s68, 458752
    buffer_load_dwordx4 v[232:235], v4, s[32:35], s68 offen offset:2048 nt
    v_add_f32_dpp v62, v60, v60 row_ror:8 row_mask:0xf bank_mask:0x3
    s_nop 1
    v_add_f32_dpp v62, v61, v61 row_ror:8 row_mask:0xf bank_mask:0xc
    v_and_b32_dpp v12, v52, v8 row_newbcast:10 row_mask:0xf bank_mask:0xf
    v_and_b32_dpp v13, v52, v9 row_newbcast:10 row_mask:0xf bank_mask:0xf
    v_and_b32_dpp v14, v52, v10 row_newbcast:10 row_mask:0xf bank_mask:0xf
    v_and_b32_dpp v15, v52, v11 row_newbcast:10 row_mask:0xf bank_mask:0xf
    s_nop 1
    v_mfma_f32_16x16x32_bf16 v[24:27], v[12:15], a[40:43], v[24:27]
    s_waitcnt vmcnt(7)
    v_dot2_f32_bf16 v60, v216, v28, 0
    v_dot2_f32_bf16 v60, v217, v29, v60
    v_dot2_f32_bf16 v60, v218, v30, v60
    v_dot2_f32_bf16 v60, v219, v31, v60
    s_mov_b32 s68, 458752
    buffer_load_dwordx4 v[236:239], v4, s[32:35], s68 offen offset:3072 nt
    s_mov_b32 s68, 430080
    buffer_load_dwordx4 a[60:63], v6, s[44:47], s68 offen
    s_waitcnt vmcnt(7)
    v_dot2_f32_bf16 v61, v220, v28, 0
    v_dot2_f32_bf16 v61, v221, v29, v61
    v_dot2_f32_bf16 v61, v222, v30, v61
    v_dot2_f32_bf16 v61, v223, v31, v61
    s_mov_b32 s68, 475136
    buffer_load_dwordx4 v[80:83], v4, s[32:35], s68 offen nt
    v_add_f32_dpp v60, v60, v60 row_ror:8 row_mask:0xf bank_mask:0x3
    s_nop 1
    v_add_f32_dpp v60, v61, v61 row_ror:8 row_mask:0xf bank_mask:0xc
    v_add_f32_dpp v62, v62, v62 row_ror:12 row_mask:0xf bank_mask:0x5
    s_nop 1
    v_add_f32_dpp v62, v60, v60 row_ror:4 row_mask:0xf bank_mask:0xa
    v_add_f32_dpp v60, v63, v63 quad_perm:[2,3,0,1] row_mask:0xf bank_mask:0xf
    s_nop 0
    v_add_f32_dpp v61, v62, v62 quad_perm:[2,3,0,1] row_mask:0xf bank_mask:0xf
    v_cndmask_b32 v63, v60, v61, s[80:81]
    v_add_f32_dpp v60, v64, v64 quad_perm:[1,0,3,2] row_mask:0xf bank_mask:0xf
    s_nop 0
    v_add_f32_dpp v61, v63, v63 quad_perm:[1,0,3,2] row_mask:0xf bank_mask:0xf
    v_cndmask_b32 v38, v60, v61, s[82:83]
    v_cvt_pk_bf16_f32 v38, 0, v38
    v_mul_f32 v38, 0x3db504f3, v38
    v_cvt_pk_bf16_f32 v38, 0, v38
    v_and_b32_dpp v16, v52, v8 row_newbcast:11 row_mask:0xf bank_mask:0xf
    v_and_b32_dpp v17, v52, v9 row_newbcast:11 row_mask:0xf bank_mask:0xf
    v_and_b32_dpp v18, v52, v10 row_newbcast:11 row_mask:0xf bank_mask:0xf
    v_and_b32_dpp v19, v52, v11 row_newbcast:11 row_mask:0xf bank_mask:0xf
    s_nop 1
    v_mfma_f32_16x16x32_bf16 v[24:27], v[16:19], a[44:47], v[24:27]
    s_waitcnt vmcnt(6)
    v_dot2_f32_bf16 v60, v224, v28, 0
    v_dot2_f32_bf16 v60, v225, v29, v60
    v_dot2_f32_bf16 v60, v226, v30, v60
    v_dot2_f32_bf16 v60, v227, v31, v60
    s_mov_b32 s68, 475136
    buffer_load_dwordx4 v[84:87], v4, s[32:35], s68 offen offset:1024 nt
    s_mov_b32 s68, 458752
    buffer_load_dwordx4 a[64:67], v6, s[44:47], s68 offen
    s_waitcnt vmcnt(7)
    v_dot2_f32_bf16 v61, v228, v28, 0
    v_dot2_f32_bf16 v61, v229, v29, v61
    v_dot2_f32_bf16 v61, v230, v30, v61
    v_dot2_f32_bf16 v61, v231, v31, v61
    s_mov_b32 s68, 475136
    buffer_load_dwordx4 v[88:91], v4, s[32:35], s68 offen offset:2048 nt
    v_add_f32_dpp v62, v60, v60 row_ror:8 row_mask:0xf bank_mask:0x3
    s_nop 1
    v_add_f32_dpp v62, v61, v61 row_ror:8 row_mask:0xf bank_mask:0xc
    v_and_b32_dpp v12, v52, v8 row_newbcast:12 row_mask:0xf bank_mask:0xf
    v_and_b32_dpp v13, v52, v9 row_newbcast:12 row_mask:0xf bank_mask:0xf
    v_and_b32_dpp v14, v52, v10 row_newbcast:12 row_mask:0xf bank_mask:0xf
    v_and_b32_dpp v15, v52, v11 row_newbcast:12 row_mask:0xf bank_mask:0xf
    s_nop 1
    v_mfma_f32_16x16x32_bf16 v[24:27], v[12:15], a[48:51], v[24:27]
    s_waitcnt vmcnt(6)
    v_dot2_f32_bf16 v60, v232, v28, 0
    v_dot2_f32_bf16 v60, v233, v29, v60
    v_dot2_f32_bf16 v60, v234, v30, v60
    v_dot2_f32_bf16 v60, v235, v31, v60
    s_mov_b32 s68, 475136
    buffer_load_dwordx4 v[92:95], v4, s[32:35], s68 offen offset:3072 nt
    s_mov_b32 s68, 487424
    buffer_load_dwordx4 a[68:71], v6, s[44:47], s68 offen
    s_waitcnt vmcnt(7)
    v_dot2_f32_bf16 v61, v236, v28, 0
    v_dot2_f32_bf16 v61, v237, v29, v61
    v_dot2_f32_bf16 v61, v238, v30, v61
    v_dot2_f32_bf16 v61, v239, v31, v61
    s_mov_b32 s68, 491520
    buffer_load_dwordx4 v[96:99], v4, s[32:35], s68 offen nt
    v_add_f32_dpp v60, v60, v60 row_ror:8 row_mask:0xf bank_mask:0x3
    s_nop 1
    v_add_f32_dpp v60, v61, v61 row_ror:8 row_mask:0xf bank_mask:0xc
    v_add_f32_dpp v63, v62, v62 row_ror:12 row_mask:0xf bank_mask:0x5
    s_nop 1
    v_add_f32_dpp v63, v60, v60 row_ror:4 row_mask:0xf bank_mask:0xa
    v_and_b32_dpp v16, v52, v8 row_newbcast:13 row_mask:0xf bank_mask:0xf
    v_and_b32_dpp v17, v52, v9 row_newbcast:13 row_mask:0xf bank_mask:0xf
    v_and_b32_dpp v18, v52, v10 row_newbcast:13 row_mask:0xf bank_mask:0xf
    v_and_b32_dpp v19, v52, v11 row_newbcast:13 row_mask:0xf bank_mask:0xf
    s_nop 1
    v_mfma_f32_16x16x32_bf16 v[24:27], v[16:19], a[52:55], v[24:27]
    s_waitcnt vmcnt(6)
    v_dot2_f32_bf16 v60, v80, v28, 0
    v_dot2_f32_bf16 v60, v81, v29, v60
    v_dot2_f32_bf16 v60, v82, v30, v60
    v_dot2_f32_bf16 v60, v83, v31, v60
    s_mov_b32 s68, 491520
    buffer_load_dwordx4 v[100:103], v4, s[32:35], s68 offen offset:1024 nt
    s_mov_b32 s68, 516096
    buffer_load_dwordx4 a[72:75], v6, s[44:47], s68 offen
    s_waitcnt vmcnt(7)
    v_dot2_f32_bf16 v61, v84, v28, 0
    v_dot2_f32_bf16 v61, v85, v29, v61
    v_dot2_f32_bf16 v61, v86, v30, v61
    v_dot2_f32_bf16 v61, v87, v31, v61
    s_mov_b32 s68, 491520
    buffer_load_dwordx4 v[104:107], v4, s[32:35], s68 offen offset:2048 nt
    v_add_f32_dpp v62, v60, v60 row_ror:8 row_mask:0xf bank_mask:0x3
    s_nop 1
    v_add_f32_dpp v62, v61, v61 row_ror:8 row_mask:0xf bank_mask:0xc
    v_and_b32_dpp v12, v52, v8 row_newbcast:14 row_mask:0xf bank_mask:0xf
    v_and_b32_dpp v13, v52, v9 row_newbcast:14 row_mask:0xf bank_mask:0xf
    v_and_b32_dpp v14, v52, v10 row_newbcast:14 row_mask:0xf bank_mask:0xf
    v_and_b32_dpp v15, v52, v11 row_newbcast:14 row_mask:0xf bank_mask:0xf
    s_nop 1
    v_mfma_f32_16x16x32_bf16 v[24:27], v[12:15], a[56:59], v[24:27]
    s_waitcnt vmcnt(6)
    v_dot2_f32_bf16 v60, v88, v28, 0
    v_dot2_f32_bf16 v60, v89, v29, v60
    v_dot2_f32_bf16 v60, v90, v30, v60
    v_dot2_f32_bf16 v60, v91, v31, v60
    s_mov_b32 s68, 491520
    buffer_load_dwordx4 v[108:111], v4, s[32:35], s68 offen offset:3072 nt
    s_mov_b32 s68, 544768
    buffer_load_dwordx4 a[76:79], v6, s[44:47], s68 offen
    s_waitcnt vmcnt(7)
    v_dot2_f32_bf16 v61, v92, v28, 0
    v_dot2_f32_bf16 v61, v93, v29, v61
    v_dot2_f32_bf16 v61, v94, v30, v61
    v_dot2_f32_bf16 v61, v95, v31, v61
    s_mov_b32 s68, 507904
    buffer_load_dwordx4 v[112:115], v4, s[32:35], s68 offen nt
    v_add_f32_dpp v60, v60, v60 row_ror:8 row_mask:0xf bank_mask:0x3
    s_nop 1
    v_add_f32_dpp v60, v61, v61 row_ror:8 row_mask:0xf bank_mask:0xc
    v_add_f32_dpp v62, v62, v62 row_ror:12 row_mask:0xf bank_mask:0x5
    s_nop 1
    v_add_f32_dpp v62, v60, v60 row_ror:4 row_mask:0xf bank_mask:0xa
    v_add_f32_dpp v60, v63, v63 quad_perm:[2,3,0,1] row_mask:0xf bank_mask:0xf
    s_nop 0
    v_add_f32_dpp v61, v62, v62 quad_perm:[2,3,0,1] row_mask:0xf bank_mask:0xf
    v_cndmask_b32 v64, v60, v61, s[80:81]
    v_and_b32_dpp v16, v52, v8 row_newbcast:15 row_mask:0xf bank_mask:0xf
    v_and_b32_dpp v17, v52, v9 row_newbcast:15 row_mask:0xf bank_mask:0xf
    v_and_b32_dpp v18, v52, v10 row_newbcast:15 row_mask:0xf bank_mask:0xf
    v_and_b32_dpp v19, v52, v11 row_newbcast:15 row_mask:0xf bank_mask:0xf
    s_nop 1
    v_mfma_f32_16x16x32_bf16 v[24:27], v[16:19], a[60:63], v[24:27]
    s_waitcnt vmcnt(6)
    v_dot2_f32_bf16 v60, v96, v28, 0
    v_dot2_f32_bf16 v60, v97, v29, v60
    v_dot2_f32_bf16 v60, v98, v30, v60
    v_dot2_f32_bf16 v60, v99, v31, v60
    s_mov_b32 s68, 507904
    buffer_load_dwordx4 v[116:119], v4, s[32:35], s68 offen offset:1024 nt
    s_mov_b32 s68, 573440
    buffer_load_dwordx4 a[80:83], v6, s[44:47], s68 offen
    s_waitcnt vmcnt(7)
    v_dot2_f32_bf16 v61, v100, v28, 0
    v_dot2_f32_bf16 v61, v101, v29, v61
    v_dot2_f32_bf16 v61, v102, v30, v61
    v_dot2_f32_bf16 v61, v103, v31, v61
    s_mov_b32 s68, 507904
    buffer_load_dwordx4 v[120:123], v4, s[32:35], s68 offen offset:2048 nt
    v_add_f32_dpp v62, v60, v60 row_ror:8 row_mask:0xf bank_mask:0x3
    s_nop 1
    v_add_f32_dpp v62, v61, v61 row_ror:8 row_mask:0xf bank_mask:0xc
    v_and_b32_dpp v12, v53, v8 row_newbcast:0 row_mask:0xf bank_mask:0xf
    v_and_b32_dpp v13, v53, v9 row_newbcast:0 row_mask:0xf bank_mask:0xf
    v_and_b32_dpp v14, v53, v10 row_newbcast:0 row_mask:0xf bank_mask:0xf
    v_and_b32_dpp v15, v53, v11 row_newbcast:0 row_mask:0xf bank_mask:0xf
    s_nop 1
    v_mfma_f32_16x16x32_bf16 v[24:27], v[12:15], a[64:67], v[24:27]
    s_waitcnt vmcnt(6)
    v_dot2_f32_bf16 v60, v104, v28, 0
    v_dot2_f32_bf16 v60, v105, v29, v60
    v_dot2_f32_bf16 v60, v106, v30, v60
    v_dot2_f32_bf16 v60, v107, v31, v60
    s_mov_b32 s68, 507904
    buffer_load_dwordx4 v[124:127], v4, s[32:35], s68 offen offset:3072 nt
    s_mov_b32 s68, 602112
    buffer_load_dwordx4 a[84:87], v6, s[44:47], s68 offen
    s_waitcnt vmcnt(7)
    v_dot2_f32_bf16 v61, v108, v28, 0
    v_dot2_f32_bf16 v61, v109, v29, v61
    v_dot2_f32_bf16 v61, v110, v30, v61
    v_dot2_f32_bf16 v61, v111, v31, v61
    s_mov_b32 s68, 524288
    buffer_load_dwordx4 v[128:131], v4, s[32:35], s68 offen nt
    v_add_f32_dpp v60, v60, v60 row_ror:8 row_mask:0xf bank_mask:0x3
    s_nop 1
    v_add_f32_dpp v60, v61, v61 row_ror:8 row_mask:0xf bank_mask:0xc
    v_add_f32_dpp v63, v62, v62 row_ror:12 row_mask:0xf bank_mask:0x5
    s_nop 1
    v_add_f32_dpp v63, v60, v60 row_ror:4 row_mask:0xf bank_mask:0xa
    v_and_b32_dpp v16, v53, v8 row_newbcast:1 row_mask:0xf bank_mask:0xf
    v_and_b32_dpp v17, v53, v9 row_newbcast:1 row_mask:0xf bank_mask:0xf
    v_and_b32_dpp v18, v53, v10 row_newbcast:1 row_mask:0xf bank_mask:0xf
    v_and_b32_dpp v19, v53, v11 row_newbcast:1 row_mask:0xf bank_mask:0xf
    s_nop 1
    v_mfma_f32_16x16x32_bf16 v[24:27], v[16:19], a[68:71], v[24:27]
    s_waitcnt vmcnt(6)
    v_dot2_f32_bf16 v60, v112, v28, 0
    v_dot2_f32_bf16 v60, v113, v29, v60
    v_dot2_f32_bf16 v60, v114, v30, v60
    v_dot2_f32_bf16 v60, v115, v31, v60
    s_mov_b32 s68, 524288
    buffer_load_dwordx4 v[132:135], v4, s[32:35], s68 offen offset:1024 nt
    s_mov_b32 s68, 630784
    buffer_load_dwordx4 a[88:91], v6, s[44:47], s68 offen
    s_waitcnt vmcnt(7)
    v_dot2_f32_bf16 v61, v116, v28, 0
    v_dot2_f32_bf16 v61, v117, v29, v61
    v_dot2_f32_bf16 v61, v118, v30, v61
    v_dot2_f32_bf16 v61, v119, v31, v61
    s_mov_b32 s68, 524288
    buffer_load_dwordx4 v[136:139], v4, s[32:35], s68 offen offset:2048 nt
    v_add_f32_dpp v62, v60, v60 row_ror:8 row_mask:0xf bank_mask:0x3
    s_nop 1
    v_add_f32_dpp v62, v61, v61 row_ror:8 row_mask:0xf bank_mask:0xc
    v_and_b32_dpp v12, v53, v8 row_newbcast:2 row_mask:0xf bank_mask:0xf
    v_and_b32_dpp v13, v53, v9 row_newbcast:2 row_mask:0xf bank_mask:0xf
    v_and_b32_dpp v14, v53, v10 row_newbcast:2 row_mask:0xf bank_mask:0xf
    v_and_b32_dpp v15, v53, v11 row_newbcast:2 row_mask:0xf bank_mask:0xf
    s_nop 1
    v_mfma_f32_16x16x32_bf16 v[24:27], v[12:15], a[72:75], v[24:27]
    s_waitcnt vmcnt(6)
    v_dot2_f32_bf16 v60, v120, v28, 0
    v_dot2_f32_bf16 v60, v121, v29, v60
    v_dot2_f32_bf16 v60, v122, v30, v60
    v_dot2_f32_bf16 v60, v123, v31, v60
    s_mov_b32 s68, 524288
    buffer_load_dwordx4 v[140:143], v4, s[32:35], s68 offen offset:3072 nt
    s_mov_b32 s68, 659456
    buffer_load_dwordx4 a[92:95], v6, s[44:47], s68 offen
    s_waitcnt vmcnt(7)
    v_dot2_f32_bf16 v61, v124, v28, 0
    v_dot2_f32_bf16 v61, v125, v29, v61
    v_dot2_f32_bf16 v61, v126, v30, v61
    v_dot2_f32_bf16 v61, v127, v31, v61
    s_mov_b32 s68, 540672
    buffer_load_dwordx4 v[144:147], v4, s[32:35], s68 offen nt
    v_add_f32_dpp v60, v60, v60 row_ror:8 row_mask:0xf bank_mask:0x3
    s_nop 1
    v_add_f32_dpp v60, v61, v61 row_ror:8 row_mask:0xf bank_mask:0xc
    v_add_f32_dpp v62, v62, v62 row_ror:12 row_mask:0xf bank_mask:0x5
    s_nop 1
    v_add_f32_dpp v62, v60, v60 row_ror:4 row_mask:0xf bank_mask:0xa
    v_add_f32_dpp v60, v63, v63 quad_perm:[2,3,0,1] row_mask:0xf bank_mask:0xf
    s_nop 0
    v_add_f32_dpp v61, v62, v62 quad_perm:[2,3,0,1] row_mask:0xf bank_mask:0xf
    v_cndmask_b32 v63, v60, v61, s[80:81]
    v_add_f32_dpp v60, v64, v64 quad_perm:[1,0,3,2] row_mask:0xf bank_mask:0xf
    s_nop 0
    v_add_f32_dpp v61, v63, v63 quad_perm:[1,0,3,2] row_mask:0xf bank_mask:0xf
    v_cndmask_b32 v39, v60, v61, s[82:83]
    v_cvt_pk_bf16_f32 v39, 0, v39
    v_mul_f32 v39, 0x3db504f3, v39
    v_cvt_pk_bf16_f32 v39, 0, v39
    v_and_b32_dpp v16, v53, v8 row_newbcast:3 row_mask:0xf bank_mask:0xf
    v_and_b32_dpp v17, v53, v9 row_newbcast:3 row_mask:0xf bank_mask:0xf
    v_and_b32_dpp v18, v53, v10 row_newbcast:3 row_mask:0xf bank_mask:0xf
    v_and_b32_dpp v19, v53, v11 row_newbcast:3 row_mask:0xf bank_mask:0xf
    s_nop 1
    v_mfma_f32_16x16x32_bf16 v[24:27], v[16:19], a[76:79], v[24:27]
    s_waitcnt vmcnt(6)
    v_dot2_f32_bf16 v60, v128, v28, 0
    v_dot2_f32_bf16 v60, v129, v29, v60
    v_dot2_f32_bf16 v60, v130, v30, v60
    v_dot2_f32_bf16 v60, v131, v31, v60
    s_mov_b32 s68, 540672
    buffer_load_dwordx4 v[148:151], v4, s[32:35], s68 offen offset:1024 nt
    s_mov_b32 s68, 688128
    buffer_load_dwordx4 a[96:99], v6, s[44:47], s68 offen
    s_waitcnt vmcnt(7)
    v_dot2_f32_bf16 v61, v132, v28, 0
    v_dot2_f32_bf16 v61, v133, v29, v61
    v_dot2_f32_bf16 v61, v134, v30, v61
    v_dot2_f32_bf16 v61, v135, v31, v61
    s_mov_b32 s68, 540672
    buffer_load_dwordx4 v[152:155], v4, s[32:35], s68 offen offset:2048 nt
    v_add_f32_dpp v62, v60, v60 row_ror:8 row_mask:0xf bank_mask:0x3
    s_nop 1
    v_add_f32_dpp v62, v61, v61 row_ror:8 row_mask:0xf bank_mask:0xc
    v_and_b32_dpp v12, v53, v8 row_newbcast:4 row_mask:0xf bank_mask:0xf
    v_and_b32_dpp v13, v53, v9 row_newbcast:4 row_mask:0xf bank_mask:0xf
    v_and_b32_dpp v14, v53, v10 row_newbcast:4 row_mask:0xf bank_mask:0xf
    v_and_b32_dpp v15, v53, v11 row_newbcast:4 row_mask:0xf bank_mask:0xf
    s_nop 1
    v_mfma_f32_16x16x32_bf16 v[24:27], v[12:15], a[80:83], v[24:27]
    s_waitcnt vmcnt(6)
    v_dot2_f32_bf16 v60, v136, v28, 0
    v_dot2_f32_bf16 v60, v137, v29, v60
    v_dot2_f32_bf16 v60, v138, v30, v60
    v_dot2_f32_bf16 v60, v139, v31, v60
    s_mov_b32 s68, 540672
    buffer_load_dwordx4 v[156:159], v4, s[32:35], s68 offen offset:3072 nt
    s_mov_b32 s68, 716800
    buffer_load_dwordx4 a[100:103], v6, s[44:47], s68 offen
    s_waitcnt vmcnt(7)
    v_dot2_f32_bf16 v61, v140, v28, 0
    v_dot2_f32_bf16 v61, v141, v29, v61
    v_dot2_f32_bf16 v61, v142, v30, v61
    v_dot2_f32_bf16 v61, v143, v31, v61
    s_mov_b32 s68, 557056
    buffer_load_dwordx4 v[160:163], v4, s[32:35], s68 offen nt
    v_add_f32_dpp v60, v60, v60 row_ror:8 row_mask:0xf bank_mask:0x3
    s_nop 1
    v_add_f32_dpp v60, v61, v61 row_ror:8 row_mask:0xf bank_mask:0xc
    v_add_f32_dpp v63, v62, v62 row_ror:12 row_mask:0xf bank_mask:0x5
    s_nop 1
    v_add_f32_dpp v63, v60, v60 row_ror:4 row_mask:0xf bank_mask:0xa
    v_and_b32_dpp v16, v53, v8 row_newbcast:5 row_mask:0xf bank_mask:0xf
    v_and_b32_dpp v17, v53, v9 row_newbcast:5 row_mask:0xf bank_mask:0xf
    v_and_b32_dpp v18, v53, v10 row_newbcast:5 row_mask:0xf bank_mask:0xf
    v_and_b32_dpp v19, v53, v11 row_newbcast:5 row_mask:0xf bank_mask:0xf
    s_nop 1
    v_mfma_f32_16x16x32_bf16 v[24:27], v[16:19], a[84:87], v[24:27]
    s_waitcnt vmcnt(6)
    v_dot2_f32_bf16 v60, v144, v28, 0
    v_dot2_f32_bf16 v60, v145, v29, v60
    v_dot2_f32_bf16 v60, v146, v30, v60
    v_dot2_f32_bf16 v60, v147, v31, v60
    s_mov_b32 s68, 557056
    buffer_load_dwordx4 v[164:167], v4, s[32:35], s68 offen offset:1024 nt
    s_mov_b32 s68, 745472
    buffer_load_dwordx4 a[104:107], v6, s[44:47], s68 offen
    s_waitcnt vmcnt(7)
    v_dot2_f32_bf16 v61, v148, v28, 0
    v_dot2_f32_bf16 v61, v149, v29, v61
    v_dot2_f32_bf16 v61, v150, v30, v61
    v_dot2_f32_bf16 v61, v151, v31, v61
    s_mov_b32 s68, 557056
    buffer_load_dwordx4 v[168:171], v4, s[32:35], s68 offen offset:2048 nt
    v_add_f32_dpp v62, v60, v60 row_ror:8 row_mask:0xf bank_mask:0x3
    s_nop 1
    v_add_f32_dpp v62, v61, v61 row_ror:8 row_mask:0xf bank_mask:0xc
    v_and_b32_dpp v12, v53, v8 row_newbcast:6 row_mask:0xf bank_mask:0xf
    v_and_b32_dpp v13, v53, v9 row_newbcast:6 row_mask:0xf bank_mask:0xf
    v_and_b32_dpp v14, v53, v10 row_newbcast:6 row_mask:0xf bank_mask:0xf
    v_and_b32_dpp v15, v53, v11 row_newbcast:6 row_mask:0xf bank_mask:0xf
    s_nop 1
    v_mfma_f32_16x16x32_bf16 v[24:27], v[12:15], a[88:91], v[24:27]
    s_waitcnt vmcnt(6)
    v_dot2_f32_bf16 v60, v152, v28, 0
    v_dot2_f32_bf16 v60, v153, v29, v60
    v_dot2_f32_bf16 v60, v154, v30, v60
    v_dot2_f32_bf16 v60, v155, v31, v60
    s_mov_b32 s68, 557056
    buffer_load_dwordx4 v[172:175], v4, s[32:35], s68 offen offset:3072 nt
    s_mov_b32 s68, 774144
    buffer_load_dwordx4 a[108:111], v6, s[44:47], s68 offen
    s_waitcnt vmcnt(7)
    v_dot2_f32_bf16 v61, v156, v28, 0
    v_dot2_f32_bf16 v61, v157, v29, v61
    v_dot2_f32_bf16 v61, v158, v30, v61
    v_dot2_f32_bf16 v61, v159, v31, v61
    s_mov_b32 s68, 573440
    buffer_load_dwordx4 v[176:179], v4, s[32:35], s68 offen nt
    v_add_f32_dpp v60, v60, v60 row_ror:8 row_mask:0xf bank_mask:0x3
    s_nop 1
    v_add_f32_dpp v60, v61, v61 row_ror:8 row_mask:0xf bank_mask:0xc
    v_add_f32_dpp v62, v62, v62 row_ror:12 row_mask:0xf bank_mask:0x5
    s_nop 1
    v_add_f32_dpp v62, v60, v60 row_ror:4 row_mask:0xf bank_mask:0xa
    v_add_f32_dpp v60, v63, v63 quad_perm:[2,3,0,1] row_mask:0xf bank_mask:0xf
    s_nop 0
    v_add_f32_dpp v61, v62, v62 quad_perm:[2,3,0,1] row_mask:0xf bank_mask:0xf
    v_cndmask_b32 v64, v60, v61, s[80:81]
    v_and_b32_dpp v16, v53, v8 row_newbcast:7 row_mask:0xf bank_mask:0xf
    v_and_b32_dpp v17, v53, v9 row_newbcast:7 row_mask:0xf bank_mask:0xf
    v_and_b32_dpp v18, v53, v10 row_newbcast:7 row_mask:0xf bank_mask:0xf
    v_and_b32_dpp v19, v53, v11 row_newbcast:7 row_mask:0xf bank_mask:0xf
    s_nop 1
    v_mfma_f32_16x16x32_bf16 v[24:27], v[16:19], a[92:95], v[24:27]
    s_waitcnt vmcnt(6)
    v_dot2_f32_bf16 v60, v160, v28, 0
    v_dot2_f32_bf16 v60, v161, v29, v60
    v_dot2_f32_bf16 v60, v162, v30, v60
    v_dot2_f32_bf16 v60, v163, v31, v60
    s_mov_b32 s68, 573440
    buffer_load_dwordx4 v[180:183], v4, s[32:35], s68 offen offset:1024 nt
    s_mov_b32 s68, 802816
    buffer_load_dwordx4 a[112:115], v6, s[44:47], s68 offen
    s_waitcnt vmcnt(7)
    v_dot2_f32_bf16 v61, v164, v28, 0
    v_dot2_f32_bf16 v61, v165, v29, v61
    v_dot2_f32_bf16 v61, v166, v30, v61
    v_dot2_f32_bf16 v61, v167, v31, v61
    s_mov_b32 s68, 573440
    buffer_load_dwordx4 v[184:187], v4, s[32:35], s68 offen offset:2048 nt
    v_add_f32_dpp v62, v60, v60 row_ror:8 row_mask:0xf bank_mask:0x3
    s_nop 1
    v_add_f32_dpp v62, v61, v61 row_ror:8 row_mask:0xf bank_mask:0xc
    v_and_b32_dpp v12, v53, v8 row_newbcast:8 row_mask:0xf bank_mask:0xf
    v_and_b32_dpp v13, v53, v9 row_newbcast:8 row_mask:0xf bank_mask:0xf
    v_and_b32_dpp v14, v53, v10 row_newbcast:8 row_mask:0xf bank_mask:0xf
    v_and_b32_dpp v15, v53, v11 row_newbcast:8 row_mask:0xf bank_mask:0xf
    s_nop 1
    v_mfma_f32_16x16x32_bf16 v[24:27], v[12:15], a[96:99], v[24:27]
    s_waitcnt vmcnt(6)
    v_dot2_f32_bf16 v60, v168, v28, 0
    v_dot2_f32_bf16 v60, v169, v29, v60
    v_dot2_f32_bf16 v60, v170, v30, v60
    v_dot2_f32_bf16 v60, v171, v31, v60
    s_mov_b32 s68, 573440
    buffer_load_dwordx4 v[188:191], v4, s[32:35], s68 offen offset:3072 nt
    s_mov_b32 s68, 831488
    buffer_load_dwordx4 a[116:119], v6, s[44:47], s68 offen
    s_waitcnt vmcnt(7)
    v_dot2_f32_bf16 v61, v172, v28, 0
    v_dot2_f32_bf16 v61, v173, v29, v61
    v_dot2_f32_bf16 v61, v174, v30, v61
    v_dot2_f32_bf16 v61, v175, v31, v61
    s_mov_b32 s68, 589824
    buffer_load_dwordx4 v[192:195], v4, s[32:35], s68 offen nt
    v_add_f32_dpp v60, v60, v60 row_ror:8 row_mask:0xf bank_mask:0x3
    s_nop 1
    v_add_f32_dpp v60, v61, v61 row_ror:8 row_mask:0xf bank_mask:0xc
    v_add_f32_dpp v63, v62, v62 row_ror:12 row_mask:0xf bank_mask:0x5
    s_nop 1
    v_add_f32_dpp v63, v60, v60 row_ror:4 row_mask:0xf bank_mask:0xa
    v_and_b32_dpp v16, v53, v8 row_newbcast:9 row_mask:0xf bank_mask:0xf
    v_and_b32_dpp v17, v53, v9 row_newbcast:9 row_mask:0xf bank_mask:0xf
    v_and_b32_dpp v18, v53, v10 row_newbcast:9 row_mask:0xf bank_mask:0xf
    v_and_b32_dpp v19, v53, v11 row_newbcast:9 row_mask:0xf bank_mask:0xf
    s_nop 1
    v_mfma_f32_16x16x32_bf16 v[24:27], v[16:19], a[100:103], v[24:27]
    s_waitcnt vmcnt(6)
    v_dot2_f32_bf16 v60, v176, v28, 0
    v_dot2_f32_bf16 v60, v177, v29, v60
    v_dot2_f32_bf16 v60, v178, v30, v60
    v_dot2_f32_bf16 v60, v179, v31, v60
    s_mov_b32 s68, 589824
    buffer_load_dwordx4 v[196:199], v4, s[32:35], s68 offen offset:1024 nt
    s_mov_b32 s68, 860160
    buffer_load_dwordx4 a[120:123], v6, s[44:47], s68 offen
    s_waitcnt vmcnt(7)
    v_dot2_f32_bf16 v61, v180, v28, 0
    v_dot2_f32_bf16 v61, v181, v29, v61
    v_dot2_f32_bf16 v61, v182, v30, v61
    v_dot2_f32_bf16 v61, v183, v31, v61
    s_mov_b32 s68, 589824
    buffer_load_dwordx4 v[200:203], v4, s[32:35], s68 offen offset:2048 nt
    v_add_f32_dpp v62, v60, v60 row_ror:8 row_mask:0xf bank_mask:0x3
    s_nop 1
    v_add_f32_dpp v62, v61, v61 row_ror:8 row_mask:0xf bank_mask:0xc
    v_and_b32_dpp v12, v53, v8 row_newbcast:10 row_mask:0xf bank_mask:0xf
    v_and_b32_dpp v13, v53, v9 row_newbcast:10 row_mask:0xf bank_mask:0xf
    v_and_b32_dpp v14, v53, v10 row_newbcast:10 row_mask:0xf bank_mask:0xf
    v_and_b32_dpp v15, v53, v11 row_newbcast:10 row_mask:0xf bank_mask:0xf
    s_nop 1
    v_mfma_f32_16x16x32_bf16 v[24:27], v[12:15], a[104:107], v[24:27]
    s_waitcnt vmcnt(6)
    v_dot2_f32_bf16 v60, v184, v28, 0
    v_dot2_f32_bf16 v60, v185, v29, v60
    v_dot2_f32_bf16 v60, v186, v30, v60
    v_dot2_f32_bf16 v60, v187, v31, v60
    s_mov_b32 s68, 589824
    buffer_load_dwordx4 v[204:207], v4, s[32:35], s68 offen offset:3072 nt
    s_mov_b32 s68, 888832
    buffer_load_dwordx4 a[124:127], v6, s[44:47], s68 offen
    s_waitcnt vmcnt(7)
    v_dot2_f32_bf16 v61, v188, v28, 0
    v_dot2_f32_bf16 v61, v189, v29, v61
    v_dot2_f32_bf16 v61, v190, v30, v61
    v_dot2_f32_bf16 v61, v191, v31, v61
    s_mov_b32 s68, 606208
    buffer_load_dwordx4 v[208:211], v4, s[32:35], s68 offen nt
    v_add_f32_dpp v60, v60, v60 row_ror:8 row_mask:0xf bank_mask:0x3
    s_nop 1
    v_add_f32_dpp v60, v61, v61 row_ror:8 row_mask:0xf bank_mask:0xc
    v_add_f32_dpp v62, v62, v62 row_ror:12 row_mask:0xf bank_mask:0x5
    s_nop 1
    v_add_f32_dpp v62, v60, v60 row_ror:4 row_mask:0xf bank_mask:0xa
    v_add_f32_dpp v60, v63, v63 quad_perm:[2,3,0,1] row_mask:0xf bank_mask:0xf
    s_nop 0
    v_add_f32_dpp v61, v62, v62 quad_perm:[2,3,0,1] row_mask:0xf bank_mask:0xf
    v_cndmask_b32 v63, v60, v61, s[80:81]
    v_add_f32_dpp v60, v64, v64 quad_perm:[1,0,3,2] row_mask:0xf bank_mask:0xf
    s_nop 0
    v_add_f32_dpp v61, v63, v63 quad_perm:[1,0,3,2] row_mask:0xf bank_mask:0xf
    v_cndmask_b32 v40, v60, v61, s[82:83]
    v_cvt_pk_bf16_f32 v40, 0, v40
    v_mul_f32 v40, 0x3db504f3, v40
    v_cvt_pk_bf16_f32 v40, 0, v40
    v_and_b32_dpp v16, v53, v8 row_newbcast:11 row_mask:0xf bank_mask:0xf
    v_and_b32_dpp v17, v53, v9 row_newbcast:11 row_mask:0xf bank_mask:0xf
    v_and_b32_dpp v18, v53, v10 row_newbcast:11 row_mask:0xf bank_mask:0xf
    v_and_b32_dpp v19, v53, v11 row_newbcast:11 row_mask:0xf bank_mask:0xf
    s_nop 1
    v_mfma_f32_16x16x32_bf16 v[24:27], v[16:19], a[108:111], v[24:27]
    s_waitcnt vmcnt(6)
    v_dot2_f32_bf16 v60, v192, v28, 0
    v_dot2_f32_bf16 v60, v193, v29, v60
    v_dot2_f32_bf16 v60, v194, v30, v60
    v_dot2_f32_bf16 v60, v195, v31, v60
    s_mov_b32 s68, 606208
    buffer_load_dwordx4 v[212:215], v4, s[32:35], s68 offen offset:1024 nt
    s_mov_b32 s68, 917504
    buffer_load_dwordx4 a[128:131], v6, s[44:47], s68 offen
    s_waitcnt vmcnt(7)
    v_dot2_f32_bf16 v61, v196, v28, 0
    v_dot2_f32_bf16 v61, v197, v29, v61
    v_dot2_f32_bf16 v61, v198, v30, v61
    v_dot2_f32_bf16 v61, v199, v31, v61
    s_mov_b32 s68, 606208
    buffer_load_dwordx4 v[216:219], v4, s[32:35], s68 offen offset:2048 nt
    v_add_f32_dpp v62, v60, v60 row_ror:8 row_mask:0xf bank_mask:0x3
    s_nop 1
    v_add_f32_dpp v62, v61, v61 row_ror:8 row_mask:0xf bank_mask:0xc
    v_and_b32_dpp v12, v53, v8 row_newbcast:12 row_mask:0xf bank_mask:0xf
    v_and_b32_dpp v13, v53, v9 row_newbcast:12 row_mask:0xf bank_mask:0xf
    v_and_b32_dpp v14, v53, v10 row_newbcast:12 row_mask:0xf bank_mask:0xf
    v_and_b32_dpp v15, v53, v11 row_newbcast:12 row_mask:0xf bank_mask:0xf
    s_nop 1
    v_mfma_f32_16x16x32_bf16 v[24:27], v[12:15], a[112:115], v[24:27]
    s_waitcnt vmcnt(6)
    v_dot2_f32_bf16 v60, v200, v28, 0
    v_dot2_f32_bf16 v60, v201, v29, v60
    v_dot2_f32_bf16 v60, v202, v30, v60
    v_dot2_f32_bf16 v60, v203, v31, v60
    s_mov_b32 s68, 606208
    buffer_load_dwordx4 v[220:223], v4, s[32:35], s68 offen offset:3072 nt
    s_mov_b32 s68, 946176
    buffer_load_dwordx4 a[132:135], v6, s[44:47], s68 offen
    s_waitcnt vmcnt(7)
    v_dot2_f32_bf16 v61, v204, v28, 0
    v_dot2_f32_bf16 v61, v205, v29, v61
    v_dot2_f32_bf16 v61, v206, v30, v61
    v_dot2_f32_bf16 v61, v207, v31, v61
    s_mov_b32 s68, 622592
    buffer_load_dwordx4 v[224:227], v4, s[32:35], s68 offen nt
    v_add_f32_dpp v60, v60, v60 row_ror:8 row_mask:0xf bank_mask:0x3
    s_nop 1
    v_add_f32_dpp v60, v61, v61 row_ror:8 row_mask:0xf bank_mask:0xc
    v_add_f32_dpp v63, v62, v62 row_ror:12 row_mask:0xf bank_mask:0x5
    s_nop 1
    v_add_f32_dpp v63, v60, v60 row_ror:4 row_mask:0xf bank_mask:0xa
    v_and_b32_dpp v16, v53, v8 row_newbcast:13 row_mask:0xf bank_mask:0xf
    v_and_b32_dpp v17, v53, v9 row_newbcast:13 row_mask:0xf bank_mask:0xf
    v_and_b32_dpp v18, v53, v10 row_newbcast:13 row_mask:0xf bank_mask:0xf
    v_and_b32_dpp v19, v53, v11 row_newbcast:13 row_mask:0xf bank_mask:0xf
    s_nop 1
    v_mfma_f32_16x16x32_bf16 v[24:27], v[16:19], a[116:119], v[24:27]
    s_waitcnt vmcnt(6)
    v_dot2_f32_bf16 v60, v208, v28, 0
    v_dot2_f32_bf16 v60, v209, v29, v60
    v_dot2_f32_bf16 v60, v210, v30, v60
    v_dot2_f32_bf16 v60, v211, v31, v60
    s_mov_b32 s68, 622592
    buffer_load_dwordx4 v[228:231], v4, s[32:35], s68 offen offset:1024 nt
    s_mov_b32 s68, 974848
    buffer_load_dwordx4 a[136:139], v6, s[44:47], s68 offen
    s_waitcnt vmcnt(7)
    v_dot2_f32_bf16 v61, v212, v28, 0
    v_dot2_f32_bf16 v61, v213, v29, v61
    v_dot2_f32_bf16 v61, v214, v30, v61
    v_dot2_f32_bf16 v61, v215, v31, v61
    s_mov_b32 s68, 622592
    buffer_load_dwordx4 v[232:235], v4, s[32:35], s68 offen offset:2048 nt
    v_add_f32_dpp v62, v60, v60 row_ror:8 row_mask:0xf bank_mask:0x3
    s_nop 1
    v_add_f32_dpp v62, v61, v61 row_ror:8 row_mask:0xf bank_mask:0xc
    v_and_b32_dpp v12, v53, v8 row_newbcast:14 row_mask:0xf bank_mask:0xf
    v_and_b32_dpp v13, v53, v9 row_newbcast:14 row_mask:0xf bank_mask:0xf
    v_and_b32_dpp v14, v53, v10 row_newbcast:14 row_mask:0xf bank_mask:0xf
    v_and_b32_dpp v15, v53, v11 row_newbcast:14 row_mask:0xf bank_mask:0xf
    s_nop 1
    v_mfma_f32_16x16x32_bf16 v[24:27], v[12:15], a[120:123], v[24:27]
    s_waitcnt vmcnt(6)
    v_dot2_f32_bf16 v60, v216, v28, 0
    v_dot2_f32_bf16 v60, v217, v29, v60
    v_dot2_f32_bf16 v60, v218, v30, v60
    v_dot2_f32_bf16 v60, v219, v31, v60
    s_mov_b32 s68, 622592
    buffer_load_dwordx4 v[236:239], v4, s[32:35], s68 offen offset:3072 nt
    s_mov_b32 s68, 1003520
    buffer_load_dwordx4 a[140:143], v6, s[44:47], s68 offen
    s_waitcnt vmcnt(7)
    v_dot2_f32_bf16 v61, v220, v28, 0
    v_dot2_f32_bf16 v61, v221, v29, v61
    v_dot2_f32_bf16 v61, v222, v30, v61
    v_dot2_f32_bf16 v61, v223, v31, v61
    s_mov_b32 s68, 638976
    buffer_load_dwordx4 v[80:83], v4, s[32:35], s68 offen nt
    v_add_f32_dpp v60, v60, v60 row_ror:8 row_mask:0xf bank_mask:0x3
    s_nop 1
    v_add_f32_dpp v60, v61, v61 row_ror:8 row_mask:0xf bank_mask:0xc
    v_add_f32_dpp v62, v62, v62 row_ror:12 row_mask:0xf bank_mask:0x5
    s_nop 1
    v_add_f32_dpp v62, v60, v60 row_ror:4 row_mask:0xf bank_mask:0xa
    v_add_f32_dpp v60, v63, v63 quad_perm:[2,3,0,1] row_mask:0xf bank_mask:0xf
    s_nop 0
    v_add_f32_dpp v61, v62, v62 quad_perm:[2,3,0,1] row_mask:0xf bank_mask:0xf
    v_cndmask_b32 v64, v60, v61, s[80:81]
    v_and_b32_dpp v16, v53, v8 row_newbcast:15 row_mask:0xf bank_mask:0xf
    v_and_b32_dpp v17, v53, v9 row_newbcast:15 row_mask:0xf bank_mask:0xf
    v_and_b32_dpp v18, v53, v10 row_newbcast:15 row_mask:0xf bank_mask:0xf
    v_and_b32_dpp v19, v53, v11 row_newbcast:15 row_mask:0xf bank_mask:0xf
    s_nop 1
    v_mfma_f32_16x16x32_bf16 v[24:27], v[16:19], a[124:127], v[24:27]
    s_waitcnt vmcnt(6)
    v_dot2_f32_bf16 v60, v224, v28, 0
    v_dot2_f32_bf16 v60, v225, v29, v60
    v_dot2_f32_bf16 v60, v226, v30, v60
    v_dot2_f32_bf16 v60, v227, v31, v60
    s_mov_b32 s68, 638976
    buffer_load_dwordx4 v[84:87], v4, s[32:35], s68 offen offset:1024 nt
    s_mov_b32 s68, 1032192
    buffer_load_dwordx4 a[144:147], v6, s[44:47], s68 offen
    s_waitcnt vmcnt(7)
    v_dot2_f32_bf16 v61, v228, v28, 0
    v_dot2_f32_bf16 v61, v229, v29, v61
    v_dot2_f32_bf16 v61, v230, v30, v61
    v_dot2_f32_bf16 v61, v231, v31, v61
    s_mov_b32 s68, 638976
    buffer_load_dwordx4 v[88:91], v4, s[32:35], s68 offen offset:2048 nt
    v_add_f32_dpp v62, v60, v60 row_ror:8 row_mask:0xf bank_mask:0x3
    s_nop 1
    v_add_f32_dpp v62, v61, v61 row_ror:8 row_mask:0xf bank_mask:0xc
    v_and_b32_dpp v12, v54, v8 row_newbcast:0 row_mask:0xf bank_mask:0xf
    v_and_b32_dpp v13, v54, v9 row_newbcast:0 row_mask:0xf bank_mask:0xf
    v_and_b32_dpp v14, v54, v10 row_newbcast:0 row_mask:0xf bank_mask:0xf
    v_and_b32_dpp v15, v54, v11 row_newbcast:0 row_mask:0xf bank_mask:0xf
    s_nop 1
    v_mfma_f32_16x16x32_bf16 v[24:27], v[12:15], a[128:131], v[24:27]
    s_waitcnt vmcnt(6)
    v_dot2_f32_bf16 v60, v232, v28, 0
    v_dot2_f32_bf16 v60, v233, v29, v60
    v_dot2_f32_bf16 v60, v234, v30, v60
    v_dot2_f32_bf16 v60, v235, v31, v60
    s_mov_b32 s68, 638976
    buffer_load_dwordx4 v[92:95], v4, s[32:35], s68 offen offset:3072 nt
    s_mov_b32 s68, 1060864
    buffer_load_dwordx4 a[148:151], v6, s[44:47], s68 offen
    s_waitcnt vmcnt(7)
    v_dot2_f32_bf16 v61, v236, v28, 0
    v_dot2_f32_bf16 v61, v237, v29, v61
    v_dot2_f32_bf16 v61, v238, v30, v61
    v_dot2_f32_bf16 v61, v239, v31, v61
    s_mov_b32 s68, 655360
    buffer_load_dwordx4 v[96:99], v4, s[32:35], s68 offen nt
    v_add_f32_dpp v60, v60, v60 row_ror:8 row_mask:0xf bank_mask:0x3
    s_nop 1
    v_add_f32_dpp v60, v61, v61 row_ror:8 row_mask:0xf bank_mask:0xc
    v_add_f32_dpp v63, v62, v62 row_ror:12 row_mask:0xf bank_mask:0x5
    s_nop 1
    v_add_f32_dpp v63, v60, v60 row_ror:4 row_mask:0xf bank_mask:0xa
    v_and_b32_dpp v16, v54, v8 row_newbcast:1 row_mask:0xf bank_mask:0xf
    v_and_b32_dpp v17, v54, v9 row_newbcast:1 row_mask:0xf bank_mask:0xf
    v_and_b32_dpp v18, v54, v10 row_newbcast:1 row_mask:0xf bank_mask:0xf
    v_and_b32_dpp v19, v54, v11 row_newbcast:1 row_mask:0xf bank_mask:0xf
    s_nop 1
    v_mfma_f32_16x16x32_bf16 v[24:27], v[16:19], a[132:135], v[24:27]
    s_waitcnt vmcnt(6)
    v_dot2_f32_bf16 v60, v80, v28, 0
    v_dot2_f32_bf16 v60, v81, v29, v60
    v_dot2_f32_bf16 v60, v82, v30, v60
    v_dot2_f32_bf16 v60, v83, v31, v60
    s_mov_b32 s68, 655360
    buffer_load_dwordx4 v[100:103], v4, s[32:35], s68 offen offset:1024 nt
    s_mov_b32 s68, 1089536
    buffer_load_dwordx4 a[152:155], v6, s[44:47], s68 offen
    s_waitcnt vmcnt(7)
    v_dot2_f32_bf16 v61, v84, v28, 0
    v_dot2_f32_bf16 v61, v85, v29, v61
    v_dot2_f32_bf16 v61, v86, v30, v61
    v_dot2_f32_bf16 v61, v87, v31, v61
    s_mov_b32 s68, 655360
    buffer_load_dwordx4 v[104:107], v4, s[32:35], s68 offen offset:2048 nt
    v_add_f32_dpp v62, v60, v60 row_ror:8 row_mask:0xf bank_mask:0x3
    s_nop 1
    v_add_f32_dpp v62, v61, v61 row_ror:8 row_mask:0xf bank_mask:0xc
    v_and_b32_dpp v12, v54, v8 row_newbcast:2 row_mask:0xf bank_mask:0xf
    v_and_b32_dpp v13, v54, v9 row_newbcast:2 row_mask:0xf bank_mask:0xf
    v_and_b32_dpp v14, v54, v10 row_newbcast:2 row_mask:0xf bank_mask:0xf
    v_and_b32_dpp v15, v54, v11 row_newbcast:2 row_mask:0xf bank_mask:0xf
    s_nop 1
    v_mfma_f32_16x16x32_bf16 v[24:27], v[12:15], a[136:139], v[24:27]
    s_waitcnt vmcnt(6)
    v_dot2_f32_bf16 v60, v88, v28, 0
    v_dot2_f32_bf16 v60, v89, v29, v60
    v_dot2_f32_bf16 v60, v90, v30, v60
    v_dot2_f32_bf16 v60, v91, v31, v60
    s_mov_b32 s68, 655360
    buffer_load_dwordx4 v[108:111], v4, s[32:35], s68 offen offset:3072 nt
    s_mov_b32 s68, 1118208
    buffer_load_dwordx4 a[156:159], v6, s[44:47], s68 offen
    s_waitcnt vmcnt(7)
    v_dot2_f32_bf16 v61, v92, v28, 0
    v_dot2_f32_bf16 v61, v93, v29, v61
    v_dot2_f32_bf16 v61, v94, v30, v61
    v_dot2_f32_bf16 v61, v95, v31, v61
    s_mov_b32 s68, 671744
    buffer_load_dwordx4 v[112:115], v4, s[32:35], s68 offen nt
    v_add_f32_dpp v60, v60, v60 row_ror:8 row_mask:0xf bank_mask:0x3
    s_nop 1
    v_add_f32_dpp v60, v61, v61 row_ror:8 row_mask:0xf bank_mask:0xc
    v_add_f32_dpp v62, v62, v62 row_ror:12 row_mask:0xf bank_mask:0x5
    s_nop 1
    v_add_f32_dpp v62, v60, v60 row_ror:4 row_mask:0xf bank_mask:0xa
    v_add_f32_dpp v60, v63, v63 quad_perm:[2,3,0,1] row_mask:0xf bank_mask:0xf
    s_nop 0
    v_add_f32_dpp v61, v62, v62 quad_perm:[2,3,0,1] row_mask:0xf bank_mask:0xf
    v_cndmask_b32 v63, v60, v61, s[80:81]
    v_add_f32_dpp v60, v64, v64 quad_perm:[1,0,3,2] row_mask:0xf bank_mask:0xf
    s_nop 0
    v_add_f32_dpp v61, v63, v63 quad_perm:[1,0,3,2] row_mask:0xf bank_mask:0xf
    v_cndmask_b32 v41, v60, v61, s[82:83]
    v_cvt_pk_bf16_f32 v41, 0, v41
    v_mul_f32 v41, 0x3db504f3, v41
    v_cvt_pk_bf16_f32 v41, 0, v41
    v_and_b32_dpp v16, v54, v8 row_newbcast:3 row_mask:0xf bank_mask:0xf
    v_and_b32_dpp v17, v54, v9 row_newbcast:3 row_mask:0xf bank_mask:0xf
    v_and_b32_dpp v18, v54, v10 row_newbcast:3 row_mask:0xf bank_mask:0xf
    v_and_b32_dpp v19, v54, v11 row_newbcast:3 row_mask:0xf bank_mask:0xf
    s_nop 1
    v_mfma_f32_16x16x32_bf16 v[24:27], v[16:19], a[140:143], v[24:27]
    s_waitcnt vmcnt(6)
    v_dot2_f32_bf16 v60, v96, v28, 0
    v_dot2_f32_bf16 v60, v97, v29, v60
    v_dot2_f32_bf16 v60, v98, v30, v60
    v_dot2_f32_bf16 v60, v99, v31, v60
    s_mov_b32 s68, 671744
    buffer_load_dwordx4 v[116:119], v4, s[32:35], s68 offen offset:1024 nt
    s_mov_b32 s68, 1146880
    buffer_load_dwordx4 a[160:163], v6, s[44:47], s68 offen
    s_waitcnt vmcnt(7)
    v_dot2_f32_bf16 v61, v100, v28, 0
    v_dot2_f32_bf16 v61, v101, v29, v61
    v_dot2_f32_bf16 v61, v102, v30, v61
    v_dot2_f32_bf16 v61, v103, v31, v61
    s_mov_b32 s68, 671744
    buffer_load_dwordx4 v[120:123], v4, s[32:35], s68 offen offset:2048 nt
    v_add_f32_dpp v62, v60, v60 row_ror:8 row_mask:0xf bank_mask:0x3
    s_nop 1
    v_add_f32_dpp v62, v61, v61 row_ror:8 row_mask:0xf bank_mask:0xc
    v_and_b32_dpp v12, v54, v8 row_newbcast:4 row_mask:0xf bank_mask:0xf
    v_and_b32_dpp v13, v54, v9 row_newbcast:4 row_mask:0xf bank_mask:0xf
    v_and_b32_dpp v14, v54, v10 row_newbcast:4 row_mask:0xf bank_mask:0xf
    v_and_b32_dpp v15, v54, v11 row_newbcast:4 row_mask:0xf bank_mask:0xf
    s_nop 1
    v_mfma_f32_16x16x32_bf16 v[24:27], v[12:15], a[144:147], v[24:27]
    s_waitcnt vmcnt(6)
    v_dot2_f32_bf16 v60, v104, v28, 0
    v_dot2_f32_bf16 v60, v105, v29, v60
    v_dot2_f32_bf16 v60, v106, v30, v60
    v_dot2_f32_bf16 v60, v107, v31, v60
    s_mov_b32 s68, 671744
    buffer_load_dwordx4 v[124:127], v4, s[32:35], s68 offen offset:3072 nt
    s_mov_b32 s68, 1175552
    buffer_load_dwordx4 a[164:167], v6, s[44:47], s68 offen
    s_waitcnt vmcnt(7)
    v_dot2_f32_bf16 v61, v108, v28, 0
    v_dot2_f32_bf16 v61, v109, v29, v61
    v_dot2_f32_bf16 v61, v110, v30, v61
    v_dot2_f32_bf16 v61, v111, v31, v61
    s_mov_b32 s68, 688128
    buffer_load_dwordx4 v[128:131], v4, s[32:35], s68 offen nt
    v_add_f32_dpp v60, v60, v60 row_ror:8 row_mask:0xf bank_mask:0x3
    s_nop 1
    v_add_f32_dpp v60, v61, v61 row_ror:8 row_mask:0xf bank_mask:0xc
    v_add_f32_dpp v63, v62, v62 row_ror:12 row_mask:0xf bank_mask:0x5
    s_nop 1
    v_add_f32_dpp v63, v60, v60 row_ror:4 row_mask:0xf bank_mask:0xa
    v_and_b32_dpp v16, v54, v8 row_newbcast:5 row_mask:0xf bank_mask:0xf
    v_and_b32_dpp v17, v54, v9 row_newbcast:5 row_mask:0xf bank_mask:0xf
    v_and_b32_dpp v18, v54, v10 row_newbcast:5 row_mask:0xf bank_mask:0xf
    v_and_b32_dpp v19, v54, v11 row_newbcast:5 row_mask:0xf bank_mask:0xf
    s_nop 1
    v_mfma_f32_16x16x32_bf16 v[24:27], v[16:19], a[148:151], v[24:27]
    s_waitcnt vmcnt(6)
    v_dot2_f32_bf16 v60, v112, v28, 0
    v_dot2_f32_bf16 v60, v113, v29, v60
    v_dot2_f32_bf16 v60, v114, v30, v60
    v_dot2_f32_bf16 v60, v115, v31, v60
    s_mov_b32 s68, 688128
    buffer_load_dwordx4 v[132:135], v4, s[32:35], s68 offen offset:1024 nt
    s_mov_b32 s68, 1204224
    buffer_load_dwordx4 a[168:171], v6, s[44:47], s68 offen
    s_waitcnt vmcnt(7)
    v_dot2_f32_bf16 v61, v116, v28, 0
    v_dot2_f32_bf16 v61, v117, v29, v61
    v_dot2_f32_bf16 v61, v118, v30, v61
    v_dot2_f32_bf16 v61, v119, v31, v61
    s_mov_b32 s68, 688128
    buffer_load_dwordx4 v[136:139], v4, s[32:35], s68 offen offset:2048 nt
    v_add_f32_dpp v62, v60, v60 row_ror:8 row_mask:0xf bank_mask:0x3
    s_nop 1
    v_add_f32_dpp v62, v61, v61 row_ror:8 row_mask:0xf bank_mask:0xc
    v_and_b32_dpp v12, v54, v8 row_newbcast:6 row_mask:0xf bank_mask:0xf
    v_and_b32_dpp v13, v54, v9 row_newbcast:6 row_mask:0xf bank_mask:0xf
    v_and_b32_dpp v14, v54, v10 row_newbcast:6 row_mask:0xf bank_mask:0xf
    v_and_b32_dpp v15, v54, v11 row_newbcast:6 row_mask:0xf bank_mask:0xf
    s_nop 1
    v_mfma_f32_16x16x32_bf16 v[24:27], v[12:15], a[152:155], v[24:27]
    s_waitcnt vmcnt(6)
    v_dot2_f32_bf16 v60, v120, v28, 0
    v_dot2_f32_bf16 v60, v121, v29, v60
    v_dot2_f32_bf16 v60, v122, v30, v60
    v_dot2_f32_bf16 v60, v123, v31, v60
    s_mov_b32 s68, 688128
    buffer_load_dwordx4 v[140:143], v4, s[32:35], s68 offen offset:3072 nt
    s_mov_b32 s68, 1232896
    buffer_load_dwordx4 a[172:175], v6, s[44:47], s68 offen
    s_waitcnt vmcnt(7)
    v_dot2_f32_bf16 v61, v124, v28, 0
    v_dot2_f32_bf16 v61, v125, v29, v61
    v_dot2_f32_bf16 v61, v126, v30, v61
    v_dot2_f32_bf16 v61, v127, v31, v61
    s_mov_b32 s68, 704512
    buffer_load_dwordx4 v[144:147], v4, s[32:35], s68 offen nt
    v_add_f32_dpp v60, v60, v60 row_ror:8 row_mask:0xf bank_mask:0x3
    s_nop 1
    v_add_f32_dpp v60, v61, v61 row_ror:8 row_mask:0xf bank_mask:0xc
    v_add_f32_dpp v62, v62, v62 row_ror:12 row_mask:0xf bank_mask:0x5
    s_nop 1
    v_add_f32_dpp v62, v60, v60 row_ror:4 row_mask:0xf bank_mask:0xa
    v_add_f32_dpp v60, v63, v63 quad_perm:[2,3,0,1] row_mask:0xf bank_mask:0xf
    s_nop 0
    v_add_f32_dpp v61, v62, v62 quad_perm:[2,3,0,1] row_mask:0xf bank_mask:0xf
    v_cndmask_b32 v64, v60, v61, s[80:81]
    v_and_b32_dpp v16, v54, v8 row_newbcast:7 row_mask:0xf bank_mask:0xf
    v_and_b32_dpp v17, v54, v9 row_newbcast:7 row_mask:0xf bank_mask:0xf
    v_and_b32_dpp v18, v54, v10 row_newbcast:7 row_mask:0xf bank_mask:0xf
    v_and_b32_dpp v19, v54, v11 row_newbcast:7 row_mask:0xf bank_mask:0xf
    s_nop 1
    v_mfma_f32_16x16x32_bf16 v[24:27], v[16:19], a[156:159], v[24:27]
    s_waitcnt vmcnt(6)
    v_dot2_f32_bf16 v60, v128, v28, 0
    v_dot2_f32_bf16 v60, v129, v29, v60
    v_dot2_f32_bf16 v60, v130, v30, v60
    v_dot2_f32_bf16 v60, v131, v31, v60
    s_mov_b32 s68, 704512
    buffer_load_dwordx4 v[148:151], v4, s[32:35], s68 offen offset:1024 nt
    s_mov_b32 s68, 1261568
    buffer_load_dwordx4 a[176:179], v6, s[44:47], s68 offen
    s_waitcnt vmcnt(7)
    v_dot2_f32_bf16 v61, v132, v28, 0
    v_dot2_f32_bf16 v61, v133, v29, v61
    v_dot2_f32_bf16 v61, v134, v30, v61
    v_dot2_f32_bf16 v61, v135, v31, v61
    s_mov_b32 s68, 704512
    buffer_load_dwordx4 v[152:155], v4, s[32:35], s68 offen offset:2048 nt
    v_add_f32_dpp v62, v60, v60 row_ror:8 row_mask:0xf bank_mask:0x3
    s_nop 1
    v_add_f32_dpp v62, v61, v61 row_ror:8 row_mask:0xf bank_mask:0xc
    v_and_b32_dpp v12, v54, v8 row_newbcast:8 row_mask:0xf bank_mask:0xf
    v_and_b32_dpp v13, v54, v9 row_newbcast:8 row_mask:0xf bank_mask:0xf
    v_and_b32_dpp v14, v54, v10 row_newbcast:8 row_mask:0xf bank_mask:0xf
    v_and_b32_dpp v15, v54, v11 row_newbcast:8 row_mask:0xf bank_mask:0xf
    s_nop 1
    v_mfma_f32_16x16x32_bf16 v[24:27], v[12:15], a[160:163], v[24:27]
    s_waitcnt vmcnt(6)
    v_dot2_f32_bf16 v60, v136, v28, 0
    v_dot2_f32_bf16 v60, v137, v29, v60
    v_dot2_f32_bf16 v60, v138, v30, v60
    v_dot2_f32_bf16 v60, v139, v31, v60
    s_mov_b32 s68, 704512
    buffer_load_dwordx4 v[156:159], v4, s[32:35], s68 offen offset:3072 nt
    s_mov_b32 s68, 1290240
    buffer_load_dwordx4 a[180:183], v6, s[44:47], s68 offen
    s_waitcnt vmcnt(7)
    v_dot2_f32_bf16 v61, v140, v28, 0
    v_dot2_f32_bf16 v61, v141, v29, v61
    v_dot2_f32_bf16 v61, v142, v30, v61
    v_dot2_f32_bf16 v61, v143, v31, v61
    s_mov_b32 s68, 720896
    buffer_load_dwordx4 v[160:163], v4, s[32:35], s68 offen nt
    v_add_f32_dpp v60, v60, v60 row_ror:8 row_mask:0xf bank_mask:0x3
    s_nop 1
    v_add_f32_dpp v60, v61, v61 row_ror:8 row_mask:0xf bank_mask:0xc
    v_add_f32_dpp v63, v62, v62 row_ror:12 row_mask:0xf bank_mask:0x5
    s_nop 1
    v_add_f32_dpp v63, v60, v60 row_ror:4 row_mask:0xf bank_mask:0xa
    v_and_b32_dpp v16, v54, v8 row_newbcast:9 row_mask:0xf bank_mask:0xf
    v_and_b32_dpp v17, v54, v9 row_newbcast:9 row_mask:0xf bank_mask:0xf
    v_and_b32_dpp v18, v54, v10 row_newbcast:9 row_mask:0xf bank_mask:0xf
    v_and_b32_dpp v19, v54, v11 row_newbcast:9 row_mask:0xf bank_mask:0xf
    s_nop 1
    v_mfma_f32_16x16x32_bf16 v[24:27], v[16:19], a[164:167], v[24:27]
    s_waitcnt vmcnt(6)
    v_dot2_f32_bf16 v60, v144, v28, 0
    v_dot2_f32_bf16 v60, v145, v29, v60
    v_dot2_f32_bf16 v60, v146, v30, v60
    v_dot2_f32_bf16 v60, v147, v31, v60
    s_mov_b32 s68, 720896
    buffer_load_dwordx4 v[164:167], v4, s[32:35], s68 offen offset:1024 nt
    s_mov_b32 s68, 1318912
    buffer_load_dwordx4 a[184:187], v6, s[44:47], s68 offen
    s_waitcnt vmcnt(7)
    v_dot2_f32_bf16 v61, v148, v28, 0
    v_dot2_f32_bf16 v61, v149, v29, v61
    v_dot2_f32_bf16 v61, v150, v30, v61
    v_dot2_f32_bf16 v61, v151, v31, v61
    s_mov_b32 s68, 720896
    buffer_load_dwordx4 v[168:171], v4, s[32:35], s68 offen offset:2048 nt
    v_add_f32_dpp v62, v60, v60 row_ror:8 row_mask:0xf bank_mask:0x3
    s_nop 1
    v_add_f32_dpp v62, v61, v61 row_ror:8 row_mask:0xf bank_mask:0xc
    v_and_b32_dpp v12, v54, v8 row_newbcast:10 row_mask:0xf bank_mask:0xf
    v_and_b32_dpp v13, v54, v9 row_newbcast:10 row_mask:0xf bank_mask:0xf
    v_and_b32_dpp v14, v54, v10 row_newbcast:10 row_mask:0xf bank_mask:0xf
    v_and_b32_dpp v15, v54, v11 row_newbcast:10 row_mask:0xf bank_mask:0xf
    s_nop 1
    v_mfma_f32_16x16x32_bf16 v[24:27], v[12:15], a[168:171], v[24:27]
    s_waitcnt vmcnt(6)
    v_dot2_f32_bf16 v60, v152, v28, 0
    v_dot2_f32_bf16 v60, v153, v29, v60
    v_dot2_f32_bf16 v60, v154, v30, v60
    v_dot2_f32_bf16 v60, v155, v31, v60
    s_mov_b32 s68, 720896
    buffer_load_dwordx4 v[172:175], v4, s[32:35], s68 offen offset:3072 nt
    s_mov_b32 s68, 1347584
    buffer_load_dwordx4 a[188:191], v6, s[44:47], s68 offen
    s_waitcnt vmcnt(7)
    v_dot2_f32_bf16 v61, v156, v28, 0
    v_dot2_f32_bf16 v61, v157, v29, v61
    v_dot2_f32_bf16 v61, v158, v30, v61
    v_dot2_f32_bf16 v61, v159, v31, v61
    s_mov_b32 s68, 737280
    buffer_load_dwordx4 v[176:179], v4, s[32:35], s68 offen nt
    v_add_f32_dpp v60, v60, v60 row_ror:8 row_mask:0xf bank_mask:0x3
    s_nop 1
    v_add_f32_dpp v60, v61, v61 row_ror:8 row_mask:0xf bank_mask:0xc
    v_add_f32_dpp v62, v62, v62 row_ror:12 row_mask:0xf bank_mask:0x5
    s_nop 1
    v_add_f32_dpp v62, v60, v60 row_ror:4 row_mask:0xf bank_mask:0xa
    v_add_f32_dpp v60, v63, v63 quad_perm:[2,3,0,1] row_mask:0xf bank_mask:0xf
    s_nop 0
    v_add_f32_dpp v61, v62, v62 quad_perm:[2,3,0,1] row_mask:0xf bank_mask:0xf
    v_cndmask_b32 v63, v60, v61, s[80:81]
    v_add_f32_dpp v60, v64, v64 quad_perm:[1,0,3,2] row_mask:0xf bank_mask:0xf
    s_nop 0
    v_add_f32_dpp v61, v63, v63 quad_perm:[1,0,3,2] row_mask:0xf bank_mask:0xf
    v_cndmask_b32 v42, v60, v61, s[82:83]
    v_cvt_pk_bf16_f32 v42, 0, v42
    v_mul_f32 v42, 0x3db504f3, v42
    v_cvt_pk_bf16_f32 v42, 0, v42
    v_and_b32_dpp v16, v54, v8 row_newbcast:11 row_mask:0xf bank_mask:0xf
    v_and_b32_dpp v17, v54, v9 row_newbcast:11 row_mask:0xf bank_mask:0xf
    v_and_b32_dpp v18, v54, v10 row_newbcast:11 row_mask:0xf bank_mask:0xf
    v_and_b32_dpp v19, v54, v11 row_newbcast:11 row_mask:0xf bank_mask:0xf
    s_nop 1
    v_mfma_f32_16x16x32_bf16 v[24:27], v[16:19], a[172:175], v[24:27]
    s_waitcnt vmcnt(6)
    v_dot2_f32_bf16 v60, v160, v28, 0
    v_dot2_f32_bf16 v60, v161, v29, v60
    v_dot2_f32_bf16 v60, v162, v30, v60
    v_dot2_f32_bf16 v60, v163, v31, v60
    s_mov_b32 s68, 737280
    buffer_load_dwordx4 v[180:183], v4, s[32:35], s68 offen offset:1024 nt
    s_mov_b32 s68, 1376256
    buffer_load_dwordx4 a[192:195], v6, s[44:47], s68 offen
    s_waitcnt vmcnt(7)
    v_dot2_f32_bf16 v61, v164, v28, 0
    v_dot2_f32_bf16 v61, v165, v29, v61
    v_dot2_f32_bf16 v61, v166, v30, v61
    v_dot2_f32_bf16 v61, v167, v31, v61
    s_mov_b32 s68, 737280
    buffer_load_dwordx4 v[184:187], v4, s[32:35], s68 offen offset:2048 nt
    v_add_f32_dpp v62, v60, v60 row_ror:8 row_mask:0xf bank_mask:0x3
    s_nop 1
    v_add_f32_dpp v62, v61, v61 row_ror:8 row_mask:0xf bank_mask:0xc
    v_and_b32_dpp v12, v54, v8 row_newbcast:12 row_mask:0xf bank_mask:0xf
    v_and_b32_dpp v13, v54, v9 row_newbcast:12 row_mask:0xf bank_mask:0xf
    v_and_b32_dpp v14, v54, v10 row_newbcast:12 row_mask:0xf bank_mask:0xf
    v_and_b32_dpp v15, v54, v11 row_newbcast:12 row_mask:0xf bank_mask:0xf
    s_nop 1
    v_mfma_f32_16x16x32_bf16 v[24:27], v[12:15], a[176:179], v[24:27]
    s_waitcnt vmcnt(6)
    v_dot2_f32_bf16 v60, v168, v28, 0
    v_dot2_f32_bf16 v60, v169, v29, v60
    v_dot2_f32_bf16 v60, v170, v30, v60
    v_dot2_f32_bf16 v60, v171, v31, v60
    s_mov_b32 s68, 737280
    buffer_load_dwordx4 v[188:191], v4, s[32:35], s68 offen offset:3072 nt
    s_mov_b32 s68, 1404928
    buffer_load_dwordx4 a[196:199], v6, s[44:47], s68 offen
    s_waitcnt vmcnt(7)
    v_dot2_f32_bf16 v61, v172, v28, 0
    v_dot2_f32_bf16 v61, v173, v29, v61
    v_dot2_f32_bf16 v61, v174, v30, v61
    v_dot2_f32_bf16 v61, v175, v31, v61
    s_mov_b32 s68, 753664
    buffer_load_dwordx4 v[192:195], v4, s[32:35], s68 offen nt
    v_add_f32_dpp v60, v60, v60 row_ror:8 row_mask:0xf bank_mask:0x3
    s_nop 1
    v_add_f32_dpp v60, v61, v61 row_ror:8 row_mask:0xf bank_mask:0xc
    v_add_f32_dpp v63, v62, v62 row_ror:12 row_mask:0xf bank_mask:0x5
    s_nop 1
    v_add_f32_dpp v63, v60, v60 row_ror:4 row_mask:0xf bank_mask:0xa
    v_and_b32_dpp v16, v54, v8 row_newbcast:13 row_mask:0xf bank_mask:0xf
    v_and_b32_dpp v17, v54, v9 row_newbcast:13 row_mask:0xf bank_mask:0xf
    v_and_b32_dpp v18, v54, v10 row_newbcast:13 row_mask:0xf bank_mask:0xf
    v_and_b32_dpp v19, v54, v11 row_newbcast:13 row_mask:0xf bank_mask:0xf
    s_nop 1
    v_mfma_f32_16x16x32_bf16 v[24:27], v[16:19], a[180:183], v[24:27]
    s_waitcnt vmcnt(6)
    v_dot2_f32_bf16 v60, v176, v28, 0
    v_dot2_f32_bf16 v60, v177, v29, v60
    v_dot2_f32_bf16 v60, v178, v30, v60
    v_dot2_f32_bf16 v60, v179, v31, v60
    s_mov_b32 s68, 753664
    buffer_load_dwordx4 v[196:199], v4, s[32:35], s68 offen offset:1024 nt
    s_mov_b32 s68, 1433600
    buffer_load_dwordx4 a[200:203], v6, s[44:47], s68 offen
    s_waitcnt vmcnt(7)
    v_dot2_f32_bf16 v61, v180, v28, 0
    v_dot2_f32_bf16 v61, v181, v29, v61
    v_dot2_f32_bf16 v61, v182, v30, v61
    v_dot2_f32_bf16 v61, v183, v31, v61
    s_mov_b32 s68, 753664
    buffer_load_dwordx4 v[200:203], v4, s[32:35], s68 offen offset:2048 nt
    v_add_f32_dpp v62, v60, v60 row_ror:8 row_mask:0xf bank_mask:0x3
    s_nop 1
    v_add_f32_dpp v62, v61, v61 row_ror:8 row_mask:0xf bank_mask:0xc
    v_and_b32_dpp v12, v54, v8 row_newbcast:14 row_mask:0xf bank_mask:0xf
    v_and_b32_dpp v13, v54, v9 row_newbcast:14 row_mask:0xf bank_mask:0xf
    v_and_b32_dpp v14, v54, v10 row_newbcast:14 row_mask:0xf bank_mask:0xf
    v_and_b32_dpp v15, v54, v11 row_newbcast:14 row_mask:0xf bank_mask:0xf
    s_nop 1
    v_mfma_f32_16x16x32_bf16 v[24:27], v[12:15], a[184:187], v[24:27]
    s_waitcnt vmcnt(6)
    v_dot2_f32_bf16 v60, v184, v28, 0
    v_dot2_f32_bf16 v60, v185, v29, v60
    v_dot2_f32_bf16 v60, v186, v30, v60
    v_dot2_f32_bf16 v60, v187, v31, v60
    s_mov_b32 s68, 753664
    buffer_load_dwordx4 v[204:207], v4, s[32:35], s68 offen offset:3072 nt
    s_mov_b32 s68, 1462272
    buffer_load_dwordx4 a[204:207], v6, s[44:47], s68 offen
    s_waitcnt vmcnt(7)
    v_dot2_f32_bf16 v61, v188, v28, 0
    v_dot2_f32_bf16 v61, v189, v29, v61
    v_dot2_f32_bf16 v61, v190, v30, v61
    v_dot2_f32_bf16 v61, v191, v31, v61
    s_mov_b32 s68, 770048
    buffer_load_dwordx4 v[208:211], v4, s[32:35], s68 offen nt
    v_add_f32_dpp v60, v60, v60 row_ror:8 row_mask:0xf bank_mask:0x3
    s_nop 1
    v_add_f32_dpp v60, v61, v61 row_ror:8 row_mask:0xf bank_mask:0xc
    v_add_f32_dpp v62, v62, v62 row_ror:12 row_mask:0xf bank_mask:0x5
    s_nop 1
    v_add_f32_dpp v62, v60, v60 row_ror:4 row_mask:0xf bank_mask:0xa
    v_add_f32_dpp v60, v63, v63 quad_perm:[2,3,0,1] row_mask:0xf bank_mask:0xf
    s_nop 0
    v_add_f32_dpp v61, v62, v62 quad_perm:[2,3,0,1] row_mask:0xf bank_mask:0xf
    v_cndmask_b32 v64, v60, v61, s[80:81]
    v_and_b32_dpp v16, v54, v8 row_newbcast:15 row_mask:0xf bank_mask:0xf
    v_and_b32_dpp v17, v54, v9 row_newbcast:15 row_mask:0xf bank_mask:0xf
    v_and_b32_dpp v18, v54, v10 row_newbcast:15 row_mask:0xf bank_mask:0xf
    v_and_b32_dpp v19, v54, v11 row_newbcast:15 row_mask:0xf bank_mask:0xf
    s_nop 1
    v_mfma_f32_16x16x32_bf16 v[24:27], v[16:19], a[188:191], v[24:27]
    s_waitcnt vmcnt(6)
    v_dot2_f32_bf16 v60, v192, v28, 0
    v_dot2_f32_bf16 v60, v193, v29, v60
    v_dot2_f32_bf16 v60, v194, v30, v60
    v_dot2_f32_bf16 v60, v195, v31, v60
    s_mov_b32 s68, 770048
    buffer_load_dwordx4 v[212:215], v4, s[32:35], s68 offen offset:1024 nt
    s_mov_b32 s68, 1490944
    buffer_load_dwordx4 a[208:211], v6, s[44:47], s68 offen
    s_waitcnt vmcnt(7)
    v_dot2_f32_bf16 v61, v196, v28, 0
    v_dot2_f32_bf16 v61, v197, v29, v61
    v_dot2_f32_bf16 v61, v198, v30, v61
    v_dot2_f32_bf16 v61, v199, v31, v61
    s_mov_b32 s68, 770048
    buffer_load_dwordx4 v[216:219], v4, s[32:35], s68 offen offset:2048 nt
    v_add_f32_dpp v62, v60, v60 row_ror:8 row_mask:0xf bank_mask:0x3
    s_nop 1
    v_add_f32_dpp v62, v61, v61 row_ror:8 row_mask:0xf bank_mask:0xc
    v_and_b32_dpp v12, v55, v8 row_newbcast:0 row_mask:0xf bank_mask:0xf
    v_and_b32_dpp v13, v55, v9 row_newbcast:0 row_mask:0xf bank_mask:0xf
    v_and_b32_dpp v14, v55, v10 row_newbcast:0 row_mask:0xf bank_mask:0xf
    v_and_b32_dpp v15, v55, v11 row_newbcast:0 row_mask:0xf bank_mask:0xf
    s_nop 1
    v_mfma_f32_16x16x32_bf16 v[24:27], v[12:15], a[192:195], v[24:27]
    s_waitcnt vmcnt(6)
    v_dot2_f32_bf16 v60, v200, v28, 0
    v_dot2_f32_bf16 v60, v201, v29, v60
    v_dot2_f32_bf16 v60, v202, v30, v60
    v_dot2_f32_bf16 v60, v203, v31, v60
    s_mov_b32 s68, 770048
    buffer_load_dwordx4 v[220:223], v4, s[32:35], s68 offen offset:3072 nt
    s_mov_b32 s68, 1519616
    buffer_load_dwordx4 a[212:215], v6, s[44:47], s68 offen
    s_waitcnt vmcnt(7)
    v_dot2_f32_bf16 v61, v204, v28, 0
    v_dot2_f32_bf16 v61, v205, v29, v61
    v_dot2_f32_bf16 v61, v206, v30, v61
    v_dot2_f32_bf16 v61, v207, v31, v61
    s_mov_b32 s68, 786432
    buffer_load_dwordx4 v[224:227], v4, s[32:35], s68 offen nt
    v_add_f32_dpp v60, v60, v60 row_ror:8 row_mask:0xf bank_mask:0x3
    s_nop 1
    v_add_f32_dpp v60, v61, v61 row_ror:8 row_mask:0xf bank_mask:0xc
    v_add_f32_dpp v63, v62, v62 row_ror:12 row_mask:0xf bank_mask:0x5
    s_nop 1
    v_add_f32_dpp v63, v60, v60 row_ror:4 row_mask:0xf bank_mask:0xa
    v_and_b32_dpp v16, v55, v8 row_newbcast:1 row_mask:0xf bank_mask:0xf
    v_and_b32_dpp v17, v55, v9 row_newbcast:1 row_mask:0xf bank_mask:0xf
    v_and_b32_dpp v18, v55, v10 row_newbcast:1 row_mask:0xf bank_mask:0xf
    v_and_b32_dpp v19, v55, v11 row_newbcast:1 row_mask:0xf bank_mask:0xf
    s_nop 1
    v_mfma_f32_16x16x32_bf16 v[24:27], v[16:19], a[196:199], v[24:27]
    s_waitcnt vmcnt(6)
    v_dot2_f32_bf16 v60, v208, v28, 0
    v_dot2_f32_bf16 v60, v209, v29, v60
    v_dot2_f32_bf16 v60, v210, v30, v60
    v_dot2_f32_bf16 v60, v211, v31, v60
    s_mov_b32 s68, 786432
    buffer_load_dwordx4 v[228:231], v4, s[32:35], s68 offen offset:1024 nt
    s_mov_b32 s68, 1548288
    buffer_load_dwordx4 a[216:219], v6, s[44:47], s68 offen
    s_waitcnt vmcnt(7)
    v_dot2_f32_bf16 v61, v212, v28, 0
    v_dot2_f32_bf16 v61, v213, v29, v61
    v_dot2_f32_bf16 v61, v214, v30, v61
    v_dot2_f32_bf16 v61, v215, v31, v61
    s_mov_b32 s68, 786432
    buffer_load_dwordx4 v[232:235], v4, s[32:35], s68 offen offset:2048 nt
    v_add_f32_dpp v62, v60, v60 row_ror:8 row_mask:0xf bank_mask:0x3
    s_nop 1
    v_add_f32_dpp v62, v61, v61 row_ror:8 row_mask:0xf bank_mask:0xc
    v_and_b32_dpp v12, v55, v8 row_newbcast:2 row_mask:0xf bank_mask:0xf
    v_and_b32_dpp v13, v55, v9 row_newbcast:2 row_mask:0xf bank_mask:0xf
    v_and_b32_dpp v14, v55, v10 row_newbcast:2 row_mask:0xf bank_mask:0xf
    v_and_b32_dpp v15, v55, v11 row_newbcast:2 row_mask:0xf bank_mask:0xf
    s_nop 1
    v_mfma_f32_16x16x32_bf16 v[24:27], v[12:15], a[200:203], v[24:27]
    s_waitcnt vmcnt(6)
    v_dot2_f32_bf16 v60, v216, v28, 0
    v_dot2_f32_bf16 v60, v217, v29, v60
    v_dot2_f32_bf16 v60, v218, v30, v60
    v_dot2_f32_bf16 v60, v219, v31, v60
    s_mov_b32 s68, 786432
    buffer_load_dwordx4 v[236:239], v4, s[32:35], s68 offen offset:3072 nt
    s_mov_b32 s68, 1576960
    buffer_load_dwordx4 a[220:223], v6, s[44:47], s68 offen
    s_waitcnt vmcnt(7)
    v_dot2_f32_bf16 v61, v220, v28, 0
    v_dot2_f32_bf16 v61, v221, v29, v61
    v_dot2_f32_bf16 v61, v222, v30, v61
    v_dot2_f32_bf16 v61, v223, v31, v61
    s_mov_b32 s68, 802816
    buffer_load_dwordx4 v[80:83], v4, s[32:35], s68 offen nt
    v_add_f32_dpp v60, v60, v60 row_ror:8 row_mask:0xf bank_mask:0x3
    s_nop 1
    v_add_f32_dpp v60, v61, v61 row_ror:8 row_mask:0xf bank_mask:0xc
    v_add_f32_dpp v62, v62, v62 row_ror:12 row_mask:0xf bank_mask:0x5
    s_nop 1
    v_add_f32_dpp v62, v60, v60 row_ror:4 row_mask:0xf bank_mask:0xa
    v_add_f32_dpp v60, v63, v63 quad_perm:[2,3,0,1] row_mask:0xf bank_mask:0xf
    s_nop 0
    v_add_f32_dpp v61, v62, v62 quad_perm:[2,3,0,1] row_mask:0xf bank_mask:0xf
    v_cndmask_b32 v63, v60, v61, s[80:81]
    v_add_f32_dpp v60, v64, v64 quad_perm:[1,0,3,2] row_mask:0xf bank_mask:0xf
    s_nop 0
    v_add_f32_dpp v61, v63, v63 quad_perm:[1,0,3,2] row_mask:0xf bank_mask:0xf
    v_cndmask_b32 v43, v60, v61, s[82:83]
    v_cvt_pk_bf16_f32 v43, 0, v43
    v_mul_f32 v43, 0x3db504f3, v43
    v_cvt_pk_bf16_f32 v43, 0, v43
    v_and_b32_dpp v16, v55, v8 row_newbcast:3 row_mask:0xf bank_mask:0xf
    v_and_b32_dpp v17, v55, v9 row_newbcast:3 row_mask:0xf bank_mask:0xf
    v_and_b32_dpp v18, v55, v10 row_newbcast:3 row_mask:0xf bank_mask:0xf
    v_and_b32_dpp v19, v55, v11 row_newbcast:3 row_mask:0xf bank_mask:0xf
    s_nop 1
    v_mfma_f32_16x16x32_bf16 v[24:27], v[16:19], a[204:207], v[24:27]
    s_waitcnt vmcnt(6)
    v_dot2_f32_bf16 v60, v224, v28, 0
    v_dot2_f32_bf16 v60, v225, v29, v60
    v_dot2_f32_bf16 v60, v226, v30, v60
    v_dot2_f32_bf16 v60, v227, v31, v60
    s_mov_b32 s68, 802816
    buffer_load_dwordx4 v[84:87], v4, s[32:35], s68 offen offset:1024 nt
    s_mov_b32 s68, 1605632
    buffer_load_dwordx4 a[224:227], v6, s[44:47], s68 offen
    s_waitcnt vmcnt(7)
    v_dot2_f32_bf16 v61, v228, v28, 0
    v_dot2_f32_bf16 v61, v229, v29, v61
    v_dot2_f32_bf16 v61, v230, v30, v61
    v_dot2_f32_bf16 v61, v231, v31, v61
    s_mov_b32 s68, 802816
    buffer_load_dwordx4 v[88:91], v4, s[32:35], s68 offen offset:2048 nt
    v_add_f32_dpp v62, v60, v60 row_ror:8 row_mask:0xf bank_mask:0x3
    s_nop 1
    v_add_f32_dpp v62, v61, v61 row_ror:8 row_mask:0xf bank_mask:0xc
    v_and_b32_dpp v12, v55, v8 row_newbcast:4 row_mask:0xf bank_mask:0xf
    v_and_b32_dpp v13, v55, v9 row_newbcast:4 row_mask:0xf bank_mask:0xf
    v_and_b32_dpp v14, v55, v10 row_newbcast:4 row_mask:0xf bank_mask:0xf
    v_and_b32_dpp v15, v55, v11 row_newbcast:4 row_mask:0xf bank_mask:0xf
    s_nop 1
    v_mfma_f32_16x16x32_bf16 v[24:27], v[12:15], a[208:211], v[24:27]
    s_waitcnt vmcnt(6)
    v_dot2_f32_bf16 v60, v232, v28, 0
    v_dot2_f32_bf16 v60, v233, v29, v60
    v_dot2_f32_bf16 v60, v234, v30, v60
    v_dot2_f32_bf16 v60, v235, v31, v60
    s_mov_b32 s68, 802816
    buffer_load_dwordx4 v[92:95], v4, s[32:35], s68 offen offset:3072 nt
    s_mov_b32 s68, 1634304
    buffer_load_dwordx4 a[228:231], v6, s[44:47], s68 offen
    s_waitcnt vmcnt(7)
    v_dot2_f32_bf16 v61, v236, v28, 0
    v_dot2_f32_bf16 v61, v237, v29, v61
    v_dot2_f32_bf16 v61, v238, v30, v61
    v_dot2_f32_bf16 v61, v239, v31, v61
    s_mov_b32 s68, 819200
    buffer_load_dwordx4 v[96:99], v4, s[32:35], s68 offen nt
    v_add_f32_dpp v60, v60, v60 row_ror:8 row_mask:0xf bank_mask:0x3
    s_nop 1
    v_add_f32_dpp v60, v61, v61 row_ror:8 row_mask:0xf bank_mask:0xc
    v_add_f32_dpp v63, v62, v62 row_ror:12 row_mask:0xf bank_mask:0x5
    s_nop 1
    v_add_f32_dpp v63, v60, v60 row_ror:4 row_mask:0xf bank_mask:0xa
    v_and_b32_dpp v16, v55, v8 row_newbcast:5 row_mask:0xf bank_mask:0xf
    v_and_b32_dpp v17, v55, v9 row_newbcast:5 row_mask:0xf bank_mask:0xf
    v_and_b32_dpp v18, v55, v10 row_newbcast:5 row_mask:0xf bank_mask:0xf
    v_and_b32_dpp v19, v55, v11 row_newbcast:5 row_mask:0xf bank_mask:0xf
    s_nop 1
    v_mfma_f32_16x16x32_bf16 v[24:27], v[16:19], a[212:215], v[24:27]
    s_waitcnt vmcnt(6)
    v_dot2_f32_bf16 v60, v80, v28, 0
    v_dot2_f32_bf16 v60, v81, v29, v60
    v_dot2_f32_bf16 v60, v82, v30, v60
    v_dot2_f32_bf16 v60, v83, v31, v60
    s_mov_b32 s68, 819200
    buffer_load_dwordx4 v[100:103], v4, s[32:35], s68 offen offset:1024 nt
    s_mov_b32 s68, 1662976
    buffer_load_dwordx4 a[232:235], v6, s[44:47], s68 offen
    s_waitcnt vmcnt(7)
    v_dot2_f32_bf16 v61, v84, v28, 0
    v_dot2_f32_bf16 v61, v85, v29, v61
    v_dot2_f32_bf16 v61, v86, v30, v61
    v_dot2_f32_bf16 v61, v87, v31, v61
    s_mov_b32 s68, 819200
    buffer_load_dwordx4 v[104:107], v4, s[32:35], s68 offen offset:2048 nt
    v_add_f32_dpp v62, v60, v60 row_ror:8 row_mask:0xf bank_mask:0x3
    s_nop 1
    v_add_f32_dpp v62, v61, v61 row_ror:8 row_mask:0xf bank_mask:0xc
    v_and_b32_dpp v12, v55, v8 row_newbcast:6 row_mask:0xf bank_mask:0xf
    v_and_b32_dpp v13, v55, v9 row_newbcast:6 row_mask:0xf bank_mask:0xf
    v_and_b32_dpp v14, v55, v10 row_newbcast:6 row_mask:0xf bank_mask:0xf
    v_and_b32_dpp v15, v55, v11 row_newbcast:6 row_mask:0xf bank_mask:0xf
    s_nop 1
    v_mfma_f32_16x16x32_bf16 v[24:27], v[12:15], a[216:219], v[24:27]
    s_waitcnt vmcnt(6)
    v_dot2_f32_bf16 v60, v88, v28, 0
    v_dot2_f32_bf16 v60, v89, v29, v60
    v_dot2_f32_bf16 v60, v90, v30, v60
    v_dot2_f32_bf16 v60, v91, v31, v60
    s_mov_b32 s68, 819200
    buffer_load_dwordx4 v[108:111], v4, s[32:35], s68 offen offset:3072 nt
    s_mov_b32 s68, 1691648
    buffer_load_dwordx4 a[236:239], v6, s[44:47], s68 offen
    s_waitcnt vmcnt(7)
    v_dot2_f32_bf16 v61, v92, v28, 0
    v_dot2_f32_bf16 v61, v93, v29, v61
    v_dot2_f32_bf16 v61, v94, v30, v61
    v_dot2_f32_bf16 v61, v95, v31, v61
    s_mov_b32 s68, 835584
    buffer_load_dwordx4 v[112:115], v4, s[32:35], s68 offen nt
    v_add_f32_dpp v60, v60, v60 row_ror:8 row_mask:0xf bank_mask:0x3
    s_nop 1
    v_add_f32_dpp v60, v61, v61 row_ror:8 row_mask:0xf bank_mask:0xc
    v_add_f32_dpp v62, v62, v62 row_ror:12 row_mask:0xf bank_mask:0x5
    s_nop 1
    v_add_f32_dpp v62, v60, v60 row_ror:4 row_mask:0xf bank_mask:0xa
    v_add_f32_dpp v60, v63, v63 quad_perm:[2,3,0,1] row_mask:0xf bank_mask:0xf
    s_nop 0
    v_add_f32_dpp v61, v62, v62 quad_perm:[2,3,0,1] row_mask:0xf bank_mask:0xf
    v_cndmask_b32 v64, v60, v61, s[80:81]
    v_and_b32_dpp v16, v55, v8 row_newbcast:7 row_mask:0xf bank_mask:0xf
    v_and_b32_dpp v17, v55, v9 row_newbcast:7 row_mask:0xf bank_mask:0xf
    v_and_b32_dpp v18, v55, v10 row_newbcast:7 row_mask:0xf bank_mask:0xf
    v_and_b32_dpp v19, v55, v11 row_newbcast:7 row_mask:0xf bank_mask:0xf
    s_nop 1
    v_mfma_f32_16x16x32_bf16 v[24:27], v[16:19], a[220:223], v[24:27]
    s_waitcnt vmcnt(6)
    v_dot2_f32_bf16 v60, v96, v28, 0
    v_dot2_f32_bf16 v60, v97, v29, v60
    v_dot2_f32_bf16 v60, v98, v30, v60
    v_dot2_f32_bf16 v60, v99, v31, v60
    s_mov_b32 s68, 835584
    buffer_load_dwordx4 v[116:119], v4, s[32:35], s68 offen offset:1024 nt
    s_mov_b32 s68, 1720320
    buffer_load_dwordx4 a[240:243], v6, s[44:47], s68 offen
    s_waitcnt vmcnt(7)
    v_dot2_f32_bf16 v61, v100, v28, 0
    v_dot2_f32_bf16 v61, v101, v29, v61
    v_dot2_f32_bf16 v61, v102, v30, v61
    v_dot2_f32_bf16 v61, v103, v31, v61
    s_mov_b32 s68, 835584
    buffer_load_dwordx4 v[120:123], v4, s[32:35], s68 offen offset:2048 nt
    v_add_f32_dpp v62, v60, v60 row_ror:8 row_mask:0xf bank_mask:0x3
    s_nop 1
    v_add_f32_dpp v62, v61, v61 row_ror:8 row_mask:0xf bank_mask:0xc
    v_and_b32_dpp v12, v55, v8 row_newbcast:8 row_mask:0xf bank_mask:0xf
    v_and_b32_dpp v13, v55, v9 row_newbcast:8 row_mask:0xf bank_mask:0xf
    v_and_b32_dpp v14, v55, v10 row_newbcast:8 row_mask:0xf bank_mask:0xf
    v_and_b32_dpp v15, v55, v11 row_newbcast:8 row_mask:0xf bank_mask:0xf
    s_nop 1
    v_mfma_f32_16x16x32_bf16 v[24:27], v[12:15], a[224:227], v[24:27]
    s_waitcnt vmcnt(6)
    v_dot2_f32_bf16 v60, v104, v28, 0
    v_dot2_f32_bf16 v60, v105, v29, v60
    v_dot2_f32_bf16 v60, v106, v30, v60
    v_dot2_f32_bf16 v60, v107, v31, v60
    s_mov_b32 s68, 835584
    buffer_load_dwordx4 v[124:127], v4, s[32:35], s68 offen offset:3072 nt
    s_mov_b32 s68, 1748992
    buffer_load_dwordx4 a[244:247], v6, s[44:47], s68 offen
    s_waitcnt vmcnt(7)
    v_dot2_f32_bf16 v61, v108, v28, 0
    v_dot2_f32_bf16 v61, v109, v29, v61
    v_dot2_f32_bf16 v61, v110, v30, v61
    v_dot2_f32_bf16 v61, v111, v31, v61
    s_mov_b32 s68, 851968
    buffer_load_dwordx4 v[128:131], v4, s[32:35], s68 offen nt
    v_add_f32_dpp v60, v60, v60 row_ror:8 row_mask:0xf bank_mask:0x3
    s_nop 1
    v_add_f32_dpp v60, v61, v61 row_ror:8 row_mask:0xf bank_mask:0xc
    v_add_f32_dpp v63, v62, v62 row_ror:12 row_mask:0xf bank_mask:0x5
    s_nop 1
    v_add_f32_dpp v63, v60, v60 row_ror:4 row_mask:0xf bank_mask:0xa
    v_and_b32_dpp v16, v55, v8 row_newbcast:9 row_mask:0xf bank_mask:0xf
    v_and_b32_dpp v17, v55, v9 row_newbcast:9 row_mask:0xf bank_mask:0xf
    v_and_b32_dpp v18, v55, v10 row_newbcast:9 row_mask:0xf bank_mask:0xf
    v_and_b32_dpp v19, v55, v11 row_newbcast:9 row_mask:0xf bank_mask:0xf
    s_nop 1
    v_mfma_f32_16x16x32_bf16 v[24:27], v[16:19], a[228:231], v[24:27]
    s_waitcnt vmcnt(6)
    v_dot2_f32_bf16 v60, v112, v28, 0
    v_dot2_f32_bf16 v60, v113, v29, v60
    v_dot2_f32_bf16 v60, v114, v30, v60
    v_dot2_f32_bf16 v60, v115, v31, v60
    s_mov_b32 s68, 851968
    buffer_load_dwordx4 v[132:135], v4, s[32:35], s68 offen offset:1024 nt
    s_mov_b32 s68, 1777664
    buffer_load_dwordx4 a[248:251], v6, s[44:47], s68 offen
    s_waitcnt vmcnt(7)
    v_dot2_f32_bf16 v61, v116, v28, 0
    v_dot2_f32_bf16 v61, v117, v29, v61
    v_dot2_f32_bf16 v61, v118, v30, v61
    v_dot2_f32_bf16 v61, v119, v31, v61
    s_mov_b32 s68, 851968
    buffer_load_dwordx4 v[136:139], v4, s[32:35], s68 offen offset:2048 nt
    v_add_f32_dpp v62, v60, v60 row_ror:8 row_mask:0xf bank_mask:0x3
    s_nop 1
    v_add_f32_dpp v62, v61, v61 row_ror:8 row_mask:0xf bank_mask:0xc
    v_and_b32_dpp v12, v55, v8 row_newbcast:10 row_mask:0xf bank_mask:0xf
    v_and_b32_dpp v13, v55, v9 row_newbcast:10 row_mask:0xf bank_mask:0xf
    v_and_b32_dpp v14, v55, v10 row_newbcast:10 row_mask:0xf bank_mask:0xf
    v_and_b32_dpp v15, v55, v11 row_newbcast:10 row_mask:0xf bank_mask:0xf
    s_nop 1
    v_mfma_f32_16x16x32_bf16 v[24:27], v[12:15], a[232:235], v[24:27]
    s_waitcnt vmcnt(6)
    v_dot2_f32_bf16 v60, v120, v28, 0
    v_dot2_f32_bf16 v60, v121, v29, v60
    v_dot2_f32_bf16 v60, v122, v30, v60
    v_dot2_f32_bf16 v60, v123, v31, v60
    s_mov_b32 s68, 851968
    buffer_load_dwordx4 v[140:143], v4, s[32:35], s68 offen offset:3072 nt
    s_mov_b32 s68, 1806336
    buffer_load_dwordx4 a[252:255], v6, s[44:47], s68 offen
    s_waitcnt vmcnt(7)
    v_dot2_f32_bf16 v61, v124, v28, 0
    v_dot2_f32_bf16 v61, v125, v29, v61
    v_dot2_f32_bf16 v61, v126, v30, v61
    v_dot2_f32_bf16 v61, v127, v31, v61
    s_mov_b32 s68, 868352
    buffer_load_dwordx4 v[144:147], v4, s[32:35], s68 offen nt
    v_add_f32_dpp v60, v60, v60 row_ror:8 row_mask:0xf bank_mask:0x3
    s_nop 1
    v_add_f32_dpp v60, v61, v61 row_ror:8 row_mask:0xf bank_mask:0xc
    v_add_f32_dpp v62, v62, v62 row_ror:12 row_mask:0xf bank_mask:0x5
    s_nop 1
    v_add_f32_dpp v62, v60, v60 row_ror:4 row_mask:0xf bank_mask:0xa
    v_add_f32_dpp v60, v63, v63 quad_perm:[2,3,0,1] row_mask:0xf bank_mask:0xf
    s_nop 0
    v_add_f32_dpp v61, v62, v62 quad_perm:[2,3,0,1] row_mask:0xf bank_mask:0xf
    v_cndmask_b32 v63, v60, v61, s[80:81]
    v_add_f32_dpp v60, v64, v64 quad_perm:[1,0,3,2] row_mask:0xf bank_mask:0xf
    s_nop 0
    v_add_f32_dpp v61, v63, v63 quad_perm:[1,0,3,2] row_mask:0xf bank_mask:0xf
    v_cndmask_b32 v44, v60, v61, s[82:83]
    v_cvt_pk_bf16_f32 v44, 0, v44
    v_mul_f32 v44, 0x3db504f3, v44
    v_cvt_pk_bf16_f32 v44, 0, v44
    v_and_b32_dpp v16, v55, v8 row_newbcast:11 row_mask:0xf bank_mask:0xf
    v_and_b32_dpp v17, v55, v9 row_newbcast:11 row_mask:0xf bank_mask:0xf
    v_and_b32_dpp v18, v55, v10 row_newbcast:11 row_mask:0xf bank_mask:0xf
    v_and_b32_dpp v19, v55, v11 row_newbcast:11 row_mask:0xf bank_mask:0xf
    s_nop 1
    v_mfma_f32_16x16x32_bf16 v[24:27], v[16:19], a[236:239], v[24:27]
    s_waitcnt vmcnt(6)
    v_dot2_f32_bf16 v60, v128, v28, 0
    v_dot2_f32_bf16 v60, v129, v29, v60
    v_dot2_f32_bf16 v60, v130, v30, v60
    v_dot2_f32_bf16 v60, v131, v31, v60
    s_mov_b32 s68, 868352
    buffer_load_dwordx4 v[148:151], v4, s[32:35], s68 offen offset:1024 nt
    s_mov_b32 s68, 0
    buffer_load_dwordx4 a[0:3], v7, s[48:51], s68 offen
    buffer_load_dwordx4 a[4:7], v7, s[48:51], s68 offen offset:256
    s_waitcnt vmcnt(8)
    v_dot2_f32_bf16 v61, v132, v28, 0
    v_dot2_f32_bf16 v61, v133, v29, v61
    v_dot2_f32_bf16 v61, v134, v30, v61
    v_dot2_f32_bf16 v61, v135, v31, v61
    s_mov_b32 s68, 868352
    buffer_load_dwordx4 v[152:155], v4, s[32:35], s68 offen offset:2048 nt
    v_add_f32_dpp v62, v60, v60 row_ror:8 row_mask:0xf bank_mask:0x3
    s_nop 1
    v_add_f32_dpp v62, v61, v61 row_ror:8 row_mask:0xf bank_mask:0xc
    v_and_b32_dpp v12, v55, v8 row_newbcast:12 row_mask:0xf bank_mask:0xf
    v_and_b32_dpp v13, v55, v9 row_newbcast:12 row_mask:0xf bank_mask:0xf
    v_and_b32_dpp v14, v55, v10 row_newbcast:12 row_mask:0xf bank_mask:0xf
    v_and_b32_dpp v15, v55, v11 row_newbcast:12 row_mask:0xf bank_mask:0xf
    s_nop 1
    v_mfma_f32_16x16x32_bf16 v[24:27], v[12:15], a[240:243], v[24:27]
    s_waitcnt vmcnt(7)
    v_dot2_f32_bf16 v60, v136, v28, 0
    v_dot2_f32_bf16 v60, v137, v29, v60
    v_dot2_f32_bf16 v60, v138, v30, v60
    v_dot2_f32_bf16 v60, v139, v31, v60
    s_mov_b32 s68, 868352
    buffer_load_dwordx4 v[156:159], v4, s[32:35], s68 offen offset:3072 nt
    s_mov_b32 s68, 884736
    buffer_load_dwordx4 v[160:163], v4, s[32:35], s68 offen nt
    s_waitcnt vmcnt(8)
    v_dot2_f32_bf16 v61, v140, v28, 0
    v_dot2_f32_bf16 v61, v141, v29, v61
    v_dot2_f32_bf16 v61, v142, v30, v61
    v_dot2_f32_bf16 v61, v143, v31, v61
    s_mov_b32 s68, 884736
    buffer_load_dwordx4 v[164:167], v4, s[32:35], s68 offen offset:1024 nt
    s_mov_b32 s68, 884736
    buffer_load_dwordx4 v[168:171], v4, s[32:35], s68 offen offset:2048 nt
    v_add_f32_dpp v60, v60, v60 row_ror:8 row_mask:0xf bank_mask:0x3
    s_nop 1
    v_add_f32_dpp v60, v61, v61 row_ror:8 row_mask:0xf bank_mask:0xc
    v_add_f32_dpp v63, v62, v62 row_ror:12 row_mask:0xf bank_mask:0x5
    s_nop 1
    v_add_f32_dpp v63, v60, v60 row_ror:4 row_mask:0xf bank_mask:0xa
    v_and_b32_dpp v16, v55, v8 row_newbcast:13 row_mask:0xf bank_mask:0xf
    v_and_b32_dpp v17, v55, v9 row_newbcast:13 row_mask:0xf bank_mask:0xf
    v_and_b32_dpp v18, v55, v10 row_newbcast:13 row_mask:0xf bank_mask:0xf
    v_and_b32_dpp v19, v55, v11 row_newbcast:13 row_mask:0xf bank_mask:0xf
    s_nop 1
    v_mfma_f32_16x16x32_bf16 v[24:27], v[16:19], a[244:247], v[24:27]
    s_waitcnt vmcnt(8)
    v_dot2_f32_bf16 v60, v144, v28, 0
    v_dot2_f32_bf16 v60, v145, v29, v60
    v_dot2_f32_bf16 v60, v146, v30, v60
    v_dot2_f32_bf16 v60, v147, v31, v60
    s_mov_b32 s68, 884736
    buffer_load_dwordx4 v[172:175], v4, s[32:35], s68 offen offset:3072 nt
    s_mov_b32 s68, 901120
    buffer_load_dwordx4 v[176:179], v4, s[32:35], s68 offen nt
    s_mov_b32 s68, 8192
    buffer_load_dwordx4 a[8:11], v7, s[48:51], s68 offen
    buffer_load_dwordx4 a[12:15], v7, s[48:51], s68 offen offset:256
    s_waitcnt vmcnt(11)
    v_dot2_f32_bf16 v61, v148, v28, 0
    v_dot2_f32_bf16 v61, v149, v29, v61
    v_dot2_f32_bf16 v61, v150, v30, v61
    v_dot2_f32_bf16 v61, v151, v31, v61
    s_mov_b32 s68, 901120
    buffer_load_dwordx4 v[180:183], v4, s[32:35], s68 offen offset:1024 nt
    s_mov_b32 s68, 901120
    buffer_load_dwordx4 v[184:187], v4, s[32:35], s68 offen offset:2048 nt
    v_add_f32_dpp v62, v60, v60 row_ror:8 row_mask:0xf bank_mask:0x3
    s_nop 1
    v_add_f32_dpp v62, v61, v61 row_ror:8 row_mask:0xf bank_mask:0xc
    v_and_b32_dpp v12, v55, v8 row_newbcast:14 row_mask:0xf bank_mask:0xf
    v_and_b32_dpp v13, v55, v9 row_newbcast:14 row_mask:0xf bank_mask:0xf
    v_and_b32_dpp v14, v55, v10 row_newbcast:14 row_mask:0xf bank_mask:0xf
    v_and_b32_dpp v15, v55, v11 row_newbcast:14 row_mask:0xf bank_mask:0xf
    s_nop 1
    v_mfma_f32_16x16x32_bf16 v[24:27], v[12:15], a[248:251], v[24:27]
    s_waitcnt vmcnt(10)
    v_dot2_f32_bf16 v60, v152, v28, 0
    v_dot2_f32_bf16 v60, v153, v29, v60
    v_dot2_f32_bf16 v60, v154, v30, v60
    v_dot2_f32_bf16 v60, v155, v31, v60
    s_mov_b32 s68, 901120
    buffer_load_dwordx4 v[188:191], v4, s[32:35], s68 offen offset:3072 nt
    s_mov_b32 s68, 917504
    buffer_load_dwordx4 v[192:195], v4, s[32:35], s68 offen nt
    s_waitcnt vmcnt(11)
    v_dot2_f32_bf16 v61, v156, v28, 0
    v_dot2_f32_bf16 v61, v157, v29, v61
    v_dot2_f32_bf16 v61, v158, v30, v61
    v_dot2_f32_bf16 v61, v159, v31, v61
    s_mov_b32 s68, 917504
    buffer_load_dwordx4 v[196:199], v4, s[32:35], s68 offen offset:1024 nt
    s_mov_b32 s68, 917504
    buffer_load_dwordx4 v[200:203], v4, s[32:35], s68 offen offset:2048 nt
    v_add_f32_dpp v60, v60, v60 row_ror:8 row_mask:0xf bank_mask:0x3
    s_nop 1
    v_add_f32_dpp v60, v61, v61 row_ror:8 row_mask:0xf bank_mask:0xc
    v_add_f32_dpp v62, v62, v62 row_ror:12 row_mask:0xf bank_mask:0x5
    s_nop 1
    v_add_f32_dpp v62, v60, v60 row_ror:4 row_mask:0xf bank_mask:0xa
    v_add_f32_dpp v60, v63, v63 quad_perm:[2,3,0,1] row_mask:0xf bank_mask:0xf
    s_nop 0
    v_add_f32_dpp v61, v62, v62 quad_perm:[2,3,0,1] row_mask:0xf bank_mask:0xf
    v_cndmask_b32 v64, v60, v61, s[80:81]
    v_and_b32_dpp v16, v55, v8 row_newbcast:15 row_mask:0xf bank_mask:0xf
    v_and_b32_dpp v17, v55, v9 row_newbcast:15 row_mask:0xf bank_mask:0xf
    v_and_b32_dpp v18, v55, v10 row_newbcast:15 row_mask:0xf bank_mask:0xf
    v_and_b32_dpp v19, v55, v11 row_newbcast:15 row_mask:0xf bank_mask:0xf
    s_nop 1
    v_mfma_f32_16x16x32_bf16 v[24:27], v[16:19], a[252:255], v[24:27]
    s_waitcnt vmcnt(12)
    v_dot2_f32_bf16 v60, v160, v28, 0
    v_dot2_f32_bf16 v60, v161, v29, v60
    v_dot2_f32_bf16 v60, v162, v30, v60
    v_dot2_f32_bf16 v60, v163, v31, v60
    s_mov_b32 s68, 917504
    buffer_load_dwordx4 v[204:207], v4, s[32:35], s68 offen offset:3072 nt
    s_mov_b32 s68, 16384
    buffer_load_dwordx4 a[16:19], v7, s[48:51], s68 offen
    buffer_load_dwordx4 a[20:23], v7, s[48:51], s68 offen offset:256
    s_waitcnt vmcnt(14)
    v_dot2_f32_bf16 v61, v164, v28, 0
    v_dot2_f32_bf16 v61, v165, v29, v61
    v_dot2_f32_bf16 v61, v166, v30, v61
    v_dot2_f32_bf16 v61, v167, v31, v61
    s_mov_b32 s68, 933888
    buffer_load_dwordx4 v[208:211], v4, s[32:35], s68 offen nt
    v_add_f32_dpp v62, v60, v60 row_ror:8 row_mask:0xf bank_mask:0x3
    s_nop 1
    v_add_f32_dpp v62, v61, v61 row_ror:8 row_mask:0xf bank_mask:0xc
    v_and_b32 v65, 1, v3
    v_lshlrev_b32 v65, 6, v65
    v_lshl_add_u32 v65, v2, 7, v65
    s_lshl_b32 s72, s3, 2
    v_add_u32 v65, s72, v65
    s_mov_b32 exec_hi, 0
    ds_write_b32 v65, v24 offset:2048
    ds_write_b32 v65, v25 offset:2064
    ds_write_b32 v65, v26 offset:2080
    ds_write_b32 v65, v27 offset:2096
    s_mov_b32 exec_hi, -1
    s_waitcnt lgkmcnt(0)
    s_barrier
    v_lshl_add_u32 v66, v2, 2, v3
    v_lshlrev_b32 v66, 4, v66
    ds_read_b128 v[12:15], v66 offset:2048
    ds_read_b128 v[16:19], v66 offset:3072
    s_waitcnt lgkmcnt(0)
    v_add_f32 v12, v12, v13
    v_add_f32 v14, v14, v15
    v_add_f32 v56, v12, v14
    v_cvt_pk_bf16_f32 v56, 0, v56
    v_lshlrev_b32 v71, 16, v58
    v_add_f32 v56, v56, v71
    v_cvt_pk_bf16_f32 v56, 0, v56
    v_mul_f32 v72, v56, v56
    v_mul_f32 v72, v72, v56
    v_mul_f32 v72, 0x3d372713, v72
    v_add_f32 v72, v72, v56
    v_mul_f32 v72, 0x3f4c422a, v72
    v_mul_f32 v72, 0x4038aa3b, v72
    v_exp_f32 v72, v72
    s_nop 0
    v_add_f32 v72, 1.0, v72
    v_rcp_f32 v72, v72
    s_nop 0
    v_fma_f32 v72, v72, -2.0, 2.0
    v_mul_f32 v71, 0.5, v56
    v_mul_f32 v56, v71, v72
    v_cvt_pk_bf16_f32 v56, v56, v56
    v_add_f32 v16, v16, v17
    v_add_f32 v18, v18, v19
    v_add_f32 v57, v16, v18
    v_cvt_pk_bf16_f32 v57, 0, v57
    v_lshlrev_b32 v71, 16, v59
    v_add_f32 v57, v57, v71
    v_cvt_pk_bf16_f32 v57, 0, v57
    v_mul_f32 v72, v57, v57
    v_mul_f32 v72, v72, v57
    v_mul_f32 v72, 0x3d372713, v72
    v_add_f32 v72, v72, v57
    v_mul_f32 v72, 0x3f4c422a, v72
    v_mul_f32 v72, 0x4038aa3b, v72
    v_exp_f32 v72, v72
    s_nop 0
    v_add_f32 v72, 1.0, v72
    v_rcp_f32 v72, v72
    s_nop 0
    v_fma_f32 v72, v72, -2.0, 2.0
    v_mul_f32 v71, 0.5, v57
    v_mul_f32 v57, v71, v72
    v_cvt_pk_bf16_f32 v57, v57, v57
    s_waitcnt vmcnt(14)
    v_dot2_f32_bf16 v60, v168, v28, 0
    v_dot2_f32_bf16 v60, v169, v29, v60
    v_dot2_f32_bf16 v60, v170, v30, v60
    v_dot2_f32_bf16 v60, v171, v31, v60
    v_and_b32_dpp v12, v56, v8 row_newbcast:0 row_mask:0xf bank_mask:0xf
    v_and_b32_dpp v13, v56, v9 row_newbcast:0 row_mask:0xf bank_mask:0xf
    v_and_b32_dpp v14, v56, v10 row_newbcast:0 row_mask:0xf bank_mask:0xf
    v_and_b32_dpp v15, v56, v11 row_newbcast:0 row_mask:0xf bank_mask:0xf
    s_nop 1
    v_mfma_f32_16x16x32_bf16 v[20:23], v[12:15], a[0:3], 0
    v_mfma_f32_16x16x32_bf16 v[24:27], v[12:15], a[4:7], 0
    s_waitcnt vmcnt(13)
    v_dot2_f32_bf16 v61, v172, v28, 0
    v_dot2_f32_bf16 v61, v173, v29, v61
    v_dot2_f32_bf16 v61, v174, v30, v61
    v_dot2_f32_bf16 v61, v175, v31, v61
    v_add_f32_dpp v60, v60, v60 row_ror:8 row_mask:0xf bank_mask:0x3
    s_nop 1
    v_add_f32_dpp v60, v61, v61 row_ror:8 row_mask:0xf bank_mask:0xc
    v_add_f32_dpp v63, v62, v62 row_ror:12 row_mask:0xf bank_mask:0x5
    s_nop 1
    v_add_f32_dpp v63, v60, v60 row_ror:4 row_mask:0xf bank_mask:0xa
    s_waitcnt vmcnt(12)
    v_dot2_f32_bf16 v60, v176, v28, 0
    v_dot2_f32_bf16 v60, v177, v29, v60
    v_dot2_f32_bf16 v60, v178, v30, v60
    v_dot2_f32_bf16 v60, v179, v31, v60
    s_mov_b32 s68, 24576
    buffer_load_dwordx4 a[24:27], v7, s[48:51], s68 offen
    buffer_load_dwordx4 a[28:31], v7, s[48:51], s68 offen offset:256
    s_waitcnt vmcnt(11)
    v_dot2_f32_bf16 v61, v180, v28, 0
    v_dot2_f32_bf16 v61, v181, v29, v61
    v_dot2_f32_bf16 v61, v182, v30, v61
    v_dot2_f32_bf16 v61, v183, v31, v61
    v_add_f32_dpp v62, v60, v60 row_ror:8 row_mask:0xf bank_mask:0x3
    s_nop 1
    v_add_f32_dpp v62, v61, v61 row_ror:8 row_mask:0xf bank_mask:0xc
    v_and_b32_dpp v16, v56, v8 row_newbcast:1 row_mask:0xf bank_mask:0xf
    v_and_b32_dpp v17, v56, v9 row_newbcast:1 row_mask:0xf bank_mask:0xf
    v_and_b32_dpp v18, v56, v10 row_newbcast:1 row_mask:0xf bank_mask:0xf
    v_and_b32_dpp v19, v56, v11 row_newbcast:1 row_mask:0xf bank_mask:0xf
    s_nop 1
    v_mfma_f32_16x16x32_bf16 v[20:23], v[16:19], a[8:11], v[20:23]
    v_mfma_f32_16x16x32_bf16 v[24:27], v[16:19], a[12:15], v[24:27]
    s_waitcnt vmcnt(10)
    v_dot2_f32_bf16 v60, v184, v28, 0
    v_dot2_f32_bf16 v60, v185, v29, v60
    v_dot2_f32_bf16 v60, v186, v30, v60
    v_dot2_f32_bf16 v60, v187, v31, v60
    s_waitcnt vmcnt(9)
    v_dot2_f32_bf16 v61, v188, v28, 0
    v_dot2_f32_bf16 v61, v189, v29, v61
    v_dot2_f32_bf16 v61, v190, v30, v61
    v_dot2_f32_bf16 v61, v191, v31, v61
    v_add_f32_dpp v60, v60, v60 row_ror:8 row_mask:0xf bank_mask:0x3
    s_nop 1
    v_add_f32_dpp v60, v61, v61 row_ror:8 row_mask:0xf bank_mask:0xc
    v_add_f32_dpp v62, v62, v62 row_ror:12 row_mask:0xf bank_mask:0x5
    s_nop 1
    v_add_f32_dpp v62, v60, v60 row_ror:4 row_mask:0xf bank_mask:0xa
    v_add_f32_dpp v60, v63, v63 quad_perm:[2,3,0,1] row_mask:0xf bank_mask:0xf
    s_nop 0
    v_add_f32_dpp v61, v62, v62 quad_perm:[2,3,0,1] row_mask:0xf bank_mask:0xf
    v_cndmask_b32 v63, v60, v61, s[80:81]
    v_add_f32_dpp v60, v64, v64 quad_perm:[1,0,3,2] row_mask:0xf bank_mask:0xf
    s_nop 0
    v_add_f32_dpp v61, v63, v63 quad_perm:[1,0,3,2] row_mask:0xf bank_mask:0xf
    v_cndmask_b32 v45, v60, v61, s[82:83]
    v_cvt_pk_bf16_f32 v45, 0, v45
    v_mul_f32 v45, 0x3db504f3, v45
    v_cvt_pk_bf16_f32 v45, 0, v45
    s_waitcnt vmcnt(8)
    v_dot2_f32_bf16 v60, v192, v28, 0
    v_dot2_f32_bf16 v60, v193, v29, v60
    v_dot2_f32_bf16 v60, v194, v30, v60
    v_dot2_f32_bf16 v60, v195, v31, v60
    s_mov_b32 s68, 933888
    buffer_load_dwordx4 v[212:215], v4, s[32:35], s68 offen offset:1024 nt
    s_mov_b32 s68, 32768
    buffer_load_dwordx4 a[32:35], v7, s[48:51], s68 offen
    buffer_load_dwordx4 a[36:39], v7, s[48:51], s68 offen offset:256
    s_waitcnt vmcnt(10)
    v_dot2_f32_bf16 v61, v196, v28, 0
    v_dot2_f32_bf16 v61, v197, v29, v61
    v_dot2_f32_bf16 v61, v198, v30, v61
    v_dot2_f32_bf16 v61, v199, v31, v61
    s_mov_b32 s68, 933888
    buffer_load_dwordx4 v[216:219], v4, s[32:35], s68 offen offset:2048 nt
    v_add_f32_dpp v62, v60, v60 row_ror:8 row_mask:0xf bank_mask:0x3
    s_nop 1
    v_add_f32_dpp v62, v61, v61 row_ror:8 row_mask:0xf bank_mask:0xc
    s_waitcnt vmcnt(7)
    v_and_b32_dpp v12, v56, v8 row_newbcast:2 row_mask:0xf bank_mask:0xf
    v_and_b32_dpp v13, v56, v9 row_newbcast:2 row_mask:0xf bank_mask:0xf
    v_and_b32_dpp v14, v56, v10 row_newbcast:2 row_mask:0xf bank_mask:0xf
    v_and_b32_dpp v15, v56, v11 row_newbcast:2 row_mask:0xf bank_mask:0xf
    s_nop 1
    v_mfma_f32_16x16x32_bf16 v[20:23], v[12:15], a[16:19], v[20:23]
    v_mfma_f32_16x16x32_bf16 v[24:27], v[12:15], a[20:23], v[24:27]
    v_dot2_f32_bf16 v60, v200, v28, 0
    v_dot2_f32_bf16 v60, v201, v29, v60
    v_dot2_f32_bf16 v60, v202, v30, v60
    v_dot2_f32_bf16 v60, v203, v31, v60
    s_mov_b32 s68, 933888
    buffer_load_dwordx4 v[220:223], v4, s[32:35], s68 offen offset:3072 nt
    v_dot2_f32_bf16 v61, v204, v28, 0
    v_dot2_f32_bf16 v61, v205, v29, v61
    v_dot2_f32_bf16 v61, v206, v30, v61
    v_dot2_f32_bf16 v61, v207, v31, v61
    s_mov_b32 s68, 950272
    buffer_load_dwordx4 v[224:227], v4, s[32:35], s68 offen nt
    v_add_f32_dpp v60, v60, v60 row_ror:8 row_mask:0xf bank_mask:0x3
    s_nop 1
    v_add_f32_dpp v60, v61, v61 row_ror:8 row_mask:0xf bank_mask:0xc
    v_add_f32_dpp v63, v62, v62 row_ror:12 row_mask:0xf bank_mask:0x5
    s_nop 1
    v_add_f32_dpp v63, v60, v60 row_ror:4 row_mask:0xf bank_mask:0xa
    s_waitcnt vmcnt(8)
    v_dot2_f32_bf16 v60, v208, v28, 0
    v_dot2_f32_bf16 v60, v209, v29, v60
    v_dot2_f32_bf16 v60, v210, v30, v60
    v_dot2_f32_bf16 v60, v211, v31, v60
    s_mov_b32 s68, 950272
    buffer_load_dwordx4 v[228:231], v4, s[32:35], s68 offen offset:1024 nt
    s_mov_b32 s68, 40960
    buffer_load_dwordx4 a[40:43], v7, s[48:51], s68 offen
    buffer_load_dwordx4 a[44:47], v7, s[48:51], s68 offen offset:256
    s_waitcnt vmcnt(8)
    v_dot2_f32_bf16 v61, v212, v28, 0
    v_dot2_f32_bf16 v61, v213, v29, v61
    v_dot2_f32_bf16 v61, v214, v30, v61
    v_dot2_f32_bf16 v61, v215, v31, v61
    s_mov_b32 s68, 950272
    buffer_load_dwordx4 v[232:235], v4, s[32:35], s68 offen offset:2048 nt
    v_add_f32_dpp v62, v60, v60 row_ror:8 row_mask:0xf bank_mask:0x3
    s_nop 1
    v_add_f32_dpp v62, v61, v61 row_ror:8 row_mask:0xf bank_mask:0xc
    v_and_b32_dpp v16, v56, v8 row_newbcast:3 row_mask:0xf bank_mask:0xf
    v_and_b32_dpp v17, v56, v9 row_newbcast:3 row_mask:0xf bank_mask:0xf
    v_and_b32_dpp v18, v56, v10 row_newbcast:3 row_mask:0xf bank_mask:0xf
    v_and_b32_dpp v19, v56, v11 row_newbcast:3 row_mask:0xf bank_mask:0xf
    s_nop 1
    v_mfma_f32_16x16x32_bf16 v[20:23], v[16:19], a[24:27], v[20:23]
    v_mfma_f32_16x16x32_bf16 v[24:27], v[16:19], a[28:31], v[24:27]
    s_waitcnt vmcnt(6)
    v_dot2_f32_bf16 v60, v216, v28, 0
    v_dot2_f32_bf16 v60, v217, v29, v60
    v_dot2_f32_bf16 v60, v218, v30, v60
    v_dot2_f32_bf16 v60, v219, v31, v60
    s_mov_b32 s68, 950272
    buffer_load_dwordx4 v[236:239], v4, s[32:35], s68 offen offset:3072 nt
    s_waitcnt vmcnt(6)
    v_dot2_f32_bf16 v61, v220, v28, 0
    v_dot2_f32_bf16 v61, v221, v29, v61
    v_dot2_f32_bf16 v61, v222, v30, v61
    v_dot2_f32_bf16 v61, v223, v31, v61
    s_mov_b32 s68, 966656
    buffer_load_dwordx4 v[80:83], v4, s[32:35], s68 offen nt
    v_add_f32_dpp v60, v60, v60 row_ror:8 row_mask:0xf bank_mask:0x3
    s_nop 1
    v_add_f32_dpp v60, v61, v61 row_ror:8 row_mask:0xf bank_mask:0xc
    v_add_f32_dpp v62, v62, v62 row_ror:12 row_mask:0xf bank_mask:0x5
    s_nop 1
    v_add_f32_dpp v62, v60, v60 row_ror:4 row_mask:0xf bank_mask:0xa
    v_add_f32_dpp v60, v63, v63 quad_perm:[2,3,0,1] row_mask:0xf bank_mask:0xf
    s_nop 0
    v_add_f32_dpp v61, v62, v62 quad_perm:[2,3,0,1] row_mask:0xf bank_mask:0xf
    v_cndmask_b32 v64, v60, v61, s[80:81]
    s_waitcnt vmcnt(6)
    v_dot2_f32_bf16 v60, v224, v28, 0
    v_dot2_f32_bf16 v60, v225, v29, v60
    v_dot2_f32_bf16 v60, v226, v30, v60
    v_dot2_f32_bf16 v60, v227, v31, v60
    s_mov_b32 s68, 966656
    buffer_load_dwordx4 v[84:87], v4, s[32:35], s68 offen offset:1024 nt
    s_mov_b32 s68, 49152
    buffer_load_dwordx4 a[48:51], v7, s[48:51], s68 offen
    buffer_load_dwordx4 a[52:55], v7, s[48:51], s68 offen offset:256
    s_waitcnt vmcnt(8)
    v_dot2_f32_bf16 v61, v228, v28, 0
    v_dot2_f32_bf16 v61, v229, v29, v61
    v_dot2_f32_bf16 v61, v230, v30, v61
    v_dot2_f32_bf16 v61, v231, v31, v61
    s_mov_b32 s68, 966656
    buffer_load_dwordx4 v[88:91], v4, s[32:35], s68 offen offset:2048 nt
    v_add_f32_dpp v62, v60, v60 row_ror:8 row_mask:0xf bank_mask:0x3
    s_nop 1
    v_add_f32_dpp v62, v61, v61 row_ror:8 row_mask:0xf bank_mask:0xc
    v_and_b32_dpp v12, v56, v8 row_newbcast:4 row_mask:0xf bank_mask:0xf
    v_and_b32_dpp v13, v56, v9 row_newbcast:4 row_mask:0xf bank_mask:0xf
    v_and_b32_dpp v14, v56, v10 row_newbcast:4 row_mask:0xf bank_mask:0xf
    v_and_b32_dpp v15, v56, v11 row_newbcast:4 row_mask:0xf bank_mask:0xf
    s_nop 1
    v_mfma_f32_16x16x32_bf16 v[20:23], v[12:15], a[32:35], v[20:23]
    v_mfma_f32_16x16x32_bf16 v[24:27], v[12:15], a[36:39], v[24:27]
    s_waitcnt vmcnt(6)
    v_dot2_f32_bf16 v60, v232, v28, 0
    v_dot2_f32_bf16 v60, v233, v29, v60
    v_dot2_f32_bf16 v60, v234, v30, v60
    v_dot2_f32_bf16 v60, v235, v31, v60
    s_mov_b32 s68, 966656
    buffer_load_dwordx4 v[92:95], v4, s[32:35], s68 offen offset:3072 nt
    s_waitcnt vmcnt(6)
    v_dot2_f32_bf16 v61, v236, v28, 0
    v_dot2_f32_bf16 v61, v237, v29, v61
    v_dot2_f32_bf16 v61, v238, v30, v61
    v_dot2_f32_bf16 v61, v239, v31, v61
    s_mov_b32 s68, 983040
    buffer_load_dwordx4 v[96:99], v4, s[32:35], s68 offen nt
    v_add_f32_dpp v60, v60, v60 row_ror:8 row_mask:0xf bank_mask:0x3
    s_nop 1
    v_add_f32_dpp v60, v61, v61 row_ror:8 row_mask:0xf bank_mask:0xc
    v_add_f32_dpp v63, v62, v62 row_ror:12 row_mask:0xf bank_mask:0x5
    s_nop 1
    v_add_f32_dpp v63, v60, v60 row_ror:4 row_mask:0xf bank_mask:0xa
    s_waitcnt vmcnt(6)
    v_dot2_f32_bf16 v60, v80, v28, 0
    v_dot2_f32_bf16 v60, v81, v29, v60
    v_dot2_f32_bf16 v60, v82, v30, v60
    v_dot2_f32_bf16 v60, v83, v31, v60
    s_mov_b32 s68, 983040
    buffer_load_dwordx4 v[100:103], v4, s[32:35], s68 offen offset:1024 nt
    s_mov_b32 s68, 57344
    buffer_load_dwordx4 a[56:59], v7, s[48:51], s68 offen
    buffer_load_dwordx4 a[60:63], v7, s[48:51], s68 offen offset:256
    s_waitcnt vmcnt(8)
    v_dot2_f32_bf16 v61, v84, v28, 0
    v_dot2_f32_bf16 v61, v85, v29, v61
    v_dot2_f32_bf16 v61, v86, v30, v61
    v_dot2_f32_bf16 v61, v87, v31, v61
    s_mov_b32 s68, 983040
    buffer_load_dwordx4 v[104:107], v4, s[32:35], s68 offen offset:2048 nt
    v_add_f32_dpp v62, v60, v60 row_ror:8 row_mask:0xf bank_mask:0x3
    s_nop 1
    v_add_f32_dpp v62, v61, v61 row_ror:8 row_mask:0xf bank_mask:0xc
    v_and_b32_dpp v16, v56, v8 row_newbcast:5 row_mask:0xf bank_mask:0xf
    v_and_b32_dpp v17, v56, v9 row_newbcast:5 row_mask:0xf bank_mask:0xf
    v_and_b32_dpp v18, v56, v10 row_newbcast:5 row_mask:0xf bank_mask:0xf
    v_and_b32_dpp v19, v56, v11 row_newbcast:5 row_mask:0xf bank_mask:0xf
    s_nop 1
    v_mfma_f32_16x16x32_bf16 v[20:23], v[16:19], a[40:43], v[20:23]
    v_mfma_f32_16x16x32_bf16 v[24:27], v[16:19], a[44:47], v[24:27]
    s_waitcnt vmcnt(6)
    v_dot2_f32_bf16 v60, v88, v28, 0
    v_dot2_f32_bf16 v60, v89, v29, v60
    v_dot2_f32_bf16 v60, v90, v30, v60
    v_dot2_f32_bf16 v60, v91, v31, v60
    s_mov_b32 s68, 983040
    buffer_load_dwordx4 v[108:111], v4, s[32:35], s68 offen offset:3072 nt
    s_waitcnt vmcnt(6)
    v_dot2_f32_bf16 v61, v92, v28, 0
    v_dot2_f32_bf16 v61, v93, v29, v61
    v_dot2_f32_bf16 v61, v94, v30, v61
    v_dot2_f32_bf16 v61, v95, v31, v61
    s_mov_b32 s68, 999424
    buffer_load_dwordx4 v[112:115], v4, s[32:35], s68 offen nt
    v_add_f32_dpp v60, v60, v60 row_ror:8 row_mask:0xf bank_mask:0x3
    s_nop 1
    v_add_f32_dpp v60, v61, v61 row_ror:8 row_mask:0xf bank_mask:0xc
    v_add_f32_dpp v62, v62, v62 row_ror:12 row_mask:0xf bank_mask:0x5
    s_nop 1
    v_add_f32_dpp v62, v60, v60 row_ror:4 row_mask:0xf bank_mask:0xa
    v_add_f32_dpp v60, v63, v63 quad_perm:[2,3,0,1] row_mask:0xf bank_mask:0xf
    s_nop 0
    v_add_f32_dpp v61, v62, v62 quad_perm:[2,3,0,1] row_mask:0xf bank_mask:0xf
    v_cndmask_b32 v63, v60, v61, s[80:81]
    v_add_f32_dpp v60, v64, v64 quad_perm:[1,0,3,2] row_mask:0xf bank_mask:0xf
    s_nop 0
    v_add_f32_dpp v61, v63, v63 quad_perm:[1,0,3,2] row_mask:0xf bank_mask:0xf
    v_cndmask_b32 v46, v60, v61, s[82:83]
    v_cvt_pk_bf16_f32 v46, 0, v46
    v_mul_f32 v46, 0x3db504f3, v46
    v_cvt_pk_bf16_f32 v46, 0, v46
    s_waitcnt vmcnt(6)
    v_dot2_f32_bf16 v60, v96, v28, 0
    v_dot2_f32_bf16 v60, v97, v29, v60
    v_dot2_f32_bf16 v60, v98, v30, v60
    v_dot2_f32_bf16 v60, v99, v31, v60
    s_mov_b32 s68, 999424
    buffer_load_dwordx4 v[116:119], v4, s[32:35], s68 offen offset:1024 nt
    s_mov_b32 s68, 65536
    buffer_load_dwordx4 a[64:67], v7, s[48:51], s68 offen
    buffer_load_dwordx4 a[68:71], v7, s[48:51], s68 offen offset:256
    s_waitcnt vmcnt(8)
    v_dot2_f32_bf16 v61, v100, v28, 0
    v_dot2_f32_bf16 v61, v101, v29, v61
    v_dot2_f32_bf16 v61, v102, v30, v61
    v_dot2_f32_bf16 v61, v103, v31, v61
    s_mov_b32 s68, 999424
    buffer_load_dwordx4 v[120:123], v4, s[32:35], s68 offen offset:2048 nt
    v_add_f32_dpp v62, v60, v60 row_ror:8 row_mask:0xf bank_mask:0x3
    s_nop 1
    v_add_f32_dpp v62, v61, v61 row_ror:8 row_mask:0xf bank_mask:0xc
    v_and_b32_dpp v12, v56, v8 row_newbcast:6 row_mask:0xf bank_mask:0xf
    v_and_b32_dpp v13, v56, v9 row_newbcast:6 row_mask:0xf bank_mask:0xf
    v_and_b32_dpp v14, v56, v10 row_newbcast:6 row_mask:0xf bank_mask:0xf
    v_and_b32_dpp v15, v56, v11 row_newbcast:6 row_mask:0xf bank_mask:0xf
    s_nop 1
    v_mfma_f32_16x16x32_bf16 v[20:23], v[12:15], a[48:51], v[20:23]
    v_mfma_f32_16x16x32_bf16 v[24:27], v[12:15], a[52:55], v[24:27]
    s_waitcnt vmcnt(6)
    v_dot2_f32_bf16 v60, v104, v28, 0
    v_dot2_f32_bf16 v60, v105, v29, v60
    v_dot2_f32_bf16 v60, v106, v30, v60
    v_dot2_f32_bf16 v60, v107, v31, v60
    s_mov_b32 s68, 999424
    buffer_load_dwordx4 v[124:127], v4, s[32:35], s68 offen offset:3072 nt
    s_waitcnt vmcnt(6)
    v_dot2_f32_bf16 v61, v108, v28, 0
    v_dot2_f32_bf16 v61, v109, v29, v61
    v_dot2_f32_bf16 v61, v110, v30, v61
    v_dot2_f32_bf16 v61, v111, v31, v61
    s_mov_b32 s68, 1015808
    buffer_load_dwordx4 v[128:131], v4, s[32:35], s68 offen nt
    v_add_f32_dpp v60, v60, v60 row_ror:8 row_mask:0xf bank_mask:0x3
    s_nop 1
    v_add_f32_dpp v60, v61, v61 row_ror:8 row_mask:0xf bank_mask:0xc
    v_add_f32_dpp v63, v62, v62 row_ror:12 row_mask:0xf bank_mask:0x5
    s_nop 1
    v_add_f32_dpp v63, v60, v60 row_ror:4 row_mask:0xf bank_mask:0xa
    s_waitcnt vmcnt(6)
    v_dot2_f32_bf16 v60, v112, v28, 0
    v_dot2_f32_bf16 v60, v113, v29, v60
    v_dot2_f32_bf16 v60, v114, v30, v60
    v_dot2_f32_bf16 v60, v115, v31, v60
    s_mov_b32 s68, 1015808
    buffer_load_dwordx4 v[132:135], v4, s[32:35], s68 offen offset:1024 nt
    s_mov_b32 s68, 73728
    buffer_load_dwordx4 a[72:75], v7, s[48:51], s68 offen
    buffer_load_dwordx4 a[76:79], v7, s[48:51], s68 offen offset:256
    s_waitcnt vmcnt(8)
    v_dot2_f32_bf16 v61, v116, v28, 0
    v_dot2_f32_bf16 v61, v117, v29, v61
    v_dot2_f32_bf16 v61, v118, v30, v61
    v_dot2_f32_bf16 v61, v119, v31, v61
    s_mov_b32 s68, 1015808
    buffer_load_dwordx4 v[136:139], v4, s[32:35], s68 offen offset:2048 nt
    v_add_f32_dpp v62, v60, v60 row_ror:8 row_mask:0xf bank_mask:0x3
    s_nop 1
    v_add_f32_dpp v62, v61, v61 row_ror:8 row_mask:0xf bank_mask:0xc
    v_and_b32_dpp v16, v56, v8 row_newbcast:7 row_mask:0xf bank_mask:0xf
    v_and_b32_dpp v17, v56, v9 row_newbcast:7 row_mask:0xf bank_mask:0xf
    v_and_b32_dpp v18, v56, v10 row_newbcast:7 row_mask:0xf bank_mask:0xf
    v_and_b32_dpp v19, v56, v11 row_newbcast:7 row_mask:0xf bank_mask:0xf
    s_nop 1
    v_mfma_f32_16x16x32_bf16 v[20:23], v[16:19], a[56:59], v[20:23]
    v_mfma_f32_16x16x32_bf16 v[24:27], v[16:19], a[60:63], v[24:27]
    s_waitcnt vmcnt(6)
    v_dot2_f32_bf16 v60, v120, v28, 0
    v_dot2_f32_bf16 v60, v121, v29, v60
    v_dot2_f32_bf16 v60, v122, v30, v60
    v_dot2_f32_bf16 v60, v123, v31, v60
    s_mov_b32 s68, 1015808
    buffer_load_dwordx4 v[140:143], v4, s[32:35], s68 offen offset:3072 nt
    s_waitcnt vmcnt(6)
    v_dot2_f32_bf16 v61, v124, v28, 0
    v_dot2_f32_bf16 v61, v125, v29, v61
    v_dot2_f32_bf16 v61, v126, v30, v61
    v_dot2_f32_bf16 v61, v127, v31, v61
    s_mov_b32 s68, 1032192
    buffer_load_dwordx4 v[144:147], v4, s[32:35], s68 offen nt
    v_add_f32_dpp v60, v60, v60 row_ror:8 row_mask:0xf bank_mask:0x3
    s_nop 1
    v_add_f32_dpp v60, v61, v61 row_ror:8 row_mask:0xf bank_mask:0xc
    v_add_f32_dpp v62, v62, v62 row_ror:12 row_mask:0xf bank_mask:0x5
    s_nop 1
    v_add_f32_dpp v62, v60, v60 row_ror:4 row_mask:0xf bank_mask:0xa
    v_add_f32_dpp v60, v63, v63 quad_perm:[2,3,0,1] row_mask:0xf bank_mask:0xf
    s_nop 0
    v_add_f32_dpp v61, v62, v62 quad_perm:[2,3,0,1] row_mask:0xf bank_mask:0xf
    v_cndmask_b32 v64, v60, v61, s[80:81]
    s_waitcnt vmcnt(6)
    v_dot2_f32_bf16 v60, v128, v28, 0
    v_dot2_f32_bf16 v60, v129, v29, v60
    v_dot2_f32_bf16 v60, v130, v30, v60
    v_dot2_f32_bf16 v60, v131, v31, v60
    s_mov_b32 s68, 1032192
    buffer_load_dwordx4 v[148:151], v4, s[32:35], s68 offen offset:1024 nt
    s_mov_b32 s68, 1032192
    buffer_load_dwordx4 v[152:155], v4, s[32:35], s68 offen offset:2048 nt
    s_mov_b32 s68, 81920
    buffer_load_dwordx4 a[80:83], v7, s[48:51], s68 offen
    buffer_load_dwordx4 a[84:87], v7, s[48:51], s68 offen offset:256
    s_waitcnt vmcnt(9)
    v_dot2_f32_bf16 v61, v132, v28, 0
    v_dot2_f32_bf16 v61, v133, v29, v61
    v_dot2_f32_bf16 v61, v134, v30, v61
    v_dot2_f32_bf16 v61, v135, v31, v61
    s_mov_b32 s68, 1032192
    buffer_load_dwordx4 v[156:159], v4, s[32:35], s68 offen offset:3072 nt
    s_mov_b32 s68, 0
    buffer_load_dwordx4 v[160:163], v4, s[36:39], s68 offen nt
    v_add_f32_dpp v62, v60, v60 row_ror:8 row_mask:0xf bank_mask:0x3
    s_nop 1
    v_add_f32_dpp v62, v61, v61 row_ror:8 row_mask:0xf bank_mask:0xc
    v_and_b32_dpp v12, v56, v8 row_newbcast:8 row_mask:0xf bank_mask:0xf
    v_and_b32_dpp v13, v56, v9 row_newbcast:8 row_mask:0xf bank_mask:0xf
    v_and_b32_dpp v14, v56, v10 row_newbcast:8 row_mask:0xf bank_mask:0xf
    v_and_b32_dpp v15, v56, v11 row_newbcast:8 row_mask:0xf bank_mask:0xf
    s_nop 1
    v_mfma_f32_16x16x32_bf16 v[20:23], v[12:15], a[64:67], v[20:23]
    v_mfma_f32_16x16x32_bf16 v[24:27], v[12:15], a[68:71], v[24:27]
    s_waitcnt vmcnt(8)
    v_dot2_f32_bf16 v60, v136, v28, 0
    v_dot2_f32_bf16 v60, v137, v29, v60
    v_dot2_f32_bf16 v60, v138, v30, v60
    v_dot2_f32_bf16 v60, v139, v31, v60
    s_mov_b32 s68, 0
    buffer_load_dwordx4 v[164:167], v4, s[36:39], s68 offen offset:1024 nt
    s_mov_b32 s68, 0
    buffer_load_dwordx4 v[168:171], v4, s[36:39], s68 offen offset:2048 nt
    s_waitcnt vmcnt(9)
    v_dot2_f32_bf16 v61, v140, v28, 0
    v_dot2_f32_bf16 v61, v141, v29, v61
    v_dot2_f32_bf16 v61, v142, v30, v61
    v_dot2_f32_bf16 v61, v143, v31, v61
    s_mov_b32 s68, 0
    buffer_load_dwordx4 v[172:175], v4, s[36:39], s68 offen offset:3072 nt
    s_mov_b32 s68, 16384
    buffer_load_dwordx4 v[176:179], v4, s[36:39], s68 offen nt
    v_add_f32_dpp v60, v60, v60 row_ror:8 row_mask:0xf bank_mask:0x3
    s_nop 1
    v_add_f32_dpp v60, v61, v61 row_ror:8 row_mask:0xf bank_mask:0xc
    v_add_f32_dpp v63, v62, v62 row_ror:12 row_mask:0xf bank_mask:0x5
    s_nop 1
    v_add_f32_dpp v63, v60, v60 row_ror:4 row_mask:0xf bank_mask:0xa
    s_waitcnt vmcnt(10)
    v_dot2_f32_bf16 v60, v144, v28, 0
    v_dot2_f32_bf16 v60, v145, v29, v60
    v_dot2_f32_bf16 v60, v146, v30, v60
    v_dot2_f32_bf16 v60, v147, v31, v60
    s_mov_b32 s68, 16384
    buffer_load_dwordx4 v[180:183], v4, s[36:39], s68 offen offset:1024 nt
    s_mov_b32 s68, 16384
    buffer_load_dwordx4 v[184:187], v4, s[36:39], s68 offen offset:2048 nt
    s_mov_b32 s68, 90112
    buffer_load_dwordx4 a[88:91], v7, s[48:51], s68 offen
    buffer_load_dwordx4 a[92:95], v7, s[48:51], s68 offen offset:256
    s_waitcnt vmcnt(13)
    v_dot2_f32_bf16 v61, v148, v28, 0
    v_dot2_f32_bf16 v61, v149, v29, v61
    v_dot2_f32_bf16 v61, v150, v30, v61
    v_dot2_f32_bf16 v61, v151, v31, v61
    s_mov_b32 s68, 16384
    buffer_load_dwordx4 v[188:191], v4, s[36:39], s68 offen offset:3072 nt
    s_mov_b32 s68, 32768
    buffer_load_dwordx4 v[192:195], v4, s[36:39], s68 offen nt
    v_add_f32_dpp v62, v60, v60 row_ror:8 row_mask:0xf bank_mask:0x3
    s_nop 1
    v_add_f32_dpp v62, v61, v61 row_ror:8 row_mask:0xf bank_mask:0xc
    v_and_b32_dpp v16, v56, v8 row_newbcast:9 row_mask:0xf bank_mask:0xf
    v_and_b32_dpp v17, v56, v9 row_newbcast:9 row_mask:0xf bank_mask:0xf
    v_and_b32_dpp v18, v56, v10 row_newbcast:9 row_mask:0xf bank_mask:0xf
    v_and_b32_dpp v19, v56, v11 row_newbcast:9 row_mask:0xf bank_mask:0xf
    s_nop 1
    v_mfma_f32_16x16x32_bf16 v[20:23], v[16:19], a[72:75], v[20:23]
    v_mfma_f32_16x16x32_bf16 v[24:27], v[16:19], a[76:79], v[24:27]
    s_waitcnt vmcnt(14)
    v_dot2_f32_bf16 v60, v152, v28, 0
    v_dot2_f32_bf16 v60, v153, v29, v60
    v_dot2_f32_bf16 v60, v154, v30, v60
    v_dot2_f32_bf16 v60, v155, v31, v60
    s_mov_b32 s68, 32768
    buffer_load_dwordx4 v[196:199], v4, s[36:39], s68 offen offset:1024 nt
    s_waitcnt vmcnt(12)
    v_dot2_f32_bf16 v61, v156, v28, 0
    v_dot2_f32_bf16 v61, v157, v29, v61
    v_dot2_f32_bf16 v61, v158, v30, v61
    v_dot2_f32_bf16 v61, v159, v31, v61
    s_mov_b32 s68, 32768
    buffer_load_dwordx4 v[200:203], v4, s[36:39], s68 offen offset:2048 nt
    v_add_f32_dpp v60, v60, v60 row_ror:8 row_mask:0xf bank_mask:0x3
    s_nop 1
    v_add_f32_dpp v60, v61, v61 row_ror:8 row_mask:0xf bank_mask:0xc
    v_add_f32_dpp v62, v62, v62 row_ror:12 row_mask:0xf bank_mask:0x5
    s_nop 1
    v_add_f32_dpp v62, v60, v60 row_ror:4 row_mask:0xf bank_mask:0xa
    v_add_f32_dpp v60, v63, v63 quad_perm:[2,3,0,1] row_mask:0xf bank_mask:0xf
    s_nop 0
    v_add_f32_dpp v61, v62, v62 quad_perm:[2,3,0,1] row_mask:0xf bank_mask:0xf
    v_cndmask_b32 v63, v60, v61, s[80:81]
    v_add_f32_dpp v60, v64, v64 quad_perm:[1,0,3,2] row_mask:0xf bank_mask:0xf
    s_nop 0
    v_add_f32_dpp v61, v63, v63 quad_perm:[1,0,3,2] row_mask:0xf bank_mask:0xf
    v_cndmask_b32 v47, v60, v61, s[82:83]
    v_cvt_pk_bf16_f32 v47, 0, v47
    v_mul_f32 v47, 0x3db504f3, v47
    v_cvt_pk_bf16_f32 v47, 0, v47
    v_max3_f32 v12, v32, v33, v34
    v_max3_f32 v12, v12, v35, v36
    v_max3_f32 v12, v12, v37, v38
    v_max3_f32 v12, v12, v39, v40
    v_max3_f32 v12, v12, v41, v42
    v_max3_f32 v12, v12, v43, v44
    v_max3_f32 v12, v12, v45, v46
    v_max_f32 v12, v12, v47
    s_nop 1
    v_max_f32_dpp v12, v12, v12 row_ror:8 row_mask:0xf bank_mask:0xf
    s_nop 1
    v_max_f32_dpp v12, v12, v12 row_ror:4 row_mask:0xf bank_mask:0xf
    s_nop 1
    v_max_f32_dpp v12, v12, v12 row_ror:2 row_mask:0xf bank_mask:0xf
    s_nop 1
    v_max_f32_dpp v12, v12, v12 row_ror:1 row_mask:0xf bank_mask:0xf
    s_nop 0
    v_readlane_b32 s84, v12, 0
    v_readlane_b32 s85, v12, 16
    v_readlane_b32 s86, v12, 32
    v_readlane_b32 s87, v12, 48
    v_mov_b32 v12, s84
    v_max_f32 v12, s85, v12
    v_max_f32 v12, s86, v12
    v_max_f32 v12, s87, v12
    v_mov_b32 v13, 0
    v_sub_f32 v72, v32, v12
    v_mul_f32 v72, 0x3fb8aa3b, v72
    v_exp_f32 v72, v72
    s_nop 0
    v_add_f32 v13, v13, v72
    v_sub_f32 v71, v33, v12
    v_mul_f32 v71, 0x3fb8aa3b, v71
    v_exp_f32 v71, v71
    s_nop 0
    v_add_f32 v13, v13, v71
    v_sub_f32 v72, v34, v12
    v_mul_f32 v72, 0x3fb8aa3b, v72
    v_exp_f32 v72, v72
    s_nop 0
    v_add_f32 v13, v13, v72
    v_sub_f32 v71, v35, v12
    v_mul_f32 v71, 0x3fb8aa3b, v71
    v_exp_f32 v71, v71
    s_nop 0
    v_add_f32 v13, v13, v71
    v_sub_f32 v72, v36, v12
    v_mul_f32 v72, 0x3fb8aa3b, v72
    v_exp_f32 v72, v72
    s_nop 0
    v_add_f32 v13, v13, v72
    v_sub_f32 v71, v37, v12
    v_mul_f32 v71, 0x3fb8aa3b, v71
    v_exp_f32 v71, v71
    s_nop 0
    v_add_f32 v13, v13, v71
    v_sub_f32 v72, v38, v12
    v_mul_f32 v72, 0x3fb8aa3b, v72
    v_exp_f32 v72, v72
    s_nop 0
    v_add_f32 v13, v13, v72
    v_sub_f32 v71, v39, v12
    v_mul_f32 v71, 0x3fb8aa3b, v71
    v_exp_f32 v71, v71
    s_nop 0
    v_add_f32 v13, v13, v71
    v_sub_f32 v72, v40, v12
    v_mul_f32 v72, 0x3fb8aa3b, v72
    v_exp_f32 v72, v72
    s_nop 0
    v_add_f32 v13, v13, v72
    v_sub_f32 v71, v41, v12
    v_mul_f32 v71, 0x3fb8aa3b, v71
    v_exp_f32 v71, v71
    s_nop 0
    v_add_f32 v13, v13, v71
    v_sub_f32 v72, v42, v12
    v_mul_f32 v72, 0x3fb8aa3b, v72
    v_exp_f32 v72, v72
    s_nop 0
    v_add_f32 v13, v13, v72
    v_sub_f32 v71, v43, v12
    v_mul_f32 v71, 0x3fb8aa3b, v71
    v_exp_f32 v71, v71
    s_nop 0
    v_add_f32 v13, v13, v71
    v_sub_f32 v72, v44, v12
    v_mul_f32 v72, 0x3fb8aa3b, v72
    v_exp_f32 v72, v72
    s_nop 0
    v_add_f32 v13, v13, v72
    v_sub_f32 v71, v45, v12
    v_mul_f32 v71, 0x3fb8aa3b, v71
    v_exp_f32 v71, v71
    s_nop 0
    v_add_f32 v13, v13, v71
    v_sub_f32 v72, v46, v12
    v_mul_f32 v72, 0x3fb8aa3b, v72
    v_exp_f32 v72, v72
    s_nop 0
    v_add_f32 v13, v13, v72
    v_sub_f32 v71, v47, v12
    v_mul_f32 v71, 0x3fb8aa3b, v71
    v_exp_f32 v71, v71
    s_nop 0
    v_add_f32 v13, v13, v71
    s_nop 1
    v_add_f32_dpp v13, v13, v13 row_ror:8 row_mask:0xf bank_mask:0xf
    s_nop 1
    v_add_f32_dpp v13, v13, v13 row_ror:4 row_mask:0xf bank_mask:0xf
    s_nop 1
    v_add_f32_dpp v13, v13, v13 row_ror:2 row_mask:0xf bank_mask:0xf
    s_nop 1
    v_add_f32_dpp v13, v13, v13 row_ror:1 row_mask:0xf bank_mask:0xf
    s_nop 0
    v_readlane_b32 s84, v13, 0
    v_readlane_b32 s85, v13, 16
    v_readlane_b32 s86, v13, 32
    v_readlane_b32 s87, v13, 48
    v_mov_b32 v13, s84
    v_add_f32 v13, s85, v13
    v_add_f32 v13, s86, v13
    v_add_f32 v13, s87, v13
    s_lshl_b32 s72, s3, 3
    v_mov_b32 v65, s72
    ds_write_b64 v65, v[12:13] offset:7168
    s_waitcnt lgkmcnt(0)
    s_barrier
    v_mov_b32 v65, 0
    ds_read_b128 v[12:15], v65 offset:7168
    ds_read_b128 v[16:19], v65 offset:7184
    s_waitcnt lgkmcnt(0)
    v_max3_f32 v73, v12, v14, v16
    v_max_f32 v73, v73, v18
    v_mov_b32 v74, 0
    v_sub_f32 v71, v12, v73
    v_mul_f32 v71, 0x3fb8aa3b, v71
    v_exp_f32 v71, v71
    s_nop 0
    v_fmac_f32 v74, v71, v13
    v_sub_f32 v71, v14, v73
    v_mul_f32 v71, 0x3fb8aa3b, v71
    v_exp_f32 v71, v71
    s_nop 0
    v_fmac_f32 v74, v71, v15
    v_sub_f32 v71, v16, v73
    v_mul_f32 v71, 0x3fb8aa3b, v71
    v_exp_f32 v71, v71
    s_nop 0
    v_fmac_f32 v74, v71, v17
    v_sub_f32 v71, v18, v73
    v_mul_f32 v71, 0x3fb8aa3b, v71
    v_exp_f32 v71, v71
    s_nop 0
    v_fmac_f32 v74, v71, v19
    v_rcp_f32 v75, v74
    s_nop 0
    v_fma_f32 v71, -v74, v75, 1.0
    v_fma_f32 v75, v71, v75, v75
    v_sub_f32 v32, v32, v73
    v_mul_f32 v32, 0x3fb8aa3b, v32
    v_exp_f32 v32, v32
    s_nop 0
    v_mul_f32 v32, v32, v75
    v_cvt_pk_bf16_f32 v32, v32, v32
    s_waitcnt vmcnt(12)
    s_nop 0
    v_and_b32_dpp v12, v32, v8 row_newbcast:0 row_mask:0xf bank_mask:0xf
    v_and_b32_dpp v13, v32, v9 row_newbcast:0 row_mask:0xf bank_mask:0xf
    v_and_b32_dpp v14, v32, v10 row_newbcast:0 row_mask:0xf bank_mask:0xf
    v_and_b32_dpp v15, v32, v11 row_newbcast:0 row_mask:0xf bank_mask:0xf
    s_nop 1
    v_mfma_f32_16x16x32_bf16 v[28:31], v[12:15], v[160:163], 0
    v_sub_f32 v33, v33, v73
    v_mul_f32 v33, 0x3fb8aa3b, v33
    v_exp_f32 v33, v33
    s_nop 0
    v_mul_f32 v33, v33, v75
    v_cvt_pk_bf16_f32 v33, v33, v33
    s_mov_b32 s68, 98304
    buffer_load_dwordx4 a[96:99], v7, s[48:51], s68 offen
    buffer_load_dwordx4 a[100:103], v7, s[48:51], s68 offen offset:256
    s_waitcnt vmcnt(13)
    v_and_b32_dpp v16, v32, v8 row_newbcast:8 row_mask:0xf bank_mask:0xf
    v_and_b32_dpp v17, v32, v9 row_newbcast:8 row_mask:0xf bank_mask:0xf
    v_and_b32_dpp v18, v32, v10 row_newbcast:8 row_mask:0xf bank_mask:0xf
    v_and_b32_dpp v19, v32, v11 row_newbcast:8 row_mask:0xf bank_mask:0xf
    s_nop 1
    v_mfma_f32_16x16x32_bf16 v[28:31], v[16:19], v[164:167], v[28:31]
    v_and_b32_dpp v12, v56, v8 row_newbcast:10 row_mask:0xf bank_mask:0xf
    v_and_b32_dpp v13, v56, v9 row_newbcast:10 row_mask:0xf bank_mask:0xf
    v_and_b32_dpp v14, v56, v10 row_newbcast:10 row_mask:0xf bank_mask:0xf
    v_and_b32_dpp v15, v56, v11 row_newbcast:10 row_mask:0xf bank_mask:0xf
    s_nop 1
    v_mfma_f32_16x16x32_bf16 v[20:23], v[12:15], a[80:83], v[20:23]
    v_mfma_f32_16x16x32_bf16 v[24:27], v[12:15], a[84:87], v[24:27]
    s_waitcnt vmcnt(12)
    v_and_b32_dpp v16, v32, v8 row_newbcast:4 row_mask:0xf bank_mask:0xf
    v_and_b32_dpp v17, v32, v9 row_newbcast:4 row_mask:0xf bank_mask:0xf
    v_and_b32_dpp v18, v32, v10 row_newbcast:4 row_mask:0xf bank_mask:0xf
    v_and_b32_dpp v19, v32, v11 row_newbcast:4 row_mask:0xf bank_mask:0xf
    s_nop 1
    v_mfma_f32_16x16x32_bf16 v[28:31], v[16:19], v[168:171], v[28:31]
    s_waitcnt vmcnt(11)
    v_and_b32_dpp v12, v32, v8 row_newbcast:12 row_mask:0xf bank_mask:0xf
    v_and_b32_dpp v13, v32, v9 row_newbcast:12 row_mask:0xf bank_mask:0xf
    v_and_b32_dpp v14, v32, v10 row_newbcast:12 row_mask:0xf bank_mask:0xf
    v_and_b32_dpp v15, v32, v11 row_newbcast:12 row_mask:0xf bank_mask:0xf
    s_nop 1
    v_mfma_f32_16x16x32_bf16 v[28:31], v[12:15], v[172:175], v[28:31]
    s_waitcnt vmcnt(10)
    v_and_b32_dpp v16, v32, v8 row_newbcast:2 row_mask:0xf bank_mask:0xf
    v_and_b32_dpp v17, v32, v9 row_newbcast:2 row_mask:0xf bank_mask:0xf
    v_and_b32_dpp v18, v32, v10 row_newbcast:2 row_mask:0xf bank_mask:0xf
    v_and_b32_dpp v19, v32, v11 row_newbcast:2 row_mask:0xf bank_mask:0xf
    s_nop 1
    v_mfma_f32_16x16x32_bf16 v[28:31], v[16:19], v[176:179], v[28:31]
    s_mov_b32 s68, 106496
    buffer_load_dwordx4 a[104:107], v7, s[48:51], s68 offen
    buffer_load_dwordx4 a[108:111], v7, s[48:51], s68 offen offset:256
    s_waitcnt vmcnt(11)
    v_and_b32_dpp v12, v32, v8 row_newbcast:10 row_mask:0xf bank_mask:0xf
    v_and_b32_dpp v13, v32, v9 row_newbcast:10 row_mask:0xf bank_mask:0xf
    v_and_b32_dpp v14, v32, v10 row_newbcast:10 row_mask:0xf bank_mask:0xf
    v_and_b32_dpp v15, v32, v11 row_newbcast:10 row_mask:0xf bank_mask:0xf
    s_nop 1
    v_mfma_f32_16x16x32_bf16 v[28:31], v[12:15], v[180:183], v[28:31]
    s_waitcnt vmcnt(8)
    v_and_b32_dpp v16, v56, v8 row_newbcast:11 row_mask:0xf bank_mask:0xf
    v_and_b32_dpp v17, v56, v9 row_newbcast:11 row_mask:0xf bank_mask:0xf
    v_and_b32_dpp v18, v56, v10 row_newbcast:11 row_mask:0xf bank_mask:0xf
    v_and_b32_dpp v19, v56, v11 row_newbcast:11 row_mask:0xf bank_mask:0xf
    s_nop 1
    v_mfma_f32_16x16x32_bf16 v[20:23], v[16:19], a[88:91], v[20:23]
    v_mfma_f32_16x16x32_bf16 v[24:27], v[16:19], a[92:95], v[24:27]
    v_and_b32_dpp v12, v32, v8 row_newbcast:6 row_mask:0xf bank_mask:0xf
    v_and_b32_dpp v13, v32, v9 row_newbcast:6 row_mask:0xf bank_mask:0xf
    v_and_b32_dpp v14, v32, v10 row_newbcast:6 row_mask:0xf bank_mask:0xf
    v_and_b32_dpp v15, v32, v11 row_newbcast:6 row_mask:0xf bank_mask:0xf
    s_nop 1
    v_mfma_f32_16x16x32_bf16 v[28:31], v[12:15], v[184:187], v[28:31]
    s_mov_b32 s68, 32768
    buffer_load_dwordx4 v[204:207], v4, s[36:39], s68 offen offset:3072 nt
    s_waitcnt vmcnt(8)
    v_and_b32_dpp v16, v32, v8 row_newbcast:14 row_mask:0xf bank_mask:0xf
    v_and_b32_dpp v17, v32, v9 row_newbcast:14 row_mask:0xf bank_mask:0xf
    v_and_b32_dpp v18, v32, v10 row_newbcast:14 row_mask:0xf bank_mask:0xf
    v_and_b32_dpp v19, v32, v11 row_newbcast:14 row_mask:0xf bank_mask:0xf
    s_nop 1
    v_mfma_f32_16x16x32_bf16 v[28:31], v[16:19], v[188:191], v[28:31]
    s_mov_b32 s68, 49152
    buffer_load_dwordx4 v[208:211], v4, s[36:39], s68 offen nt
    s_waitcnt vmcnt(8)
    v_and_b32_dpp v12, v32, v8 row_newbcast:1 row_mask:0xf bank_mask:0xf
    v_and_b32_dpp v13, v32, v9 row_newbcast:1 row_mask:0xf bank_mask:0xf
    v_and_b32_dpp v14, v32, v10 row_newbcast:1 row_mask:0xf bank_mask:0xf
    v_and_b32_dpp v15, v32, v11 row_newbcast:1 row_mask:0xf bank_mask:0xf
    s_nop 1
    v_mfma_f32_16x16x32_bf16 v[28:31], v[12:15], v[192:195], v[28:31]
    s_mov_b32 s68, 49152
    buffer_load_dwordx4 v[212:215], v4, s[36:39], s68 offen offset:1024 nt
    s_mov_b32 s68, 114688
    buffer_load_dwordx4 a[112:115], v7, s[48:51], s68 offen
    buffer_load_dwordx4 a[116:119], v7, s[48:51], s68 offen offset:256
    s_waitcnt vmcnt(10)
    v_and_b32_dpp v16, v32, v8 row_newbcast:9 row_mask:0xf bank_mask:0xf
    v_and_b32_dpp v17, v32, v9 row_newbcast:9 row_mask:0xf bank_mask:0xf
    v_and_b32_dpp v18, v32, v10 row_newbcast:9 row_mask:0xf bank_mask:0xf
    v_and_b32_dpp v19, v32, v11 row_newbcast:9 row_mask:0xf bank_mask:0xf
    s_nop 1
    v_mfma_f32_16x16x32_bf16 v[28:31], v[16:19], v[196:199], v[28:31]
    s_mov_b32 s68, 49152
    buffer_load_dwordx4 v[216:219], v4, s[36:39], s68 offen offset:2048 nt
    s_waitcnt vmcnt(8)
    v_and_b32_dpp v12, v56, v8 row_newbcast:12 row_mask:0xf bank_mask:0xf
    v_and_b32_dpp v13, v56, v9 row_newbcast:12 row_mask:0xf bank_mask:0xf
    v_and_b32_dpp v14, v56, v10 row_newbcast:12 row_mask:0xf bank_mask:0xf
    v_and_b32_dpp v15, v56, v11 row_newbcast:12 row_mask:0xf bank_mask:0xf
    s_nop 1
    v_mfma_f32_16x16x32_bf16 v[20:23], v[12:15], a[96:99], v[20:23]
    v_mfma_f32_16x16x32_bf16 v[24:27], v[12:15], a[100:103], v[24:27]
    v_and_b32_dpp v16, v32, v8 row_newbcast:5 row_mask:0xf bank_mask:0xf
    v_and_b32_dpp v17, v32, v9 row_newbcast:5 row_mask:0xf bank_mask:0xf
    v_and_b32_dpp v18, v32, v10 row_newbcast:5 row_mask:0xf bank_mask:0xf
    v_and_b32_dpp v19, v32, v11 row_newbcast:5 row_mask:0xf bank_mask:0xf
    s_nop 1
    v_mfma_f32_16x16x32_bf16 v[28:31], v[16:19], v[200:203], v[28:31]
    s_mov_b32 s68, 49152
    buffer_load_dwordx4 v[220:223], v4, s[36:39], s68 offen offset:3072 nt
    s_waitcnt vmcnt(6)
    v_and_b32_dpp v12, v32, v8 row_newbcast:13 row_mask:0xf bank_mask:0xf
    v_and_b32_dpp v13, v32, v9 row_newbcast:13 row_mask:0xf bank_mask:0xf
    v_and_b32_dpp v14, v32, v10 row_newbcast:13 row_mask:0xf bank_mask:0xf
    v_and_b32_dpp v15, v32, v11 row_newbcast:13 row_mask:0xf bank_mask:0xf
    s_nop 1
    v_mfma_f32_16x16x32_bf16 v[28:31], v[12:15], v[204:207], v[28:31]
    s_mov_b32 s68, 65536
    buffer_load_dwordx4 v[224:227], v4, s[36:39], s68 offen nt
    s_waitcnt vmcnt(6)
    v_and_b32_dpp v16, v32, v8 row_newbcast:3 row_mask:0xf bank_mask:0xf
    v_and_b32_dpp v17, v32, v9 row_newbcast:3 row_mask:0xf bank_mask:0xf
    v_and_b32_dpp v18, v32, v10 row_newbcast:3 row_mask:0xf bank_mask:0xf
    v_and_b32_dpp v19, v32, v11 row_newbcast:3 row_mask:0xf bank_mask:0xf
    s_nop 1
    v_mfma_f32_16x16x32_bf16 v[28:31], v[16:19], v[208:211], v[28:31]
    s_mov_b32 s68, 65536
    buffer_load_dwordx4 v[228:231], v4, s[36:39], s68 offen offset:1024 nt
    s_mov_b32 s68, 122880
    buffer_load_dwordx4 a[120:123], v7, s[48:51], s68 offen
    buffer_load_dwordx4 a[124:127], v7, s[48:51], s68 offen offset:256
    s_waitcnt vmcnt(8)
    v_and_b32_dpp v12, v32, v8 row_newbcast:11 row_mask:0xf bank_mask:0xf
    v_and_b32_dpp v13, v32, v9 row_newbcast:11 row_mask:0xf bank_mask:0xf
    v_and_b32_dpp v14, v32, v10 row_newbcast:11 row_mask:0xf bank_mask:0xf
    v_and_b32_dpp v15, v32, v11 row_newbcast:11 row_mask:0xf bank_mask:0xf
    s_nop 1
    v_mfma_f32_16x16x32_bf16 v[28:31], v[12:15], v[212:215], v[28:31]
    s_mov_b32 s68, 65536
    buffer_load_dwordx4 v[232:235], v4, s[36:39], s68 offen offset:2048 nt
    v_and_b32_dpp v16, v56, v8 row_newbcast:13 row_mask:0xf bank_mask:0xf
    v_and_b32_dpp v17, v56, v9 row_newbcast:13 row_mask:0xf bank_mask:0xf
    v_and_b32_dpp v18, v56, v10 row_newbcast:13 row_mask:0xf bank_mask:0xf
    v_and_b32_dpp v19, v56, v11 row_newbcast:13 row_mask:0xf bank_mask:0xf
    s_nop 1
    v_mfma_f32_16x16x32_bf16 v[20:23], v[16:19], a[104:107], v[20:23]
    v_mfma_f32_16x16x32_bf16 v[24:27], v[16:19], a[108:111], v[24:27]
    s_waitcnt vmcnt(6)
    v_and_b32_dpp v12, v32, v8 row_newbcast:7 row_mask:0xf bank_mask:0xf
    v_and_b32_dpp v13, v32, v9 row_newbcast:7 row_mask:0xf bank_mask:0xf
    v_and_b32_dpp v14, v32, v10 row_newbcast:7 row_mask:0xf bank_mask:0xf
    v_and_b32_dpp v15, v32, v11 row_newbcast:7 row_mask:0xf bank_mask:0xf
    s_nop 1
    v_mfma_f32_16x16x32_bf16 v[28:31], v[12:15], v[216:219], v[28:31]
    s_mov_b32 s68, 65536
    buffer_load_dwordx4 v[236:239], v4, s[36:39], s68 offen offset:3072 nt
    s_waitcnt vmcnt(6)
    v_and_b32_dpp v16, v32, v8 row_newbcast:15 row_mask:0xf bank_mask:0xf
    v_and_b32_dpp v17, v32, v9 row_newbcast:15 row_mask:0xf bank_mask:0xf
    v_and_b32_dpp v18, v32, v10 row_newbcast:15 row_mask:0xf bank_mask:0xf
    v_and_b32_dpp v19, v32, v11 row_newbcast:15 row_mask:0xf bank_mask:0xf
    s_nop 1
    v_mfma_f32_16x16x32_bf16 v[28:31], v[16:19], v[220:223], v[28:31]
    s_mov_b32 s68, 81920
    buffer_load_dwordx4 v[80:83], v4, s[36:39], s68 offen nt
    s_waitcnt vmcnt(6)
    v_and_b32_dpp v12, v33, v8 row_newbcast:0 row_mask:0xf bank_mask:0xf
    v_and_b32_dpp v13, v33, v9 row_newbcast:0 row_mask:0xf bank_mask:0xf
    v_and_b32_dpp v14, v33, v10 row_newbcast:0 row_mask:0xf bank_mask:0xf
    v_and_b32_dpp v15, v33, v11 row_newbcast:0 row_mask:0xf bank_mask:0xf
    s_nop 1
    v_mfma_f32_16x16x32_bf16 v[28:31], v[12:15], v[224:227], v[28:31]
    s_mov_b32 s68, 81920
    buffer_load_dwordx4 v[84:87], v4, s[36:39], s68 offen offset:1024 nt
    v_sub_f32 v34, v34, v73
    v_mul_f32 v34, 0x3fb8aa3b, v34
    v_exp_f32 v34, v34
    s_nop 0
    v_mul_f32 v34, v34, v75
    v_cvt_pk_bf16_f32 v34, v34, v34
    s_mov_b32 s68, 131072
    buffer_load_dwordx4 a[128:131], v7, s[48:51], s68 offen
    buffer_load_dwordx4 a[132:135], v7, s[48:51], s68 offen offset:256
    s_waitcnt vmcnt(8)
    v_and_b32_dpp v16, v33, v8 row_newbcast:8 row_mask:0xf bank_mask:0xf
    v_and_b32_dpp v17, v33, v9 row_newbcast:8 row_mask:0xf bank_mask:0xf
    v_and_b32_dpp v18, v33, v10 row_newbcast:8 row_mask:0xf bank_mask:0xf
    v_and_b32_dpp v19, v33, v11 row_newbcast:8 row_mask:0xf bank_mask:0xf
    s_nop 1
    v_mfma_f32_16x16x32_bf16 v[28:31], v[16:19], v[228:231], v[28:31]
    s_mov_b32 s68, 81920
    buffer_load_dwordx4 v[88:91], v4, s[36:39], s68 offen offset:2048 nt
    v_and_b32_dpp v12, v56, v8 row_newbcast:14 row_mask:0xf bank_mask:0xf
    v_and_b32_dpp v13, v56, v9 row_newbcast:14 row_mask:0xf bank_mask:0xf
    v_and_b32_dpp v14, v56, v10 row_newbcast:14 row_mask:0xf bank_mask:0xf
    v_and_b32_dpp v15, v56, v11 row_newbcast:14 row_mask:0xf bank_mask:0xf
    s_nop 1
    v_mfma_f32_16x16x32_bf16 v[20:23], v[12:15], a[112:115], v[20:23]
    v_mfma_f32_16x16x32_bf16 v[24:27], v[12:15], a[116:119], v[24:27]
    s_waitcnt vmcnt(6)
    v_and_b32_dpp v16, v33, v8 row_newbcast:4 row_mask:0xf bank_mask:0xf
    v_and_b32_dpp v17, v33, v9 row_newbcast:4 row_mask:0xf bank_mask:0xf
    v_and_b32_dpp v18, v33, v10 row_newbcast:4 row_mask:0xf bank_mask:0xf
    v_and_b32_dpp v19, v33, v11 row_newbcast:4 row_mask:0xf bank_mask:0xf
    s_nop 1
    v_mfma_f32_16x16x32_bf16 v[28:31], v[16:19], v[232:235], v[28:31]
    s_mov_b32 s68, 81920
    buffer_load_dwordx4 v[92:95], v4, s[36:39], s68 offen offset:3072 nt
    s_waitcnt vmcnt(6)
    v_and_b32_dpp v12, v33, v8 row_newbcast:12 row_mask:0xf bank_mask:0xf
    v_and_b32_dpp v13, v33, v9 row_newbcast:12 row_mask:0xf bank_mask:0xf
    v_and_b32_dpp v14, v33, v10 row_newbcast:12 row_mask:0xf bank_mask:0xf
    v_and_b32_dpp v15, v33, v11 row_newbcast:12 row_mask:0xf bank_mask:0xf
    s_nop 1
    v_mfma_f32_16x16x32_bf16 v[28:31], v[12:15], v[236:239], v[28:31]
    s_mov_b32 s68, 98304
    buffer_load_dwordx4 v[96:99], v4, s[36:39], s68 offen nt
    s_waitcnt vmcnt(6)
    v_and_b32_dpp v16, v33, v8 row_newbcast:2 row_mask:0xf bank_mask:0xf
    v_and_b32_dpp v17, v33, v9 row_newbcast:2 row_mask:0xf bank_mask:0xf
    v_and_b32_dpp v18, v33, v10 row_newbcast:2 row_mask:0xf bank_mask:0xf
    v_and_b32_dpp v19, v33, v11 row_newbcast:2 row_mask:0xf bank_mask:0xf
    s_nop 1
    v_mfma_f32_16x16x32_bf16 v[28:31], v[16:19], v[80:83], v[28:31]
    s_mov_b32 s68, 98304
    buffer_load_dwordx4 v[100:103], v4, s[36:39], s68 offen offset:1024 nt
    s_mov_b32 s68, 139264
    buffer_load_dwordx4 a[136:139], v7, s[48:51], s68 offen
    buffer_load_dwordx4 a[140:143], v7, s[48:51], s68 offen offset:256
    s_waitcnt vmcnt(8)
    v_and_b32_dpp v12, v33, v8 row_newbcast:10 row_mask:0xf bank_mask:0xf
    v_and_b32_dpp v13, v33, v9 row_newbcast:10 row_mask:0xf bank_mask:0xf
    v_and_b32_dpp v14, v33, v10 row_newbcast:10 row_mask:0xf bank_mask:0xf
    v_and_b32_dpp v15, v33, v11 row_newbcast:10 row_mask:0xf bank_mask:0xf
    s_nop 1
    v_mfma_f32_16x16x32_bf16 v[28:31], v[12:15], v[84:87], v[28:31]
    s_mov_b32 s68, 98304
    buffer_load_dwordx4 v[104:107], v4, s[36:39], s68 offen offset:2048 nt
    v_and_b32_dpp v16, v56, v8 row_newbcast:15 row_mask:0xf bank_mask:0xf
    v_and_b32_dpp v17, v56, v9 row_newbcast:15 row_mask:0xf bank_mask:0xf
    v_and_b32_dpp v18, v56, v10 row_newbcast:15 row_mask:0xf bank_mask:0xf
    v_and_b32_dpp v19, v56, v11 row_newbcast:15 row_mask:0xf bank_mask:0xf
    s_nop 1
    v_mfma_f32_16x16x32_bf16 v[20:23], v[16:19], a[120:123], v[20:23]
    v_mfma_f32_16x16x32_bf16 v[24:27], v[16:19], a[124:127], v[24:27]
    s_waitcnt vmcnt(6)
    v_and_b32_dpp v12, v33, v8 row_newbcast:6 row_mask:0xf bank_mask:0xf
    v_and_b32_dpp v13, v33, v9 row_newbcast:6 row_mask:0xf bank_mask:0xf
    v_and_b32_dpp v14, v33, v10 row_newbcast:6 row_mask:0xf bank_mask:0xf
    v_and_b32_dpp v15, v33, v11 row_newbcast:6 row_mask:0xf bank_mask:0xf
    s_nop 1
    v_mfma_f32_16x16x32_bf16 v[28:31], v[12:15], v[88:91], v[28:31]
    s_mov_b32 s68, 98304
    buffer_load_dwordx4 v[108:111], v4, s[36:39], s68 offen offset:3072 nt
    s_waitcnt vmcnt(6)
    v_and_b32_dpp v16, v33, v8 row_newbcast:14 row_mask:0xf bank_mask:0xf
    v_and_b32_dpp v17, v33, v9 row_newbcast:14 row_mask:0xf bank_mask:0xf
    v_and_b32_dpp v18, v33, v10 row_newbcast:14 row_mask:0xf bank_mask:0xf
    v_and_b32_dpp v19, v33, v11 row_newbcast:14 row_mask:0xf bank_mask:0xf
    s_nop 1
    v_mfma_f32_16x16x32_bf16 v[28:31], v[16:19], v[92:95], v[28:31]
    s_mov_b32 s68, 114688
    buffer_load_dwordx4 v[112:115], v4, s[36:39], s68 offen nt
    s_waitcnt vmcnt(6)
    v_and_b32_dpp v12, v33, v8 row_newbcast:1 row_mask:0xf bank_mask:0xf
    v_and_b32_dpp v13, v33, v9 row_newbcast:1 row_mask:0xf bank_mask:0xf
    v_and_b32_dpp v14, v33, v10 row_newbcast:1 row_mask:0xf bank_mask:0xf
    v_and_b32_dpp v15, v33, v11 row_newbcast:1 row_mask:0xf bank_mask:0xf
    s_nop 1
    v_mfma_f32_16x16x32_bf16 v[28:31], v[12:15], v[96:99], v[28:31]
    s_mov_b32 s68, 114688
    buffer_load_dwordx4 v[116:119], v4, s[36:39], s68 offen offset:1024 nt
    s_mov_b32 s68, 147456
    buffer_load_dwordx4 a[144:147], v7, s[48:51], s68 offen
    buffer_load_dwordx4 a[148:151], v7, s[48:51], s68 offen offset:256
    s_waitcnt vmcnt(8)
    v_and_b32_dpp v16, v33, v8 row_newbcast:9 row_mask:0xf bank_mask:0xf
    v_and_b32_dpp v17, v33, v9 row_newbcast:9 row_mask:0xf bank_mask:0xf
    v_and_b32_dpp v18, v33, v10 row_newbcast:9 row_mask:0xf bank_mask:0xf
    v_and_b32_dpp v19, v33, v11 row_newbcast:9 row_mask:0xf bank_mask:0xf
    s_nop 1
    v_mfma_f32_16x16x32_bf16 v[28:31], v[16:19], v[100:103], v[28:31]
    s_mov_b32 s68, 114688
    buffer_load_dwordx4 v[120:123], v4, s[36:39], s68 offen offset:2048 nt
    v_and_b32_dpp v12, v57, v8 row_newbcast:0 row_mask:0xf bank_mask:0xf
    v_and_b32_dpp v13, v57, v9 row_newbcast:0 row_mask:0xf bank_mask:0xf
    v_and_b32_dpp v14, v57, v10 row_newbcast:0 row_mask:0xf bank_mask:0xf
    v_and_b32_dpp v15, v57, v11 row_newbcast:0 row_mask:0xf bank_mask:0xf
    s_nop 1
    v_mfma_f32_16x16x32_bf16 v[20:23], v[12:15], a[128:131], v[20:23]
    v_mfma_f32_16x16x32_bf16 v[24:27], v[12:15], a[132:135], v[24:27]
    s_waitcnt vmcnt(6)
    v_and_b32_dpp v16, v33, v8 row_newbcast:5 row_mask:0xf bank_mask:0xf
    v_and_b32_dpp v17, v33, v9 row_newbcast:5 row_mask:0xf bank_mask:0xf
    v_and_b32_dpp v18, v33, v10 row_newbcast:5 row_mask:0xf bank_mask:0xf
    v_and_b32_dpp v19, v33, v11 row_newbcast:5 row_mask:0xf bank_mask:0xf
    s_nop 1
    v_mfma_f32_16x16x32_bf16 v[28:31], v[16:19], v[104:107], v[28:31]
    s_mov_b32 s68, 114688
    buffer_load_dwordx4 v[124:127], v4, s[36:39], s68 offen offset:3072 nt
    s_waitcnt vmcnt(6)
    v_and_b32_dpp v12, v33, v8 row_newbcast:13 row_mask:0xf bank_mask:0xf
    v_and_b32_dpp v13, v33, v9 row_newbcast:13 row_mask:0xf bank_mask:0xf
    v_and_b32_dpp v14, v33, v10 row_newbcast:13 row_mask:0xf bank_mask:0xf
    v_and_b32_dpp v15, v33, v11 row_newbcast:13 row_mask:0xf bank_mask:0xf
    s_nop 1
    v_mfma_f32_16x16x32_bf16 v[28:31], v[12:15], v[108:111], v[28:31]
    s_mov_b32 s68, 131072
    buffer_load_dwordx4 v[128:131], v4, s[36:39], s68 offen nt
    s_waitcnt vmcnt(6)
    v_and_b32_dpp v16, v33, v8 row_newbcast:3 row_mask:0xf bank_mask:0xf
    v_and_b32_dpp v17, v33, v9 row_newbcast:3 row_mask:0xf bank_mask:0xf
    v_and_b32_dpp v18, v33, v10 row_newbcast:3 row_mask:0xf bank_mask:0xf
    v_and_b32_dpp v19, v33, v11 row_newbcast:3 row_mask:0xf bank_mask:0xf
    s_nop 1
    v_mfma_f32_16x16x32_bf16 v[28:31], v[16:19], v[112:115], v[28:31]
    s_mov_b32 s68, 131072
    buffer_load_dwordx4 v[132:135], v4, s[36:39], s68 offen offset:1024 nt
    s_mov_b32 s68, 155648
    buffer_load_dwordx4 a[152:155], v7, s[48:51], s68 offen
    buffer_load_dwordx4 a[156:159], v7, s[48:51], s68 offen offset:256
    s_waitcnt vmcnt(8)
    v_and_b32_dpp v12, v33, v8 row_newbcast:11 row_mask:0xf bank_mask:0xf
    v_and_b32_dpp v13, v33, v9 row_newbcast:11 row_mask:0xf bank_mask:0xf
    v_and_b32_dpp v14, v33, v10 row_newbcast:11 row_mask:0xf bank_mask:0xf
    v_and_b32_dpp v15, v33, v11 row_newbcast:11 row_mask:0xf bank_mask:0xf
    s_nop 1
    v_mfma_f32_16x16x32_bf16 v[28:31], v[12:15], v[116:119], v[28:31]
    s_mov_b32 s68, 131072
    buffer_load_dwordx4 v[136:139], v4, s[36:39], s68 offen offset:2048 nt
    v_and_b32_dpp v16, v57, v8 row_newbcast:1 row_mask:0xf bank_mask:0xf
    v_and_b32_dpp v17, v57, v9 row_newbcast:1 row_mask:0xf bank_mask:0xf
    v_and_b32_dpp v18, v57, v10 row_newbcast:1 row_mask:0xf bank_mask:0xf
    v_and_b32_dpp v19, v57, v11 row_newbcast:1 row_mask:0xf bank_mask:0xf
    s_nop 1
    v_mfma_f32_16x16x32_bf16 v[20:23], v[16:19], a[136:139], v[20:23]
    v_mfma_f32_16x16x32_bf16 v[24:27], v[16:19], a[140:143], v[24:27]
    s_waitcnt vmcnt(6)
    v_and_b32_dpp v12, v33, v8 row_newbcast:7 row_mask:0xf bank_mask:0xf
    v_and_b32_dpp v13, v33, v9 row_newbcast:7 row_mask:0xf bank_mask:0xf
    v_and_b32_dpp v14, v33, v10 row_newbcast:7 row_mask:0xf bank_mask:0xf
    v_and_b32_dpp v15, v33, v11 row_newbcast:7 row_mask:0xf bank_mask:0xf
    s_nop 1
    v_mfma_f32_16x16x32_bf16 v[28:31], v[12:15], v[120:123], v[28:31]
    s_mov_b32 s68, 131072
    buffer_load_dwordx4 v[140:143], v4, s[36:39], s68 offen offset:3072 nt
    s_waitcnt vmcnt(6)
    v_and_b32_dpp v16, v33, v8 row_newbcast:15 row_mask:0xf bank_mask:0xf
    v_and_b32_dpp v17, v33, v9 row_newbcast:15 row_mask:0xf bank_mask:0xf
    v_and_b32_dpp v18, v33, v10 row_newbcast:15 row_mask:0xf bank_mask:0xf
    v_and_b32_dpp v19, v33, v11 row_newbcast:15 row_mask:0xf bank_mask:0xf
    s_nop 1
    v_mfma_f32_16x16x32_bf16 v[28:31], v[16:19], v[124:127], v[28:31]
    s_mov_b32 s68, 147456
    buffer_load_dwordx4 v[144:147], v4, s[36:39], s68 offen nt
    s_waitcnt vmcnt(6)
    v_and_b32_dpp v12, v34, v8 row_newbcast:0 row_mask:0xf bank_mask:0xf
    v_and_b32_dpp v13, v34, v9 row_newbcast:0 row_mask:0xf bank_mask:0xf
    v_and_b32_dpp v14, v34, v10 row_newbcast:0 row_mask:0xf bank_mask:0xf
    v_and_b32_dpp v15, v34, v11 row_newbcast:0 row_mask:0xf bank_mask:0xf
    s_nop 1
    v_mfma_f32_16x16x32_bf16 v[28:31], v[12:15], v[128:131], v[28:31]
    s_mov_b32 s68, 147456
    buffer_load_dwordx4 v[148:151], v4, s[36:39], s68 offen offset:1024 nt
    v_sub_f32 v35, v35, v73
    v_mul_f32 v35, 0x3fb8aa3b, v35
    v_exp_f32 v35, v35
    s_nop 0
    v_mul_f32 v35, v35, v75
    v_cvt_pk_bf16_f32 v35, v35, v35
    s_mov_b32 s68, 163840
    buffer_load_dwordx4 a[160:163], v7, s[48:51], s68 offen
    buffer_load_dwordx4 a[164:167], v7, s[48:51], s68 offen offset:256
    s_waitcnt vmcnt(8)
    v_and_b32_dpp v16, v34, v8 row_newbcast:8 row_mask:0xf bank_mask:0xf
    v_and_b32_dpp v17, v34, v9 row_newbcast:8 row_mask:0xf bank_mask:0xf
    v_and_b32_dpp v18, v34, v10 row_newbcast:8 row_mask:0xf bank_mask:0xf
    v_and_b32_dpp v19, v34, v11 row_newbcast:8 row_mask:0xf bank_mask:0xf
    s_nop 1
    v_mfma_f32_16x16x32_bf16 v[28:31], v[16:19], v[132:135], v[28:31]
    s_mov_b32 s68, 147456
    buffer_load_dwordx4 v[152:155], v4, s[36:39], s68 offen offset:2048 nt
    v_and_b32_dpp v12, v57, v8 row_newbcast:2 row_mask:0xf bank_mask:0xf
    v_and_b32_dpp v13, v57, v9 row_newbcast:2 row_mask:0xf bank_mask:0xf
    v_and_b32_dpp v14, v57, v10 row_newbcast:2 row_mask:0xf bank_mask:0xf
    v_and_b32_dpp v15, v57, v11 row_newbcast:2 row_mask:0xf bank_mask:0xf
    s_nop 1
    v_mfma_f32_16x16x32_bf16 v[20:23], v[12:15], a[144:147], v[20:23]
    v_mfma_f32_16x16x32_bf16 v[24:27], v[12:15], a[148:151], v[24:27]
    s_waitcnt vmcnt(6)
    v_and_b32_dpp v16, v34, v8 row_newbcast:4 row_mask:0xf bank_mask:0xf
    v_and_b32_dpp v17, v34, v9 row_newbcast:4 row_mask:0xf bank_mask:0xf
    v_and_b32_dpp v18, v34, v10 row_newbcast:4 row_mask:0xf bank_mask:0xf
    v_and_b32_dpp v19, v34, v11 row_newbcast:4 row_mask:0xf bank_mask:0xf
    s_nop 1
    v_mfma_f32_16x16x32_bf16 v[28:31], v[16:19], v[136:139], v[28:31]
    s_mov_b32 s68, 147456
    buffer_load_dwordx4 v[156:159], v4, s[36:39], s68 offen offset:3072 nt
    s_waitcnt vmcnt(6)
    v_and_b32_dpp v12, v34, v8 row_newbcast:12 row_mask:0xf bank_mask:0xf
    v_and_b32_dpp v13, v34, v9 row_newbcast:12 row_mask:0xf bank_mask:0xf
    v_and_b32_dpp v14, v34, v10 row_newbcast:12 row_mask:0xf bank_mask:0xf
    v_and_b32_dpp v15, v34, v11 row_newbcast:12 row_mask:0xf bank_mask:0xf
    s_nop 1
    v_mfma_f32_16x16x32_bf16 v[28:31], v[12:15], v[140:143], v[28:31]
    s_mov_b32 s68, 163840
    buffer_load_dwordx4 v[160:163], v4, s[36:39], s68 offen nt
    s_waitcnt vmcnt(6)
    v_and_b32_dpp v16, v34, v8 row_newbcast:2 row_mask:0xf bank_mask:0xf
    v_and_b32_dpp v17, v34, v9 row_newbcast:2 row_mask:0xf bank_mask:0xf
    v_and_b32_dpp v18, v34, v10 row_newbcast:2 row_mask:0xf bank_mask:0xf
    v_and_b32_dpp v19, v34, v11 row_newbcast:2 row_mask:0xf bank_mask:0xf
    s_nop 1
    v_mfma_f32_16x16x32_bf16 v[28:31], v[16:19], v[144:147], v[28:31]
    s_mov_b32 s68, 163840
    buffer_load_dwordx4 v[164:167], v4, s[36:39], s68 offen offset:1024 nt
    s_mov_b32 s68, 172032
    buffer_load_dwordx4 a[168:171], v7, s[48:51], s68 offen
    buffer_load_dwordx4 a[172:175], v7, s[48:51], s68 offen offset:256
    s_waitcnt vmcnt(8)
    v_and_b32_dpp v12, v34, v8 row_newbcast:10 row_mask:0xf bank_mask:0xf
    v_and_b32_dpp v13, v34, v9 row_newbcast:10 row_mask:0xf bank_mask:0xf
    v_and_b32_dpp v14, v34, v10 row_newbcast:10 row_mask:0xf bank_mask:0xf
    v_and_b32_dpp v15, v34, v11 row_newbcast:10 row_mask:0xf bank_mask:0xf
    s_nop 1
    v_mfma_f32_16x16x32_bf16 v[28:31], v[12:15], v[148:151], v[28:31]
    s_mov_b32 s68, 163840
    buffer_load_dwordx4 v[168:171], v4, s[36:39], s68 offen offset:2048 nt
    v_and_b32_dpp v16, v57, v8 row_newbcast:3 row_mask:0xf bank_mask:0xf
    v_and_b32_dpp v17, v57, v9 row_newbcast:3 row_mask:0xf bank_mask:0xf
    v_and_b32_dpp v18, v57, v10 row_newbcast:3 row_mask:0xf bank_mask:0xf
    v_and_b32_dpp v19, v57, v11 row_newbcast:3 row_mask:0xf bank_mask:0xf
    s_nop 1
    v_mfma_f32_16x16x32_bf16 v[20:23], v[16:19], a[152:155], v[20:23]
    v_mfma_f32_16x16x32_bf16 v[24:27], v[16:19], a[156:159], v[24:27]
    s_waitcnt vmcnt(6)
    v_and_b32_dpp v12, v34, v8 row_newbcast:6 row_mask:0xf bank_mask:0xf
    v_and_b32_dpp v13, v34, v9 row_newbcast:6 row_mask:0xf bank_mask:0xf
    v_and_b32_dpp v14, v34, v10 row_newbcast:6 row_mask:0xf bank_mask:0xf
    v_and_b32_dpp v15, v34, v11 row_newbcast:6 row_mask:0xf bank_mask:0xf
    s_nop 1
    v_mfma_f32_16x16x32_bf16 v[28:31], v[12:15], v[152:155], v[28:31]
    s_mov_b32 s68, 163840
    buffer_load_dwordx4 v[172:175], v4, s[36:39], s68 offen offset:3072 nt
    s_waitcnt vmcnt(6)
    v_and_b32_dpp v16, v34, v8 row_newbcast:14 row_mask:0xf bank_mask:0xf
    v_and_b32_dpp v17, v34, v9 row_newbcast:14 row_mask:0xf bank_mask:0xf
    v_and_b32_dpp v18, v34, v10 row_newbcast:14 row_mask:0xf bank_mask:0xf
    v_and_b32_dpp v19, v34, v11 row_newbcast:14 row_mask:0xf bank_mask:0xf
    s_nop 1
    v_mfma_f32_16x16x32_bf16 v[28:31], v[16:19], v[156:159], v[28:31]
    s_mov_b32 s68, 180224
    buffer_load_dwordx4 v[176:179], v4, s[36:39], s68 offen nt
    s_waitcnt vmcnt(6)
    v_and_b32_dpp v12, v34, v8 row_newbcast:1 row_mask:0xf bank_mask:0xf
    v_and_b32_dpp v13, v34, v9 row_newbcast:1 row_mask:0xf bank_mask:0xf
    v_and_b32_dpp v14, v34, v10 row_newbcast:1 row_mask:0xf bank_mask:0xf
    v_and_b32_dpp v15, v34, v11 row_newbcast:1 row_mask:0xf bank_mask:0xf
    s_nop 1
    v_mfma_f32_16x16x32_bf16 v[28:31], v[12:15], v[160:163], v[28:31]
    s_mov_b32 s68, 180224
    buffer_load_dwordx4 v[180:183], v4, s[36:39], s68 offen offset:1024 nt
    s_mov_b32 s68, 180224
    buffer_load_dwordx4 a[176:179], v7, s[48:51], s68 offen
    buffer_load_dwordx4 a[180:183], v7, s[48:51], s68 offen offset:256
    s_waitcnt vmcnt(8)
    v_and_b32_dpp v16, v34, v8 row_newbcast:9 row_mask:0xf bank_mask:0xf
    v_and_b32_dpp v17, v34, v9 row_newbcast:9 row_mask:0xf bank_mask:0xf
    v_and_b32_dpp v18, v34, v10 row_newbcast:9 row_mask:0xf bank_mask:0xf
    v_and_b32_dpp v19, v34, v11 row_newbcast:9 row_mask:0xf bank_mask:0xf
    s_nop 1
    v_mfma_f32_16x16x32_bf16 v[28:31], v[16:19], v[164:167], v[28:31]
    s_mov_b32 s68, 180224
    buffer_load_dwordx4 v[184:187], v4, s[36:39], s68 offen offset:2048 nt
    v_and_b32_dpp v12, v57, v8 row_newbcast:4 row_mask:0xf bank_mask:0xf
    v_and_b32_dpp v13, v57, v9 row_newbcast:4 row_mask:0xf bank_mask:0xf
    v_and_b32_dpp v14, v57, v10 row_newbcast:4 row_mask:0xf bank_mask:0xf
    v_and_b32_dpp v15, v57, v11 row_newbcast:4 row_mask:0xf bank_mask:0xf
    s_nop 1
    v_mfma_f32_16x16x32_bf16 v[20:23], v[12:15], a[160:163], v[20:23]
    v_mfma_f32_16x16x32_bf16 v[24:27], v[12:15], a[164:167], v[24:27]
    s_waitcnt vmcnt(6)
    v_and_b32_dpp v16, v34, v8 row_newbcast:5 row_mask:0xf bank_mask:0xf
    v_and_b32_dpp v17, v34, v9 row_newbcast:5 row_mask:0xf bank_mask:0xf
    v_and_b32_dpp v18, v34, v10 row_newbcast:5 row_mask:0xf bank_mask:0xf
    v_and_b32_dpp v19, v34, v11 row_newbcast:5 row_mask:0xf bank_mask:0xf
    s_nop 1
    v_mfma_f32_16x16x32_bf16 v[28:31], v[16:19], v[168:171], v[28:31]
    s_mov_b32 s68, 180224
    buffer_load_dwordx4 v[188:191], v4, s[36:39], s68 offen offset:3072 nt
    s_waitcnt vmcnt(6)
    v_and_b32_dpp v12, v34, v8 row_newbcast:13 row_mask:0xf bank_mask:0xf
    v_and_b32_dpp v13, v34, v9 row_newbcast:13 row_mask:0xf bank_mask:0xf
    v_and_b32_dpp v14, v34, v10 row_newbcast:13 row_mask:0xf bank_mask:0xf
    v_and_b32_dpp v15, v34, v11 row_newbcast:13 row_mask:0xf bank_mask:0xf
    s_nop 1
    v_mfma_f32_16x16x32_bf16 v[28:31], v[12:15], v[172:175], v[28:31]
    s_mov_b32 s68, 196608
    buffer_load_dwordx4 v[192:195], v4, s[36:39], s68 offen nt
    s_waitcnt vmcnt(6)
    v_and_b32_dpp v16, v34, v8 row_newbcast:3 row_mask:0xf bank_mask:0xf
    v_and_b32_dpp v17, v34, v9 row_newbcast:3 row_mask:0xf bank_mask:0xf
    v_and_b32_dpp v18, v34, v10 row_newbcast:3 row_mask:0xf bank_mask:0xf
    v_and_b32_dpp v19, v34, v11 row_newbcast:3 row_mask:0xf bank_mask:0xf
    s_nop 1
    v_mfma_f32_16x16x32_bf16 v[28:31], v[16:19], v[176:179], v[28:31]
    s_mov_b32 s68, 196608
    buffer_load_dwordx4 v[196:199], v4, s[36:39], s68 offen offset:1024 nt
    s_mov_b32 s68, 188416
    buffer_load_dwordx4 a[184:187], v7, s[48:51], s68 offen
    buffer_load_dwordx4 a[188:191], v7, s[48:51], s68 offen offset:256
    s_waitcnt vmcnt(8)
    v_and_b32_dpp v12, v34, v8 row_newbcast:11 row_mask:0xf bank_mask:0xf
    v_and_b32_dpp v13, v34, v9 row_newbcast:11 row_mask:0xf bank_mask:0xf
    v_and_b32_dpp v14, v34, v10 row_newbcast:11 row_mask:0xf bank_mask:0xf
    v_and_b32_dpp v15, v34, v11 row_newbcast:11 row_mask:0xf bank_mask:0xf
    s_nop 1
    v_mfma_f32_16x16x32_bf16 v[28:31], v[12:15], v[180:183], v[28:31]
    s_mov_b32 s68, 196608
    buffer_load_dwordx4 v[200:203], v4, s[36:39], s68 offen offset:2048 nt
    v_and_b32_dpp v16, v57, v8 row_newbcast:5 row_mask:0xf bank_mask:0xf
    v_and_b32_dpp v17, v57, v9 row_newbcast:5 row_mask:0xf bank_mask:0xf
    v_and_b32_dpp v18, v57, v10 row_newbcast:5 row_mask:0xf bank_mask:0xf
    v_and_b32_dpp v19, v57, v11 row_newbcast:5 row_mask:0xf bank_mask:0xf
    s_nop 1
    v_mfma_f32_16x16x32_bf16 v[20:23], v[16:19], a[168:171], v[20:23]
    v_mfma_f32_16x16x32_bf16 v[24:27], v[16:19], a[172:175], v[24:27]
    s_waitcnt vmcnt(6)
    v_and_b32_dpp v12, v34, v8 row_newbcast:7 row_mask:0xf bank_mask:0xf
    v_and_b32_dpp v13, v34, v9 row_newbcast:7 row_mask:0xf bank_mask:0xf
    v_and_b32_dpp v14, v34, v10 row_newbcast:7 row_mask:0xf bank_mask:0xf
    v_and_b32_dpp v15, v34, v11 row_newbcast:7 row_mask:0xf bank_mask:0xf
    s_nop 1
    v_mfma_f32_16x16x32_bf16 v[28:31], v[12:15], v[184:187], v[28:31]
    s_mov_b32 s68, 196608
    buffer_load_dwordx4 v[204:207], v4, s[36:39], s68 offen offset:3072 nt
    s_waitcnt vmcnt(6)
    v_and_b32_dpp v16, v34, v8 row_newbcast:15 row_mask:0xf bank_mask:0xf
    v_and_b32_dpp v17, v34, v9 row_newbcast:15 row_mask:0xf bank_mask:0xf
    v_and_b32_dpp v18, v34, v10 row_newbcast:15 row_mask:0xf bank_mask:0xf
    v_and_b32_dpp v19, v34, v11 row_newbcast:15 row_mask:0xf bank_mask:0xf
    s_nop 1
    v_mfma_f32_16x16x32_bf16 v[28:31], v[16:19], v[188:191], v[28:31]
    s_mov_b32 s68, 212992
    buffer_load_dwordx4 v[208:211], v4, s[36:39], s68 offen nt
    s_waitcnt vmcnt(6)
    v_and_b32_dpp v12, v35, v8 row_newbcast:0 row_mask:0xf bank_mask:0xf
    v_and_b32_dpp v13, v35, v9 row_newbcast:0 row_mask:0xf bank_mask:0xf
    v_and_b32_dpp v14, v35, v10 row_newbcast:0 row_mask:0xf bank_mask:0xf
    v_and_b32_dpp v15, v35, v11 row_newbcast:0 row_mask:0xf bank_mask:0xf
    s_nop 1
    v_mfma_f32_16x16x32_bf16 v[28:31], v[12:15], v[192:195], v[28:31]
    s_mov_b32 s68, 212992
    buffer_load_dwordx4 v[212:215], v4, s[36:39], s68 offen offset:1024 nt
    v_sub_f32 v36, v36, v73
    v_mul_f32 v36, 0x3fb8aa3b, v36
    v_exp_f32 v36, v36
    s_nop 0
    v_mul_f32 v36, v36, v75
    v_cvt_pk_bf16_f32 v36, v36, v36
    s_mov_b32 s68, 196608
    buffer_load_dwordx4 a[192:195], v7, s[48:51], s68 offen
    buffer_load_dwordx4 a[196:199], v7, s[48:51], s68 offen offset:256
    s_waitcnt vmcnt(8)
    v_and_b32_dpp v16, v35, v8 row_newbcast:8 row_mask:0xf bank_mask:0xf
    v_and_b32_dpp v17, v35, v9 row_newbcast:8 row_mask:0xf bank_mask:0xf
    v_and_b32_dpp v18, v35, v10 row_newbcast:8 row_mask:0xf bank_mask:0xf
    v_and_b32_dpp v19, v35, v11 row_newbcast:8 row_mask:0xf bank_mask:0xf
    s_nop 1
    v_mfma_f32_16x16x32_bf16 v[28:31], v[16:19], v[196:199], v[28:31]
    s_mov_b32 s68, 212992
    buffer_load_dwordx4 v[216:219], v4, s[36:39], s68 offen offset:2048 nt
    v_and_b32_dpp v12, v57, v8 row_newbcast:6 row_mask:0xf bank_mask:0xf
    v_and_b32_dpp v13, v57, v9 row_newbcast:6 row_mask:0xf bank_mask:0xf
    v_and_b32_dpp v14, v57, v10 row_newbcast:6 row_mask:0xf bank_mask:0xf
    v_and_b32_dpp v15, v57, v11 row_newbcast:6 row_mask:0xf bank_mask:0xf
    s_nop 1
    v_mfma_f32_16x16x32_bf16 v[20:23], v[12:15], a[176:179], v[20:23]
    v_mfma_f32_16x16x32_bf16 v[24:27], v[12:15], a[180:183], v[24:27]
    s_waitcnt vmcnt(6)
    v_and_b32_dpp v16, v35, v8 row_newbcast:4 row_mask:0xf bank_mask:0xf
    v_and_b32_dpp v17, v35, v9 row_newbcast:4 row_mask:0xf bank_mask:0xf
    v_and_b32_dpp v18, v35, v10 row_newbcast:4 row_mask:0xf bank_mask:0xf
    v_and_b32_dpp v19, v35, v11 row_newbcast:4 row_mask:0xf bank_mask:0xf
    s_nop 1
    v_mfma_f32_16x16x32_bf16 v[28:31], v[16:19], v[200:203], v[28:31]
    s_mov_b32 s68, 212992
    buffer_load_dwordx4 v[220:223], v4, s[36:39], s68 offen offset:3072 nt
    s_waitcnt vmcnt(6)
    v_and_b32_dpp v12, v35, v8 row_newbcast:12 row_mask:0xf bank_mask:0xf
    v_and_b32_dpp v13, v35, v9 row_newbcast:12 row_mask:0xf bank_mask:0xf
    v_and_b32_dpp v14, v35, v10 row_newbcast:12 row_mask:0xf bank_mask:0xf
    v_and_b32_dpp v15, v35, v11 row_newbcast:12 row_mask:0xf bank_mask:0xf
    s_nop 1
    v_mfma_f32_16x16x32_bf16 v[28:31], v[12:15], v[204:207], v[28:31]
    s_mov_b32 s68, 229376
    buffer_load_dwordx4 v[224:227], v4, s[36:39], s68 offen nt
    s_waitcnt vmcnt(6)
    v_and_b32_dpp v16, v35, v8 row_newbcast:2 row_mask:0xf bank_mask:0xf
    v_and_b32_dpp v17, v35, v9 row_newbcast:2 row_mask:0xf bank_mask:0xf
    v_and_b32_dpp v18, v35, v10 row_newbcast:2 row_mask:0xf bank_mask:0xf
    v_and_b32_dpp v19, v35, v11 row_newbcast:2 row_mask:0xf bank_mask:0xf
    s_nop 1
    v_mfma_f32_16x16x32_bf16 v[28:31], v[16:19], v[208:211], v[28:31]
    s_mov_b32 s68, 229376
    buffer_load_dwordx4 v[228:231], v4, s[36:39], s68 offen offset:1024 nt
    s_mov_b32 s68, 204800
    buffer_load_dwordx4 a[200:203], v7, s[48:51], s68 offen
    buffer_load_dwordx4 a[204:207], v7, s[48:51], s68 offen offset:256
    s_waitcnt vmcnt(8)
    v_and_b32_dpp v12, v35, v8 row_newbcast:10 row_mask:0xf bank_mask:0xf
    v_and_b32_dpp v13, v35, v9 row_newbcast:10 row_mask:0xf bank_mask:0xf
    v_and_b32_dpp v14, v35, v10 row_newbcast:10 row_mask:0xf bank_mask:0xf
    v_and_b32_dpp v15, v35, v11 row_newbcast:10 row_mask:0xf bank_mask:0xf
    s_nop 1
    v_mfma_f32_16x16x32_bf16 v[28:31], v[12:15], v[212:215], v[28:31]
    s_mov_b32 s68, 229376
    buffer_load_dwordx4 v[232:235], v4, s[36:39], s68 offen offset:2048 nt
    v_and_b32_dpp v16, v57, v8 row_newbcast:7 row_mask:0xf bank_mask:0xf
    v_and_b32_dpp v17, v57, v9 row_newbcast:7 row_mask:0xf bank_mask:0xf
    v_and_b32_dpp v18, v57, v10 row_newbcast:7 row_mask:0xf bank_mask:0xf
    v_and_b32_dpp v19, v57, v11 row_newbcast:7 row_mask:0xf bank_mask:0xf
    s_nop 1
    v_mfma_f32_16x16x32_bf16 v[20:23], v[16:19], a[184:187], v[20:23]
    v_mfma_f32_16x16x32_bf16 v[24:27], v[16:19], a[188:191], v[24:27]
    s_waitcnt vmcnt(6)
    v_and_b32_dpp v12, v35, v8 row_newbcast:6 row_mask:0xf bank_mask:0xf
    v_and_b32_dpp v13, v35, v9 row_newbcast:6 row_mask:0xf bank_mask:0xf
    v_and_b32_dpp v14, v35, v10 row_newbcast:6 row_mask:0xf bank_mask:0xf
    v_and_b32_dpp v15, v35, v11 row_newbcast:6 row_mask:0xf bank_mask:0xf
    s_nop 1
    v_mfma_f32_16x16x32_bf16 v[28:31], v[12:15], v[216:219], v[28:31]
    s_mov_b32 s68, 229376
    buffer_load_dwordx4 v[236:239], v4, s[36:39], s68 offen offset:3072 nt
    s_waitcnt vmcnt(6)
    v_and_b32_dpp v16, v35, v8 row_newbcast:14 row_mask:0xf bank_mask:0xf
    v_and_b32_dpp v17, v35, v9 row_newbcast:14 row_mask:0xf bank_mask:0xf
    v_and_b32_dpp v18, v35, v10 row_newbcast:14 row_mask:0xf bank_mask:0xf
    v_and_b32_dpp v19, v35, v11 row_newbcast:14 row_mask:0xf bank_mask:0xf
    s_nop 1
    v_mfma_f32_16x16x32_bf16 v[28:31], v[16:19], v[220:223], v[28:31]
    s_mov_b32 s68, 245760
    buffer_load_dwordx4 v[80:83], v4, s[36:39], s68 offen nt
    s_waitcnt vmcnt(6)
    v_and_b32_dpp v12, v35, v8 row_newbcast:1 row_mask:0xf bank_mask:0xf
    v_and_b32_dpp v13, v35, v9 row_newbcast:1 row_mask:0xf bank_mask:0xf
    v_and_b32_dpp v14, v35, v10 row_newbcast:1 row_mask:0xf bank_mask:0xf
    v_and_b32_dpp v15, v35, v11 row_newbcast:1 row_mask:0xf bank_mask:0xf
    s_nop 1
    v_mfma_f32_16x16x32_bf16 v[28:31], v[12:15], v[224:227], v[28:31]
    s_mov_b32 s68, 245760
    buffer_load_dwordx4 v[84:87], v4, s[36:39], s68 offen offset:1024 nt
    s_mov_b32 s68, 212992
    buffer_load_dwordx4 a[208:211], v7, s[48:51], s68 offen
    buffer_load_dwordx4 a[212:215], v7, s[48:51], s68 offen offset:256
    s_waitcnt vmcnt(8)
    v_and_b32_dpp v16, v35, v8 row_newbcast:9 row_mask:0xf bank_mask:0xf
    v_and_b32_dpp v17, v35, v9 row_newbcast:9 row_mask:0xf bank_mask:0xf
    v_and_b32_dpp v18, v35, v10 row_newbcast:9 row_mask:0xf bank_mask:0xf
    v_and_b32_dpp v19, v35, v11 row_newbcast:9 row_mask:0xf bank_mask:0xf
    s_nop 1
    v_mfma_f32_16x16x32_bf16 v[28:31], v[16:19], v[228:231], v[28:31]
    s_mov_b32 s68, 245760
    buffer_load_dwordx4 v[88:91], v4, s[36:39], s68 offen offset:2048 nt
    v_and_b32_dpp v12, v57, v8 row_newbcast:8 row_mask:0xf bank_mask:0xf
    v_and_b32_dpp v13, v57, v9 row_newbcast:8 row_mask:0xf bank_mask:0xf
    v_and_b32_dpp v14, v57, v10 row_newbcast:8 row_mask:0xf bank_mask:0xf
    v_and_b32_dpp v15, v57, v11 row_newbcast:8 row_mask:0xf bank_mask:0xf
    s_nop 1
    v_mfma_f32_16x16x32_bf16 v[20:23], v[12:15], a[192:195], v[20:23]
    v_mfma_f32_16x16x32_bf16 v[24:27], v[12:15], a[196:199], v[24:27]
    s_waitcnt vmcnt(6)
    v_and_b32_dpp v16, v35, v8 row_newbcast:5 row_mask:0xf bank_mask:0xf
    v_and_b32_dpp v17, v35, v9 row_newbcast:5 row_mask:0xf bank_mask:0xf
    v_and_b32_dpp v18, v35, v10 row_newbcast:5 row_mask:0xf bank_mask:0xf
    v_and_b32_dpp v19, v35, v11 row_newbcast:5 row_mask:0xf bank_mask:0xf
    s_nop 1
    v_mfma_f32_16x16x32_bf16 v[28:31], v[16:19], v[232:235], v[28:31]
    s_mov_b32 s68, 245760
    buffer_load_dwordx4 v[92:95], v4, s[36:39], s68 offen offset:3072 nt
    s_waitcnt vmcnt(6)
    v_and_b32_dpp v12, v35, v8 row_newbcast:13 row_mask:0xf bank_mask:0xf
    v_and_b32_dpp v13, v35, v9 row_newbcast:13 row_mask:0xf bank_mask:0xf
    v_and_b32_dpp v14, v35, v10 row_newbcast:13 row_mask:0xf bank_mask:0xf
    v_and_b32_dpp v15, v35, v11 row_newbcast:13 row_mask:0xf bank_mask:0xf
    s_nop 1
    v_mfma_f32_16x16x32_bf16 v[28:31], v[12:15], v[236:239], v[28:31]
    s_mov_b32 s68, 262144
    buffer_load_dwordx4 v[96:99], v4, s[36:39], s68 offen nt
    s_waitcnt vmcnt(6)
    v_and_b32_dpp v16, v35, v8 row_newbcast:3 row_mask:0xf bank_mask:0xf
    v_and_b32_dpp v17, v35, v9 row_newbcast:3 row_mask:0xf bank_mask:0xf
    v_and_b32_dpp v18, v35, v10 row_newbcast:3 row_mask:0xf bank_mask:0xf
    v_and_b32_dpp v19, v35, v11 row_newbcast:3 row_mask:0xf bank_mask:0xf
    s_nop 1
    v_mfma_f32_16x16x32_bf16 v[28:31], v[16:19], v[80:83], v[28:31]
    s_mov_b32 s68, 262144
    buffer_load_dwordx4 v[100:103], v4, s[36:39], s68 offen offset:1024 nt
    s_mov_b32 s68, 221184
    buffer_load_dwordx4 a[216:219], v7, s[48:51], s68 offen
    buffer_load_dwordx4 a[220:223], v7, s[48:51], s68 offen offset:256
    s_waitcnt vmcnt(8)
    v_and_b32_dpp v12, v35, v8 row_newbcast:11 row_mask:0xf bank_mask:0xf
    v_and_b32_dpp v13, v35, v9 row_newbcast:11 row_mask:0xf bank_mask:0xf
    v_and_b32_dpp v14, v35, v10 row_newbcast:11 row_mask:0xf bank_mask:0xf
    v_and_b32_dpp v15, v35, v11 row_newbcast:11 row_mask:0xf bank_mask:0xf
    s_nop 1
    v_mfma_f32_16x16x32_bf16 v[28:31], v[12:15], v[84:87], v[28:31]
    s_mov_b32 s68, 262144
    buffer_load_dwordx4 v[104:107], v4, s[36:39], s68 offen offset:2048 nt
    v_and_b32_dpp v16, v57, v8 row_newbcast:9 row_mask:0xf bank_mask:0xf
    v_and_b32_dpp v17, v57, v9 row_newbcast:9 row_mask:0xf bank_mask:0xf
    v_and_b32_dpp v18, v57, v10 row_newbcast:9 row_mask:0xf bank_mask:0xf
    v_and_b32_dpp v19, v57, v11 row_newbcast:9 row_mask:0xf bank_mask:0xf
    s_nop 1
    v_mfma_f32_16x16x32_bf16 v[20:23], v[16:19], a[200:203], v[20:23]
    v_mfma_f32_16x16x32_bf16 v[24:27], v[16:19], a[204:207], v[24:27]
    s_waitcnt vmcnt(6)
    v_and_b32_dpp v12, v35, v8 row_newbcast:7 row_mask:0xf bank_mask:0xf
    v_and_b32_dpp v13, v35, v9 row_newbcast:7 row_mask:0xf bank_mask:0xf
    v_and_b32_dpp v14, v35, v10 row_newbcast:7 row_mask:0xf bank_mask:0xf
    v_and_b32_dpp v15, v35, v11 row_newbcast:7 row_mask:0xf bank_mask:0xf
    s_nop 1
    v_mfma_f32_16x16x32_bf16 v[28:31], v[12:15], v[88:91], v[28:31]
    s_mov_b32 s68, 262144
    buffer_load_dwordx4 v[108:111], v4, s[36:39], s68 offen offset:3072 nt
    s_waitcnt vmcnt(6)
    v_and_b32_dpp v16, v35, v8 row_newbcast:15 row_mask:0xf bank_mask:0xf
    v_and_b32_dpp v17, v35, v9 row_newbcast:15 row_mask:0xf bank_mask:0xf
    v_and_b32_dpp v18, v35, v10 row_newbcast:15 row_mask:0xf bank_mask:0xf
    v_and_b32_dpp v19, v35, v11 row_newbcast:15 row_mask:0xf bank_mask:0xf
    s_nop 1
    v_mfma_f32_16x16x32_bf16 v[28:31], v[16:19], v[92:95], v[28:31]
    s_mov_b32 s68, 278528
    buffer_load_dwordx4 v[112:115], v4, s[36:39], s68 offen nt
    s_waitcnt vmcnt(6)
    v_and_b32_dpp v12, v36, v8 row_newbcast:0 row_mask:0xf bank_mask:0xf
    v_and_b32_dpp v13, v36, v9 row_newbcast:0 row_mask:0xf bank_mask:0xf
    v_and_b32_dpp v14, v36, v10 row_newbcast:0 row_mask:0xf bank_mask:0xf
    v_and_b32_dpp v15, v36, v11 row_newbcast:0 row_mask:0xf bank_mask:0xf
    s_nop 1
    v_mfma_f32_16x16x32_bf16 v[28:31], v[12:15], v[96:99], v[28:31]
    s_mov_b32 s68, 278528
    buffer_load_dwordx4 v[116:119], v4, s[36:39], s68 offen offset:1024 nt
    v_sub_f32 v37, v37, v73
    v_mul_f32 v37, 0x3fb8aa3b, v37
    v_exp_f32 v37, v37
    s_nop 0
    v_mul_f32 v37, v37, v75
    v_cvt_pk_bf16_f32 v37, v37, v37
    s_mov_b32 s68, 0
    buffer_load_dwordx4 a[0:3], v7, s[52:55], s68 offen
    buffer_load_dwordx4 a[4:7], v7, s[52:55], s68 offen offset:256
    s_waitcnt vmcnt(8)
    v_and_b32_dpp v16, v36, v8 row_newbcast:8 row_mask:0xf bank_mask:0xf
    v_and_b32_dpp v17, v36, v9 row_newbcast:8 row_mask:0xf bank_mask:0xf
    v_and_b32_dpp v18, v36, v10 row_newbcast:8 row_mask:0xf bank_mask:0xf
    v_and_b32_dpp v19, v36, v11 row_newbcast:8 row_mask:0xf bank_mask:0xf
    s_nop 1
    v_mfma_f32_16x16x32_bf16 v[28:31], v[16:19], v[100:103], v[28:31]
    s_mov_b32 s68, 278528
    buffer_load_dwordx4 v[120:123], v4, s[36:39], s68 offen offset:2048 nt
    v_and_b32_dpp v12, v57, v8 row_newbcast:10 row_mask:0xf bank_mask:0xf
    v_and_b32_dpp v13, v57, v9 row_newbcast:10 row_mask:0xf bank_mask:0xf
    v_and_b32_dpp v14, v57, v10 row_newbcast:10 row_mask:0xf bank_mask:0xf
    v_and_b32_dpp v15, v57, v11 row_newbcast:10 row_mask:0xf bank_mask:0xf
    s_nop 1
    v_mfma_f32_16x16x32_bf16 v[20:23], v[12:15], a[208:211], v[20:23]
    v_mfma_f32_16x16x32_bf16 v[24:27], v[12:15], a[212:215], v[24:27]
    s_waitcnt vmcnt(6)
    v_and_b32_dpp v16, v36, v8 row_newbcast:4 row_mask:0xf bank_mask:0xf
    v_and_b32_dpp v17, v36, v9 row_newbcast:4 row_mask:0xf bank_mask:0xf
    v_and_b32_dpp v18, v36, v10 row_newbcast:4 row_mask:0xf bank_mask:0xf
    v_and_b32_dpp v19, v36, v11 row_newbcast:4 row_mask:0xf bank_mask:0xf
    s_nop 1
    v_mfma_f32_16x16x32_bf16 v[28:31], v[16:19], v[104:107], v[28:31]
    s_mov_b32 s68, 278528
    buffer_load_dwordx4 v[124:127], v4, s[36:39], s68 offen offset:3072 nt
    s_waitcnt vmcnt(6)
    v_and_b32_dpp v12, v36, v8 row_newbcast:12 row_mask:0xf bank_mask:0xf
    v_and_b32_dpp v13, v36, v9 row_newbcast:12 row_mask:0xf bank_mask:0xf
    v_and_b32_dpp v14, v36, v10 row_newbcast:12 row_mask:0xf bank_mask:0xf
    v_and_b32_dpp v15, v36, v11 row_newbcast:12 row_mask:0xf bank_mask:0xf
    s_nop 1
    v_mfma_f32_16x16x32_bf16 v[28:31], v[12:15], v[108:111], v[28:31]
    s_mov_b32 s68, 294912
    buffer_load_dwordx4 v[128:131], v4, s[36:39], s68 offen nt
    s_waitcnt vmcnt(6)
    v_and_b32_dpp v16, v36, v8 row_newbcast:2 row_mask:0xf bank_mask:0xf
    v_and_b32_dpp v17, v36, v9 row_newbcast:2 row_mask:0xf bank_mask:0xf
    v_and_b32_dpp v18, v36, v10 row_newbcast:2 row_mask:0xf bank_mask:0xf
    v_and_b32_dpp v19, v36, v11 row_newbcast:2 row_mask:0xf bank_mask:0xf
    s_nop 1
    v_mfma_f32_16x16x32_bf16 v[28:31], v[16:19], v[112:115], v[28:31]
    s_mov_b32 s68, 294912
    buffer_load_dwordx4 v[132:135], v4, s[36:39], s68 offen offset:1024 nt
    s_mov_b32 s68, 8192
    buffer_load_dwordx4 a[8:11], v7, s[52:55], s68 offen
    buffer_load_dwordx4 a[12:15], v7, s[52:55], s68 offen offset:256
    s_waitcnt vmcnt(8)
    v_and_b32_dpp v12, v36, v8 row_newbcast:10 row_mask:0xf bank_mask:0xf
    v_and_b32_dpp v13, v36, v9 row_newbcast:10 row_mask:0xf bank_mask:0xf
    v_and_b32_dpp v14, v36, v10 row_newbcast:10 row_mask:0xf bank_mask:0xf
    v_and_b32_dpp v15, v36, v11 row_newbcast:10 row_mask:0xf bank_mask:0xf
    s_nop 1
    v_mfma_f32_16x16x32_bf16 v[28:31], v[12:15], v[116:119], v[28:31]
    s_mov_b32 s68, 294912
    buffer_load_dwordx4 v[136:139], v4, s[36:39], s68 offen offset:2048 nt
    v_and_b32_dpp v16, v57, v8 row_newbcast:11 row_mask:0xf bank_mask:0xf
    v_and_b32_dpp v17, v57, v9 row_newbcast:11 row_mask:0xf bank_mask:0xf
    v_and_b32_dpp v18, v57, v10 row_newbcast:11 row_mask:0xf bank_mask:0xf
    v_and_b32_dpp v19, v57, v11 row_newbcast:11 row_mask:0xf bank_mask:0xf
    s_nop 1
    v_mfma_f32_16x16x32_bf16 v[20:23], v[16:19], a[216:219], v[20:23]
    v_mfma_f32_16x16x32_bf16 v[24:27], v[16:19], a[220:223], v[24:27]
    s_waitcnt vmcnt(6)
    v_and_b32_dpp v12, v36, v8 row_newbcast:6 row_mask:0xf bank_mask:0xf
    v_and_b32_dpp v13, v36, v9 row_newbcast:6 row_mask:0xf bank_mask:0xf
    v_and_b32_dpp v14, v36, v10 row_newbcast:6 row_mask:0xf bank_mask:0xf
    v_and_b32_dpp v15, v36, v11 row_newbcast:6 row_mask:0xf bank_mask:0xf
    s_nop 1
    v_mfma_f32_16x16x32_bf16 v[28:31], v[12:15], v[120:123], v[28:31]
    s_mov_b32 s68, 294912
    buffer_load_dwordx4 v[140:143], v4, s[36:39], s68 offen offset:3072 nt
    s_waitcnt vmcnt(6)
    v_and_b32_dpp v16, v36, v8 row_newbcast:14 row_mask:0xf bank_mask:0xf
    v_and_b32_dpp v17, v36, v9 row_newbcast:14 row_mask:0xf bank_mask:0xf
    v_and_b32_dpp v18, v36, v10 row_newbcast:14 row_mask:0xf bank_mask:0xf
    v_and_b32_dpp v19, v36, v11 row_newbcast:14 row_mask:0xf bank_mask:0xf
    s_nop 1
    v_mfma_f32_16x16x32_bf16 v[28:31], v[16:19], v[124:127], v[28:31]
    s_mov_b32 s68, 311296
    buffer_load_dwordx4 v[144:147], v4, s[36:39], s68 offen nt
    v_and_b32 v67, 1, v3
    v_lshlrev_b32 v67, 4, v67
    v_lshl_add_u32 v67, v2, 5, v67
    s_lshl_b32 s72, s3, 10
    v_add_u32 v67, s72, v67
    s_lshl_b32 s73, s90, 12
    s_add_u32 s74, s73, 0x100000
    s_mov_b32 exec_hi, 0
    buffer_store_dwordx4 v[20:23], v67, s[64:67], s74 offen sc1
    buffer_store_dwordx4 v[24:27], v67, s[64:67], s74 offen offset:512 sc1
    s_mov_b32 exec_hi, -1
    s_waitcnt vmcnt(8)
    v_and_b32_dpp v12, v36, v8 row_newbcast:1 row_mask:0xf bank_mask:0xf
    v_and_b32_dpp v13, v36, v9 row_newbcast:1 row_mask:0xf bank_mask:0xf
    v_and_b32_dpp v14, v36, v10 row_newbcast:1 row_mask:0xf bank_mask:0xf
    v_and_b32_dpp v15, v36, v11 row_newbcast:1 row_mask:0xf bank_mask:0xf
    s_nop 1
    v_mfma_f32_16x16x32_bf16 v[28:31], v[12:15], v[128:131], v[28:31]
    s_mov_b32 s68, 311296
    buffer_load_dwordx4 v[148:151], v4, s[36:39], s68 offen offset:1024 nt
    s_mov_b32 s68, 16384
    buffer_load_dwordx4 a[16:19], v7, s[52:55], s68 offen
    buffer_load_dwordx4 a[20:23], v7, s[52:55], s68 offen offset:256
    s_waitcnt vmcnt(10)
    v_and_b32_dpp v16, v36, v8 row_newbcast:9 row_mask:0xf bank_mask:0xf
    v_and_b32_dpp v17, v36, v9 row_newbcast:9 row_mask:0xf bank_mask:0xf
    v_and_b32_dpp v18, v36, v10 row_newbcast:9 row_mask:0xf bank_mask:0xf
    v_and_b32_dpp v19, v36, v11 row_newbcast:9 row_mask:0xf bank_mask:0xf
    s_nop 1
    v_mfma_f32_16x16x32_bf16 v[28:31], v[16:19], v[132:135], v[28:31]
    s_mov_b32 s68, 311296
    buffer_load_dwordx4 v[152:155], v4, s[36:39], s68 offen offset:2048 nt
    s_waitcnt vmcnt(8)
    v_and_b32_dpp v12, v36, v8 row_newbcast:5 row_mask:0xf bank_mask:0xf
    v_and_b32_dpp v13, v36, v9 row_newbcast:5 row_mask:0xf bank_mask:0xf
    v_and_b32_dpp v14, v36, v10 row_newbcast:5 row_mask:0xf bank_mask:0xf
    v_and_b32_dpp v15, v36, v11 row_newbcast:5 row_mask:0xf bank_mask:0xf
    s_nop 1
    v_mfma_f32_16x16x32_bf16 v[28:31], v[12:15], v[136:139], v[28:31]
    s_mov_b32 s68, 311296
    buffer_load_dwordx4 v[156:159], v4, s[36:39], s68 offen offset:3072 nt
    s_waitcnt vmcnt(8)
    v_and_b32_dpp v16, v36, v8 row_newbcast:13 row_mask:0xf bank_mask:0xf
    v_and_b32_dpp v17, v36, v9 row_newbcast:13 row_mask:0xf bank_mask:0xf
    v_and_b32_dpp v18, v36, v10 row_newbcast:13 row_mask:0xf bank_mask:0xf
    v_and_b32_dpp v19, v36, v11 row_newbcast:13 row_mask:0xf bank_mask:0xf
    s_nop 1
    v_mfma_f32_16x16x32_bf16 v[28:31], v[16:19], v[140:143], v[28:31]
    s_mov_b32 s68, 327680
    buffer_load_dwordx4 v[160:163], v4, s[36:39], s68 offen nt
    s_waitcnt vmcnt(8)
    v_and_b32_dpp v12, v36, v8 row_newbcast:3 row_mask:0xf bank_mask:0xf
    v_and_b32_dpp v13, v36, v9 row_newbcast:3 row_mask:0xf bank_mask:0xf
    v_and_b32_dpp v14, v36, v10 row_newbcast:3 row_mask:0xf bank_mask:0xf
    v_and_b32_dpp v15, v36, v11 row_newbcast:3 row_mask:0xf bank_mask:0xf
    s_nop 1
    v_mfma_f32_16x16x32_bf16 v[28:31], v[12:15], v[144:147], v[28:31]
    s_mov_b32 s68, 327680
    buffer_load_dwordx4 v[164:167], v4, s[36:39], s68 offen offset:1024 nt
    s_mov_b32 s68, 24576
    buffer_load_dwordx4 a[24:27], v7, s[52:55], s68 offen
    buffer_load_dwordx4 a[28:31], v7, s[52:55], s68 offen offset:256
    s_waitcnt vmcnt(8)
    v_and_b32_dpp v16, v36, v8 row_newbcast:11 row_mask:0xf bank_mask:0xf
    v_and_b32_dpp v17, v36, v9 row_newbcast:11 row_mask:0xf bank_mask:0xf
    v_and_b32_dpp v18, v36, v10 row_newbcast:11 row_mask:0xf bank_mask:0xf
    v_and_b32_dpp v19, v36, v11 row_newbcast:11 row_mask:0xf bank_mask:0xf
    s_nop 1
    v_mfma_f32_16x16x32_bf16 v[28:31], v[16:19], v[148:151], v[28:31]
    s_mov_b32 s68, 327680
    buffer_load_dwordx4 v[168:171], v4, s[36:39], s68 offen offset:2048 nt
    s_waitcnt vmcnt(6)
    v_and_b32_dpp v12, v36, v8 row_newbcast:7 row_mask:0xf bank_mask:0xf
    v_and_b32_dpp v13, v36, v9 row_newbcast:7 row_mask:0xf bank_mask:0xf
    v_and_b32_dpp v14, v36, v10 row_newbcast:7 row_mask:0xf bank_mask:0xf
    v_and_b32_dpp v15, v36, v11 row_newbcast:7 row_mask:0xf bank_mask:0xf
    s_nop 1
    v_mfma_f32_16x16x32_bf16 v[28:31], v[12:15], v[152:155], v[28:31]
    s_mov_b32 s68, 327680
    buffer_load_dwordx4 v[172:175], v4, s[36:39], s68 offen offset:3072 nt
    s_waitcnt vmcnt(6)
    v_and_b32_dpp v16, v36, v8 row_newbcast:15 row_mask:0xf bank_mask:0xf
    v_and_b32_dpp v17, v36, v9 row_newbcast:15 row_mask:0xf bank_mask:0xf
    v_and_b32_dpp v18, v36, v10 row_newbcast:15 row_mask:0xf bank_mask:0xf
    v_and_b32_dpp v19, v36, v11 row_newbcast:15 row_mask:0xf bank_mask:0xf
    s_nop 1
    v_mfma_f32_16x16x32_bf16 v[28:31], v[16:19], v[156:159], v[28:31]
    s_mov_b32 s68, 344064
    buffer_load_dwordx4 v[176:179], v4, s[36:39], s68 offen nt
    s_waitcnt vmcnt(6)
    v_and_b32_dpp v12, v37, v8 row_newbcast:0 row_mask:0xf bank_mask:0xf
    v_and_b32_dpp v13, v37, v9 row_newbcast:0 row_mask:0xf bank_mask:0xf
    v_and_b32_dpp v14, v37, v10 row_newbcast:0 row_mask:0xf bank_mask:0xf
    v_and_b32_dpp v15, v37, v11 row_newbcast:0 row_mask:0xf bank_mask:0xf
    s_nop 1
    v_mfma_f32_16x16x32_bf16 v[28:31], v[12:15], v[160:163], v[28:31]
    s_mov_b32 s68, 344064
    buffer_load_dwordx4 v[180:183], v4, s[36:39], s68 offen offset:1024 nt
    v_sub_f32 v38, v38, v73
    v_mul_f32 v38, 0x3fb8aa3b, v38
    v_exp_f32 v38, v38
    s_nop 0
    v_mul_f32 v38, v38, v75
    v_cvt_pk_bf16_f32 v38, v38, v38
    s_mov_b32 s68, 32768
    buffer_load_dwordx4 a[32:35], v7, s[52:55], s68 offen
    buffer_load_dwordx4 a[36:39], v7, s[52:55], s68 offen offset:256
    s_waitcnt vmcnt(8)
    v_and_b32_dpp v16, v37, v8 row_newbcast:8 row_mask:0xf bank_mask:0xf
    v_and_b32_dpp v17, v37, v9 row_newbcast:8 row_mask:0xf bank_mask:0xf
    v_and_b32_dpp v18, v37, v10 row_newbcast:8 row_mask:0xf bank_mask:0xf
    v_and_b32_dpp v19, v37, v11 row_newbcast:8 row_mask:0xf bank_mask:0xf
    s_nop 1
    v_mfma_f32_16x16x32_bf16 v[28:31], v[16:19], v[164:167], v[28:31]
    s_mov_b32 s68, 344064
    buffer_load_dwordx4 v[184:187], v4, s[36:39], s68 offen offset:2048 nt
    s_waitcnt vmcnt(6)
    v_and_b32_dpp v12, v37, v8 row_newbcast:4 row_mask:0xf bank_mask:0xf
    v_and_b32_dpp v13, v37, v9 row_newbcast:4 row_mask:0xf bank_mask:0xf
    v_and_b32_dpp v14, v37, v10 row_newbcast:4 row_mask:0xf bank_mask:0xf
    v_and_b32_dpp v15, v37, v11 row_newbcast:4 row_mask:0xf bank_mask:0xf
    s_nop 1
    v_mfma_f32_16x16x32_bf16 v[28:31], v[12:15], v[168:171], v[28:31]
    s_mov_b32 s68, 344064
    buffer_load_dwordx4 v[188:191], v4, s[36:39], s68 offen offset:3072 nt
    s_waitcnt vmcnt(6)
    v_and_b32_dpp v16, v37, v8 row_newbcast:12 row_mask:0xf bank_mask:0xf
    v_and_b32_dpp v17, v37, v9 row_newbcast:12 row_mask:0xf bank_mask:0xf
    v_and_b32_dpp v18, v37, v10 row_newbcast:12 row_mask:0xf bank_mask:0xf
    v_and_b32_dpp v19, v37, v11 row_newbcast:12 row_mask:0xf bank_mask:0xf
    s_nop 1
    v_mfma_f32_16x16x32_bf16 v[28:31], v[16:19], v[172:175], v[28:31]
    s_mov_b32 s68, 360448
    buffer_load_dwordx4 v[192:195], v4, s[36:39], s68 offen nt
    s_waitcnt vmcnt(6)
    v_and_b32_dpp v12, v37, v8 row_newbcast:2 row_mask:0xf bank_mask:0xf
    v_and_b32_dpp v13, v37, v9 row_newbcast:2 row_mask:0xf bank_mask:0xf
    v_and_b32_dpp v14, v37, v10 row_newbcast:2 row_mask:0xf bank_mask:0xf
    v_and_b32_dpp v15, v37, v11 row_newbcast:2 row_mask:0xf bank_mask:0xf
    s_nop 1
    v_mfma_f32_16x16x32_bf16 v[28:31], v[12:15], v[176:179], v[28:31]
    s_mov_b32 s68, 360448
    buffer_load_dwordx4 v[196:199], v4, s[36:39], s68 offen offset:1024 nt
    s_mov_b32 s68, 40960
    buffer_load_dwordx4 a[40:43], v7, s[52:55], s68 offen
    buffer_load_dwordx4 a[44:47], v7, s[52:55], s68 offen offset:256
    s_waitcnt vmcnt(8)
    v_and_b32_dpp v16, v37, v8 row_newbcast:10 row_mask:0xf bank_mask:0xf
    v_and_b32_dpp v17, v37, v9 row_newbcast:10 row_mask:0xf bank_mask:0xf
    v_and_b32_dpp v18, v37, v10 row_newbcast:10 row_mask:0xf bank_mask:0xf
    v_and_b32_dpp v19, v37, v11 row_newbcast:10 row_mask:0xf bank_mask:0xf
    s_nop 1
    v_mfma_f32_16x16x32_bf16 v[28:31], v[16:19], v[180:183], v[28:31]
    s_mov_b32 s68, 360448
    buffer_load_dwordx4 v[200:203], v4, s[36:39], s68 offen offset:2048 nt
    s_waitcnt vmcnt(6)
    v_and_b32_dpp v12, v37, v8 row_newbcast:6 row_mask:0xf bank_mask:0xf
    v_and_b32_dpp v13, v37, v9 row_newbcast:6 row_mask:0xf bank_mask:0xf
    v_and_b32_dpp v14, v37, v10 row_newbcast:6 row_mask:0xf bank_mask:0xf
    v_and_b32_dpp v15, v37, v11 row_newbcast:6 row_mask:0xf bank_mask:0xf
    s_nop 1
    v_mfma_f32_16x16x32_bf16 v[28:31], v[12:15], v[184:187], v[28:31]
    s_mov_b32 s68, 360448
    buffer_load_dwordx4 v[204:207], v4, s[36:39], s68 offen offset:3072 nt
    s_waitcnt vmcnt(6)
    v_and_b32_dpp v16, v37, v8 row_newbcast:14 row_mask:0xf bank_mask:0xf
    v_and_b32_dpp v17, v37, v9 row_newbcast:14 row_mask:0xf bank_mask:0xf
    v_and_b32_dpp v18, v37, v10 row_newbcast:14 row_mask:0xf bank_mask:0xf
    v_and_b32_dpp v19, v37, v11 row_newbcast:14 row_mask:0xf bank_mask:0xf
    s_nop 1
    v_mfma_f32_16x16x32_bf16 v[28:31], v[16:19], v[188:191], v[28:31]
    s_mov_b32 s68, 376832
    buffer_load_dwordx4 v[208:211], v4, s[36:39], s68 offen nt
    s_waitcnt vmcnt(6)
    v_and_b32_dpp v12, v37, v8 row_newbcast:1 row_mask:0xf bank_mask:0xf
    v_and_b32_dpp v13, v37, v9 row_newbcast:1 row_mask:0xf bank_mask:0xf
    v_and_b32_dpp v14, v37, v10 row_newbcast:1 row_mask:0xf bank_mask:0xf
    v_and_b32_dpp v15, v37, v11 row_newbcast:1 row_mask:0xf bank_mask:0xf
    s_nop 1
    v_mfma_f32_16x16x32_bf16 v[28:31], v[12:15], v[192:195], v[28:31]
    s_mov_b32 s68, 376832
    buffer_load_dwordx4 v[212:215], v4, s[36:39], s68 offen offset:1024 nt
    s_mov_b32 s68, 49152
    buffer_load_dwordx4 a[48:51], v7, s[52:55], s68 offen
    buffer_load_dwordx4 a[52:55], v7, s[52:55], s68 offen offset:256
    s_waitcnt vmcnt(8)
    v_and_b32_dpp v16, v37, v8 row_newbcast:9 row_mask:0xf bank_mask:0xf
    v_and_b32_dpp v17, v37, v9 row_newbcast:9 row_mask:0xf bank_mask:0xf
    v_and_b32_dpp v18, v37, v10 row_newbcast:9 row_mask:0xf bank_mask:0xf
    v_and_b32_dpp v19, v37, v11 row_newbcast:9 row_mask:0xf bank_mask:0xf
    s_nop 1
    v_mfma_f32_16x16x32_bf16 v[28:31], v[16:19], v[196:199], v[28:31]
    s_mov_b32 s68, 376832
    buffer_load_dwordx4 v[216:219], v4, s[36:39], s68 offen offset:2048 nt
    s_waitcnt vmcnt(6)
    v_and_b32_dpp v12, v37, v8 row_newbcast:5 row_mask:0xf bank_mask:0xf
    v_and_b32_dpp v13, v37, v9 row_newbcast:5 row_mask:0xf bank_mask:0xf
    v_and_b32_dpp v14, v37, v10 row_newbcast:5 row_mask:0xf bank_mask:0xf
    v_and_b32_dpp v15, v37, v11 row_newbcast:5 row_mask:0xf bank_mask:0xf
    s_nop 1
    v_mfma_f32_16x16x32_bf16 v[28:31], v[12:15], v[200:203], v[28:31]
    s_mov_b32 s68, 376832
    buffer_load_dwordx4 v[220:223], v4, s[36:39], s68 offen offset:3072 nt
    s_waitcnt vmcnt(6)
    v_and_b32_dpp v16, v37, v8 row_newbcast:13 row_mask:0xf bank_mask:0xf
    v_and_b32_dpp v17, v37, v9 row_newbcast:13 row_mask:0xf bank_mask:0xf
    v_and_b32_dpp v18, v37, v10 row_newbcast:13 row_mask:0xf bank_mask:0xf
    v_and_b32_dpp v19, v37, v11 row_newbcast:13 row_mask:0xf bank_mask:0xf
    s_nop 1
    v_mfma_f32_16x16x32_bf16 v[28:31], v[16:19], v[204:207], v[28:31]
    s_mov_b32 s68, 393216
    buffer_load_dwordx4 v[224:227], v4, s[36:39], s68 offen nt
    s_waitcnt vmcnt(6)
    v_and_b32_dpp v12, v37, v8 row_newbcast:3 row_mask:0xf bank_mask:0xf
    v_and_b32_dpp v13, v37, v9 row_newbcast:3 row_mask:0xf bank_mask:0xf
    v_and_b32_dpp v14, v37, v10 row_newbcast:3 row_mask:0xf bank_mask:0xf
    v_and_b32_dpp v15, v37, v11 row_newbcast:3 row_mask:0xf bank_mask:0xf
    s_nop 1
    v_mfma_f32_16x16x32_bf16 v[28:31], v[12:15], v[208:211], v[28:31]
    s_mov_b32 s68, 393216
    buffer_load_dwordx4 v[228:231], v4, s[36:39], s68 offen offset:1024 nt
    s_mov_b32 s68, 57344
    buffer_load_dwordx4 a[56:59], v7, s[52:55], s68 offen
    buffer_load_dwordx4 a[60:63], v7, s[52:55], s68 offen offset:256
    s_waitcnt vmcnt(8)
    v_and_b32_dpp v16, v37, v8 row_newbcast:11 row_mask:0xf bank_mask:0xf
    v_and_b32_dpp v17, v37, v9 row_newbcast:11 row_mask:0xf bank_mask:0xf
    v_and_b32_dpp v18, v37, v10 row_newbcast:11 row_mask:0xf bank_mask:0xf
    v_and_b32_dpp v19, v37, v11 row_newbcast:11 row_mask:0xf bank_mask:0xf
    s_nop 1
    v_mfma_f32_16x16x32_bf16 v[28:31], v[16:19], v[212:215], v[28:31]
    s_mov_b32 s68, 393216
    buffer_load_dwordx4 v[232:235], v4, s[36:39], s68 offen offset:2048 nt
    s_waitcnt vmcnt(6)
    v_and_b32_dpp v12, v37, v8 row_newbcast:7 row_mask:0xf bank_mask:0xf
    v_and_b32_dpp v13, v37, v9 row_newbcast:7 row_mask:0xf bank_mask:0xf
    v_and_b32_dpp v14, v37, v10 row_newbcast:7 row_mask:0xf bank_mask:0xf
    v_and_b32_dpp v15, v37, v11 row_newbcast:7 row_mask:0xf bank_mask:0xf
    s_nop 1
    v_mfma_f32_16x16x32_bf16 v[28:31], v[12:15], v[216:219], v[28:31]
    s_mov_b32 s68, 393216
    buffer_load_dwordx4 v[236:239], v4, s[36:39], s68 offen offset:3072 nt
    s_waitcnt vmcnt(6)
    v_and_b32_dpp v16, v37, v8 row_newbcast:15 row_mask:0xf bank_mask:0xf
    v_and_b32_dpp v17, v37, v9 row_newbcast:15 row_mask:0xf bank_mask:0xf
    v_and_b32_dpp v18, v37, v10 row_newbcast:15 row_mask:0xf bank_mask:0xf
    v_and_b32_dpp v19, v37, v11 row_newbcast:15 row_mask:0xf bank_mask:0xf
    s_nop 1
    v_mfma_f32_16x16x32_bf16 v[28:31], v[16:19], v[220:223], v[28:31]
    s_mov_b32 s68, 409600
    buffer_load_dwordx4 v[80:83], v4, s[36:39], s68 offen nt
    s_waitcnt vmcnt(6)
    v_and_b32_dpp v12, v38, v8 row_newbcast:0 row_mask:0xf bank_mask:0xf
    v_and_b32_dpp v13, v38, v9 row_newbcast:0 row_mask:0xf bank_mask:0xf
    v_and_b32_dpp v14, v38, v10 row_newbcast:0 row_mask:0xf bank_mask:0xf
    v_and_b32_dpp v15, v38, v11 row_newbcast:0 row_mask:0xf bank_mask:0xf
    s_nop 1
    v_mfma_f32_16x16x32_bf16 v[28:31], v[12:15], v[224:227], v[28:31]
    s_mov_b32 s68, 409600
    buffer_load_dwordx4 v[84:87], v4, s[36:39], s68 offen offset:1024 nt
    v_sub_f32 v39, v39, v73
    v_mul_f32 v39, 0x3fb8aa3b, v39
    v_exp_f32 v39, v39
    s_nop 0
    v_mul_f32 v39, v39, v75
    v_cvt_pk_bf16_f32 v39, v39, v39
    s_mov_b32 s68, 65536
    buffer_load_dwordx4 a[64:67], v7, s[52:55], s68 offen
    buffer_load_dwordx4 a[68:71], v7, s[52:55], s68 offen offset:256
    s_waitcnt vmcnt(8)
    v_and_b32_dpp v16, v38, v8 row_newbcast:8 row_mask:0xf bank_mask:0xf
    v_and_b32_dpp v17, v38, v9 row_newbcast:8 row_mask:0xf bank_mask:0xf
    v_and_b32_dpp v18, v38, v10 row_newbcast:8 row_mask:0xf bank_mask:0xf
    v_and_b32_dpp v19, v38, v11 row_newbcast:8 row_mask:0xf bank_mask:0xf
    s_nop 1
    v_mfma_f32_16x16x32_bf16 v[28:31], v[16:19], v[228:231], v[28:31]
    s_mov_b32 s68, 409600
    buffer_load_dwordx4 v[88:91], v4, s[36:39], s68 offen offset:2048 nt
    s_waitcnt vmcnt(6)
    v_and_b32_dpp v12, v38, v8 row_newbcast:4 row_mask:0xf bank_mask:0xf
    v_and_b32_dpp v13, v38, v9 row_newbcast:4 row_mask:0xf bank_mask:0xf
    v_and_b32_dpp v14, v38, v10 row_newbcast:4 row_mask:0xf bank_mask:0xf
    v_and_b32_dpp v15, v38, v11 row_newbcast:4 row_mask:0xf bank_mask:0xf
    s_nop 1
    v_mfma_f32_16x16x32_bf16 v[28:31], v[12:15], v[232:235], v[28:31]
    s_mov_b32 s68, 409600
    buffer_load_dwordx4 v[92:95], v4, s[36:39], s68 offen offset:3072 nt
    s_waitcnt vmcnt(6)
    v_and_b32_dpp v16, v38, v8 row_newbcast:12 row_mask:0xf bank_mask:0xf
    v_and_b32_dpp v17, v38, v9 row_newbcast:12 row_mask:0xf bank_mask:0xf
    v_and_b32_dpp v18, v38, v10 row_newbcast:12 row_mask:0xf bank_mask:0xf
    v_and_b32_dpp v19, v38, v11 row_newbcast:12 row_mask:0xf bank_mask:0xf
    s_nop 1
    v_mfma_f32_16x16x32_bf16 v[28:31], v[16:19], v[236:239], v[28:31]
    s_mov_b32 s68, 425984
    buffer_load_dwordx4 v[96:99], v4, s[36:39], s68 offen nt
    s_waitcnt vmcnt(6)
    v_and_b32_dpp v12, v38, v8 row_newbcast:2 row_mask:0xf bank_mask:0xf
    v_and_b32_dpp v13, v38, v9 row_newbcast:2 row_mask:0xf bank_mask:0xf
    v_and_b32_dpp v14, v38, v10 row_newbcast:2 row_mask:0xf bank_mask:0xf
    v_and_b32_dpp v15, v38, v11 row_newbcast:2 row_mask:0xf bank_mask:0xf
    s_nop 1
    v_mfma_f32_16x16x32_bf16 v[28:31], v[12:15], v[80:83], v[28:31]
    s_mov_b32 s68, 425984
    buffer_load_dwordx4 v[100:103], v4, s[36:39], s68 offen offset:1024 nt
    s_mov_b32 s68, 73728
    buffer_load_dwordx4 a[72:75], v7, s[52:55], s68 offen
    buffer_load_dwordx4 a[76:79], v7, s[52:55], s68 offen offset:256
    s_waitcnt vmcnt(8)
    v_and_b32_dpp v16, v38, v8 row_newbcast:10 row_mask:0xf bank_mask:0xf
    v_and_b32_dpp v17, v38, v9 row_newbcast:10 row_mask:0xf bank_mask:0xf
    v_and_b32_dpp v18, v38, v10 row_newbcast:10 row_mask:0xf bank_mask:0xf
    v_and_b32_dpp v19, v38, v11 row_newbcast:10 row_mask:0xf bank_mask:0xf
    s_nop 1
    v_mfma_f32_16x16x32_bf16 v[28:31], v[16:19], v[84:87], v[28:31]
    s_mov_b32 s68, 425984
    buffer_load_dwordx4 v[104:107], v4, s[36:39], s68 offen offset:2048 nt
    s_waitcnt vmcnt(6)
    v_and_b32_dpp v12, v38, v8 row_newbcast:6 row_mask:0xf bank_mask:0xf
    v_and_b32_dpp v13, v38, v9 row_newbcast:6 row_mask:0xf bank_mask:0xf
    v_and_b32_dpp v14, v38, v10 row_newbcast:6 row_mask:0xf bank_mask:0xf
    v_and_b32_dpp v15, v38, v11 row_newbcast:6 row_mask:0xf bank_mask:0xf
    s_nop 1
    v_mfma_f32_16x16x32_bf16 v[28:31], v[12:15], v[88:91], v[28:31]
    s_mov_b32 s68, 425984
    buffer_load_dwordx4 v[108:111], v4, s[36:39], s68 offen offset:3072 nt
    s_waitcnt vmcnt(6)
    v_and_b32_dpp v16, v38, v8 row_newbcast:14 row_mask:0xf bank_mask:0xf
    v_and_b32_dpp v17, v38, v9 row_newbcast:14 row_mask:0xf bank_mask:0xf
    v_and_b32_dpp v18, v38, v10 row_newbcast:14 row_mask:0xf bank_mask:0xf
    v_and_b32_dpp v19, v38, v11 row_newbcast:14 row_mask:0xf bank_mask:0xf
    s_nop 1
    v_mfma_f32_16x16x32_bf16 v[28:31], v[16:19], v[92:95], v[28:31]
    s_mov_b32 s68, 442368
    buffer_load_dwordx4 v[112:115], v4, s[36:39], s68 offen nt
    s_waitcnt vmcnt(6)
    v_and_b32_dpp v12, v38, v8 row_newbcast:1 row_mask:0xf bank_mask:0xf
    v_and_b32_dpp v13, v38, v9 row_newbcast:1 row_mask:0xf bank_mask:0xf
    v_and_b32_dpp v14, v38, v10 row_newbcast:1 row_mask:0xf bank_mask:0xf
    v_and_b32_dpp v15, v38, v11 row_newbcast:1 row_mask:0xf bank_mask:0xf
    s_nop 1
    v_mfma_f32_16x16x32_bf16 v[28:31], v[12:15], v[96:99], v[28:31]
    s_mov_b32 s68, 442368
    buffer_load_dwordx4 v[116:119], v4, s[36:39], s68 offen offset:1024 nt
    s_mov_b32 s68, 81920
    buffer_load_dwordx4 a[80:83], v7, s[52:55], s68 offen
    buffer_load_dwordx4 a[84:87], v7, s[52:55], s68 offen offset:256
    s_waitcnt vmcnt(8)
    v_and_b32_dpp v16, v38, v8 row_newbcast:9 row_mask:0xf bank_mask:0xf
    v_and_b32_dpp v17, v38, v9 row_newbcast:9 row_mask:0xf bank_mask:0xf
    v_and_b32_dpp v18, v38, v10 row_newbcast:9 row_mask:0xf bank_mask:0xf
    v_and_b32_dpp v19, v38, v11 row_newbcast:9 row_mask:0xf bank_mask:0xf
    s_nop 1
    v_mfma_f32_16x16x32_bf16 v[28:31], v[16:19], v[100:103], v[28:31]
    s_mov_b32 s68, 442368
    buffer_load_dwordx4 v[120:123], v4, s[36:39], s68 offen offset:2048 nt
    s_waitcnt vmcnt(6)
    v_and_b32_dpp v12, v38, v8 row_newbcast:5 row_mask:0xf bank_mask:0xf
    v_and_b32_dpp v13, v38, v9 row_newbcast:5 row_mask:0xf bank_mask:0xf
    v_and_b32_dpp v14, v38, v10 row_newbcast:5 row_mask:0xf bank_mask:0xf
    v_and_b32_dpp v15, v38, v11 row_newbcast:5 row_mask:0xf bank_mask:0xf
    s_nop 1
    v_mfma_f32_16x16x32_bf16 v[28:31], v[12:15], v[104:107], v[28:31]
    s_mov_b32 s68, 442368
    buffer_load_dwordx4 v[124:127], v4, s[36:39], s68 offen offset:3072 nt
    s_waitcnt vmcnt(6)
    v_and_b32_dpp v16, v38, v8 row_newbcast:13 row_mask:0xf bank_mask:0xf
    v_and_b32_dpp v17, v38, v9 row_newbcast:13 row_mask:0xf bank_mask:0xf
    v_and_b32_dpp v18, v38, v10 row_newbcast:13 row_mask:0xf bank_mask:0xf
    v_and_b32_dpp v19, v38, v11 row_newbcast:13 row_mask:0xf bank_mask:0xf
    s_nop 1
    v_mfma_f32_16x16x32_bf16 v[28:31], v[16:19], v[108:111], v[28:31]
    s_mov_b32 s68, 458752
    buffer_load_dwordx4 v[128:131], v4, s[36:39], s68 offen nt
    s_waitcnt vmcnt(6)
    v_and_b32_dpp v12, v38, v8 row_newbcast:3 row_mask:0xf bank_mask:0xf
    v_and_b32_dpp v13, v38, v9 row_newbcast:3 row_mask:0xf bank_mask:0xf
    v_and_b32_dpp v14, v38, v10 row_newbcast:3 row_mask:0xf bank_mask:0xf
    v_and_b32_dpp v15, v38, v11 row_newbcast:3 row_mask:0xf bank_mask:0xf
    s_nop 1
    v_mfma_f32_16x16x32_bf16 v[28:31], v[12:15], v[112:115], v[28:31]
    s_mov_b32 s68, 458752
    buffer_load_dwordx4 v[132:135], v4, s[36:39], s68 offen offset:1024 nt
    s_mov_b32 s68, 90112
    buffer_load_dwordx4 a[88:91], v7, s[52:55], s68 offen
    buffer_load_dwordx4 a[92:95], v7, s[52:55], s68 offen offset:256
    s_waitcnt vmcnt(8)
    v_and_b32_dpp v16, v38, v8 row_newbcast:11 row_mask:0xf bank_mask:0xf
    v_and_b32_dpp v17, v38, v9 row_newbcast:11 row_mask:0xf bank_mask:0xf
    v_and_b32_dpp v18, v38, v10 row_newbcast:11 row_mask:0xf bank_mask:0xf
    v_and_b32_dpp v19, v38, v11 row_newbcast:11 row_mask:0xf bank_mask:0xf
    s_nop 1
    v_mfma_f32_16x16x32_bf16 v[28:31], v[16:19], v[116:119], v[28:31]
    s_mov_b32 s68, 458752
    buffer_load_dwordx4 v[136:139], v4, s[36:39], s68 offen offset:2048 nt
    s_waitcnt vmcnt(6)
    v_and_b32_dpp v12, v38, v8 row_newbcast:7 row_mask:0xf bank_mask:0xf
    v_and_b32_dpp v13, v38, v9 row_newbcast:7 row_mask:0xf bank_mask:0xf
    v_and_b32_dpp v14, v38, v10 row_newbcast:7 row_mask:0xf bank_mask:0xf
    v_and_b32_dpp v15, v38, v11 row_newbcast:7 row_mask:0xf bank_mask:0xf
    s_nop 1
    v_mfma_f32_16x16x32_bf16 v[28:31], v[12:15], v[120:123], v[28:31]
    s_mov_b32 s68, 458752
    buffer_load_dwordx4 v[140:143], v4, s[36:39], s68 offen offset:3072 nt
    s_waitcnt vmcnt(6)
    v_and_b32_dpp v16, v38, v8 row_newbcast:15 row_mask:0xf bank_mask:0xf
    v_and_b32_dpp v17, v38, v9 row_newbcast:15 row_mask:0xf bank_mask:0xf
    v_and_b32_dpp v18, v38, v10 row_newbcast:15 row_mask:0xf bank_mask:0xf
    v_and_b32_dpp v19, v38, v11 row_newbcast:15 row_mask:0xf bank_mask:0xf
    s_nop 1
    v_mfma_f32_16x16x32_bf16 v[28:31], v[16:19], v[124:127], v[28:31]
    s_mov_b32 s68, 475136
    buffer_load_dwordx4 v[144:147], v4, s[36:39], s68 offen nt
    s_waitcnt vmcnt(6)
    v_and_b32_dpp v12, v39, v8 row_newbcast:0 row_mask:0xf bank_mask:0xf
    v_and_b32_dpp v13, v39, v9 row_newbcast:0 row_mask:0xf bank_mask:0xf
    v_and_b32_dpp v14, v39, v10 row_newbcast:0 row_mask:0xf bank_mask:0xf
    v_and_b32_dpp v15, v39, v11 row_newbcast:0 row_mask:0xf bank_mask:0xf
    s_nop 1
    v_mfma_f32_16x16x32_bf16 v[28:31], v[12:15], v[128:131], v[28:31]
    s_mov_b32 s68, 475136
    buffer_load_dwordx4 v[148:151], v4, s[36:39], s68 offen offset:1024 nt
    v_sub_f32 v40, v40, v73
    v_mul_f32 v40, 0x3fb8aa3b, v40
    v_exp_f32 v40, v40
    s_nop 0
    v_mul_f32 v40, v40, v75
    v_cvt_pk_bf16_f32 v40, v40, v40
    s_mov_b32 s68, 98304
    buffer_load_dwordx4 a[96:99], v7, s[52:55], s68 offen
    buffer_load_dwordx4 a[100:103], v7, s[52:55], s68 offen offset:256
    s_waitcnt vmcnt(8)
    v_and_b32_dpp v16, v39, v8 row_newbcast:8 row_mask:0xf bank_mask:0xf
    v_and_b32_dpp v17, v39, v9 row_newbcast:8 row_mask:0xf bank_mask:0xf
    v_and_b32_dpp v18, v39, v10 row_newbcast:8 row_mask:0xf bank_mask:0xf
    v_and_b32_dpp v19, v39, v11 row_newbcast:8 row_mask:0xf bank_mask:0xf
    s_nop 1
    v_mfma_f32_16x16x32_bf16 v[28:31], v[16:19], v[132:135], v[28:31]
    s_mov_b32 s68, 475136
    buffer_load_dwordx4 v[152:155], v4, s[36:39], s68 offen offset:2048 nt
    s_waitcnt vmcnt(6)
    v_and_b32_dpp v12, v39, v8 row_newbcast:4 row_mask:0xf bank_mask:0xf
    v_and_b32_dpp v13, v39, v9 row_newbcast:4 row_mask:0xf bank_mask:0xf
    v_and_b32_dpp v14, v39, v10 row_newbcast:4 row_mask:0xf bank_mask:0xf
    v_and_b32_dpp v15, v39, v11 row_newbcast:4 row_mask:0xf bank_mask:0xf
    s_nop 1
    v_mfma_f32_16x16x32_bf16 v[28:31], v[12:15], v[136:139], v[28:31]
    s_mov_b32 s68, 475136
    buffer_load_dwordx4 v[156:159], v4, s[36:39], s68 offen offset:3072 nt
    s_waitcnt vmcnt(6)
    v_and_b32_dpp v16, v39, v8 row_newbcast:12 row_mask:0xf bank_mask:0xf
    v_and_b32_dpp v17, v39, v9 row_newbcast:12 row_mask:0xf bank_mask:0xf
    v_and_b32_dpp v18, v39, v10 row_newbcast:12 row_mask:0xf bank_mask:0xf
    v_and_b32_dpp v19, v39, v11 row_newbcast:12 row_mask:0xf bank_mask:0xf
    s_nop 1
    v_mfma_f32_16x16x32_bf16 v[28:31], v[16:19], v[140:143], v[28:31]
    s_mov_b32 s68, 491520
    buffer_load_dwordx4 v[160:163], v4, s[36:39], s68 offen nt
    s_waitcnt vmcnt(6)
    v_and_b32_dpp v12, v39, v8 row_newbcast:2 row_mask:0xf bank_mask:0xf
    v_and_b32_dpp v13, v39, v9 row_newbcast:2 row_mask:0xf bank_mask:0xf
    v_and_b32_dpp v14, v39, v10 row_newbcast:2 row_mask:0xf bank_mask:0xf
    v_and_b32_dpp v15, v39, v11 row_newbcast:2 row_mask:0xf bank_mask:0xf
    s_nop 1
    v_mfma_f32_16x16x32_bf16 v[28:31], v[12:15], v[144:147], v[28:31]
    s_mov_b32 s68, 491520
    buffer_load_dwordx4 v[164:167], v4, s[36:39], s68 offen offset:1024 nt
    s_mov_b32 s68, 106496
    buffer_load_dwordx4 a[104:107], v7, s[52:55], s68 offen
    buffer_load_dwordx4 a[108:111], v7, s[52:55], s68 offen offset:256
    s_waitcnt vmcnt(8)
    v_and_b32_dpp v16, v39, v8 row_newbcast:10 row_mask:0xf bank_mask:0xf
    v_and_b32_dpp v17, v39, v9 row_newbcast:10 row_mask:0xf bank_mask:0xf
    v_and_b32_dpp v18, v39, v10 row_newbcast:10 row_mask:0xf bank_mask:0xf
    v_and_b32_dpp v19, v39, v11 row_newbcast:10 row_mask:0xf bank_mask:0xf
    s_nop 1
    v_mfma_f32_16x16x32_bf16 v[28:31], v[16:19], v[148:151], v[28:31]
    s_mov_b32 s68, 491520
    buffer_load_dwordx4 v[168:171], v4, s[36:39], s68 offen offset:2048 nt
    s_waitcnt vmcnt(6)
    v_and_b32_dpp v12, v39, v8 row_newbcast:6 row_mask:0xf bank_mask:0xf
    v_and_b32_dpp v13, v39, v9 row_newbcast:6 row_mask:0xf bank_mask:0xf
    v_and_b32_dpp v14, v39, v10 row_newbcast:6 row_mask:0xf bank_mask:0xf
    v_and_b32_dpp v15, v39, v11 row_newbcast:6 row_mask:0xf bank_mask:0xf
    s_nop 1
    v_mfma_f32_16x16x32_bf16 v[28:31], v[12:15], v[152:155], v[28:31]
    s_mov_b32 s68, 491520
    buffer_load_dwordx4 v[172:175], v4, s[36:39], s68 offen offset:3072 nt
    s_waitcnt vmcnt(6)
    v_and_b32_dpp v16, v39, v8 row_newbcast:14 row_mask:0xf bank_mask:0xf
    v_and_b32_dpp v17, v39, v9 row_newbcast:14 row_mask:0xf bank_mask:0xf
    v_and_b32_dpp v18, v39, v10 row_newbcast:14 row_mask:0xf bank_mask:0xf
    v_and_b32_dpp v19, v39, v11 row_newbcast:14 row_mask:0xf bank_mask:0xf
    s_nop 1
    v_mfma_f32_16x16x32_bf16 v[28:31], v[16:19], v[156:159], v[28:31]
    s_mov_b32 s68, 507904
    buffer_load_dwordx4 v[176:179], v4, s[36:39], s68 offen nt
    s_waitcnt vmcnt(6)
    v_and_b32_dpp v12, v39, v8 row_newbcast:1 row_mask:0xf bank_mask:0xf
    v_and_b32_dpp v13, v39, v9 row_newbcast:1 row_mask:0xf bank_mask:0xf
    v_and_b32_dpp v14, v39, v10 row_newbcast:1 row_mask:0xf bank_mask:0xf
    v_and_b32_dpp v15, v39, v11 row_newbcast:1 row_mask:0xf bank_mask:0xf
    s_nop 1
    v_mfma_f32_16x16x32_bf16 v[28:31], v[12:15], v[160:163], v[28:31]
    s_mov_b32 s68, 507904
    buffer_load_dwordx4 v[180:183], v4, s[36:39], s68 offen offset:1024 nt
    s_mov_b32 s68, 114688
    buffer_load_dwordx4 a[112:115], v7, s[52:55], s68 offen
    buffer_load_dwordx4 a[116:119], v7, s[52:55], s68 offen offset:256
    s_waitcnt vmcnt(8)
    v_and_b32_dpp v16, v39, v8 row_newbcast:9 row_mask:0xf bank_mask:0xf
    v_and_b32_dpp v17, v39, v9 row_newbcast:9 row_mask:0xf bank_mask:0xf
    v_and_b32_dpp v18, v39, v10 row_newbcast:9 row_mask:0xf bank_mask:0xf
    v_and_b32_dpp v19, v39, v11 row_newbcast:9 row_mask:0xf bank_mask:0xf
    s_nop 1
    v_mfma_f32_16x16x32_bf16 v[28:31], v[16:19], v[164:167], v[28:31]
    s_mov_b32 s68, 507904
    buffer_load_dwordx4 v[184:187], v4, s[36:39], s68 offen offset:2048 nt
    s_waitcnt vmcnt(6)
    v_and_b32_dpp v12, v39, v8 row_newbcast:5 row_mask:0xf bank_mask:0xf
    v_and_b32_dpp v13, v39, v9 row_newbcast:5 row_mask:0xf bank_mask:0xf
    v_and_b32_dpp v14, v39, v10 row_newbcast:5 row_mask:0xf bank_mask:0xf
    v_and_b32_dpp v15, v39, v11 row_newbcast:5 row_mask:0xf bank_mask:0xf
    s_nop 1
    v_mfma_f32_16x16x32_bf16 v[28:31], v[12:15], v[168:171], v[28:31]
    s_mov_b32 s68, 507904
    buffer_load_dwordx4 v[188:191], v4, s[36:39], s68 offen offset:3072 nt
    s_waitcnt vmcnt(6)
    v_and_b32_dpp v16, v39, v8 row_newbcast:13 row_mask:0xf bank_mask:0xf
    v_and_b32_dpp v17, v39, v9 row_newbcast:13 row_mask:0xf bank_mask:0xf
    v_and_b32_dpp v18, v39, v10 row_newbcast:13 row_mask:0xf bank_mask:0xf
    v_and_b32_dpp v19, v39, v11 row_newbcast:13 row_mask:0xf bank_mask:0xf
    s_nop 1
    v_mfma_f32_16x16x32_bf16 v[28:31], v[16:19], v[172:175], v[28:31]
    s_mov_b32 s68, 524288
    buffer_load_dwordx4 v[192:195], v4, s[36:39], s68 offen nt
    s_waitcnt vmcnt(6)
    v_and_b32_dpp v12, v39, v8 row_newbcast:3 row_mask:0xf bank_mask:0xf
    v_and_b32_dpp v13, v39, v9 row_newbcast:3 row_mask:0xf bank_mask:0xf
    v_and_b32_dpp v14, v39, v10 row_newbcast:3 row_mask:0xf bank_mask:0xf
    v_and_b32_dpp v15, v39, v11 row_newbcast:3 row_mask:0xf bank_mask:0xf
    s_nop 1
    v_mfma_f32_16x16x32_bf16 v[28:31], v[12:15], v[176:179], v[28:31]
    s_mov_b32 s68, 524288
    buffer_load_dwordx4 v[196:199], v4, s[36:39], s68 offen offset:1024 nt
    s_mov_b32 s68, 122880
    buffer_load_dwordx4 a[120:123], v7, s[52:55], s68 offen
    buffer_load_dwordx4 a[124:127], v7, s[52:55], s68 offen offset:256
    s_waitcnt vmcnt(8)
    v_and_b32_dpp v16, v39, v8 row_newbcast:11 row_mask:0xf bank_mask:0xf
    v_and_b32_dpp v17, v39, v9 row_newbcast:11 row_mask:0xf bank_mask:0xf
    v_and_b32_dpp v18, v39, v10 row_newbcast:11 row_mask:0xf bank_mask:0xf
    v_and_b32_dpp v19, v39, v11 row_newbcast:11 row_mask:0xf bank_mask:0xf
    s_nop 1
    v_mfma_f32_16x16x32_bf16 v[28:31], v[16:19], v[180:183], v[28:31]
    s_mov_b32 s68, 524288
    buffer_load_dwordx4 v[200:203], v4, s[36:39], s68 offen offset:2048 nt
    s_waitcnt vmcnt(6)
    v_and_b32_dpp v12, v39, v8 row_newbcast:7 row_mask:0xf bank_mask:0xf
    v_and_b32_dpp v13, v39, v9 row_newbcast:7 row_mask:0xf bank_mask:0xf
    v_and_b32_dpp v14, v39, v10 row_newbcast:7 row_mask:0xf bank_mask:0xf
    v_and_b32_dpp v15, v39, v11 row_newbcast:7 row_mask:0xf bank_mask:0xf
    s_nop 1
    v_mfma_f32_16x16x32_bf16 v[28:31], v[12:15], v[184:187], v[28:31]
    s_mov_b32 s68, 524288
    buffer_load_dwordx4 v[204:207], v4, s[36:39], s68 offen offset:3072 nt
    s_waitcnt vmcnt(6)
    v_and_b32_dpp v16, v39, v8 row_newbcast:15 row_mask:0xf bank_mask:0xf
    v_and_b32_dpp v17, v39, v9 row_newbcast:15 row_mask:0xf bank_mask:0xf
    v_and_b32_dpp v18, v39, v10 row_newbcast:15 row_mask:0xf bank_mask:0xf
    v_and_b32_dpp v19, v39, v11 row_newbcast:15 row_mask:0xf bank_mask:0xf
    s_nop 1
    v_mfma_f32_16x16x32_bf16 v[28:31], v[16:19], v[188:191], v[28:31]
    s_mov_b32 s68, 540672
    buffer_load_dwordx4 v[208:211], v4, s[36:39], s68 offen nt
    s_waitcnt vmcnt(6)
    v_and_b32_dpp v12, v40, v8 row_newbcast:0 row_mask:0xf bank_mask:0xf
    v_and_b32_dpp v13, v40, v9 row_newbcast:0 row_mask:0xf bank_mask:0xf
    v_and_b32_dpp v14, v40, v10 row_newbcast:0 row_mask:0xf bank_mask:0xf
    v_and_b32_dpp v15, v40, v11 row_newbcast:0 row_mask:0xf bank_mask:0xf
    s_nop 1
    v_mfma_f32_16x16x32_bf16 v[28:31], v[12:15], v[192:195], v[28:31]
    s_mov_b32 s68, 540672
    buffer_load_dwordx4 v[212:215], v4, s[36:39], s68 offen offset:1024 nt
    v_sub_f32 v41, v41, v73
    v_mul_f32 v41, 0x3fb8aa3b, v41
    v_exp_f32 v41, v41
    s_nop 0
    v_mul_f32 v41, v41, v75
    v_cvt_pk_bf16_f32 v41, v41, v41
    s_mov_b32 s68, 131072
    buffer_load_dwordx4 a[128:131], v7, s[52:55], s68 offen
    buffer_load_dwordx4 a[132:135], v7, s[52:55], s68 offen offset:256
    s_waitcnt vmcnt(8)
    v_and_b32_dpp v16, v40, v8 row_newbcast:8 row_mask:0xf bank_mask:0xf
    v_and_b32_dpp v17, v40, v9 row_newbcast:8 row_mask:0xf bank_mask:0xf
    v_and_b32_dpp v18, v40, v10 row_newbcast:8 row_mask:0xf bank_mask:0xf
    v_and_b32_dpp v19, v40, v11 row_newbcast:8 row_mask:0xf bank_mask:0xf
    s_nop 1
    v_mfma_f32_16x16x32_bf16 v[28:31], v[16:19], v[196:199], v[28:31]
    s_mov_b32 s68, 540672
    buffer_load_dwordx4 v[216:219], v4, s[36:39], s68 offen offset:2048 nt
    s_waitcnt vmcnt(6)
    v_and_b32_dpp v12, v40, v8 row_newbcast:4 row_mask:0xf bank_mask:0xf
    v_and_b32_dpp v13, v40, v9 row_newbcast:4 row_mask:0xf bank_mask:0xf
    v_and_b32_dpp v14, v40, v10 row_newbcast:4 row_mask:0xf bank_mask:0xf
    v_and_b32_dpp v15, v40, v11 row_newbcast:4 row_mask:0xf bank_mask:0xf
    s_nop 1
    v_mfma_f32_16x16x32_bf16 v[28:31], v[12:15], v[200:203], v[28:31]
    s_mov_b32 s68, 540672
    buffer_load_dwordx4 v[220:223], v4, s[36:39], s68 offen offset:3072 nt
    s_waitcnt vmcnt(6)
    v_and_b32_dpp v16, v40, v8 row_newbcast:12 row_mask:0xf bank_mask:0xf
    v_and_b32_dpp v17, v40, v9 row_newbcast:12 row_mask:0xf bank_mask:0xf
    v_and_b32_dpp v18, v40, v10 row_newbcast:12 row_mask:0xf bank_mask:0xf
    v_and_b32_dpp v19, v40, v11 row_newbcast:12 row_mask:0xf bank_mask:0xf
    s_nop 1
    v_mfma_f32_16x16x32_bf16 v[28:31], v[16:19], v[204:207], v[28:31]
    s_mov_b32 s68, 557056
    buffer_load_dwordx4 v[224:227], v4, s[36:39], s68 offen nt
    s_waitcnt vmcnt(6)
    v_and_b32_dpp v12, v40, v8 row_newbcast:2 row_mask:0xf bank_mask:0xf
    v_and_b32_dpp v13, v40, v9 row_newbcast:2 row_mask:0xf bank_mask:0xf
    v_and_b32_dpp v14, v40, v10 row_newbcast:2 row_mask:0xf bank_mask:0xf
    v_and_b32_dpp v15, v40, v11 row_newbcast:2 row_mask:0xf bank_mask:0xf
    s_nop 1
    v_mfma_f32_16x16x32_bf16 v[28:31], v[12:15], v[208:211], v[28:31]
    s_mov_b32 s68, 557056
    buffer_load_dwordx4 v[228:231], v4, s[36:39], s68 offen offset:1024 nt
    s_mov_b32 s68, 139264
    buffer_load_dwordx4 a[136:139], v7, s[52:55], s68 offen
    buffer_load_dwordx4 a[140:143], v7, s[52:55], s68 offen offset:256
    s_waitcnt vmcnt(8)
    v_and_b32_dpp v16, v40, v8 row_newbcast:10 row_mask:0xf bank_mask:0xf
    v_and_b32_dpp v17, v40, v9 row_newbcast:10 row_mask:0xf bank_mask:0xf
    v_and_b32_dpp v18, v40, v10 row_newbcast:10 row_mask:0xf bank_mask:0xf
    v_and_b32_dpp v19, v40, v11 row_newbcast:10 row_mask:0xf bank_mask:0xf
    s_nop 1
    v_mfma_f32_16x16x32_bf16 v[28:31], v[16:19], v[212:215], v[28:31]
    s_mov_b32 s68, 557056
    buffer_load_dwordx4 v[232:235], v4, s[36:39], s68 offen offset:2048 nt
    s_waitcnt vmcnt(6)
    v_and_b32_dpp v12, v40, v8 row_newbcast:6 row_mask:0xf bank_mask:0xf
    v_and_b32_dpp v13, v40, v9 row_newbcast:6 row_mask:0xf bank_mask:0xf
    v_and_b32_dpp v14, v40, v10 row_newbcast:6 row_mask:0xf bank_mask:0xf
    v_and_b32_dpp v15, v40, v11 row_newbcast:6 row_mask:0xf bank_mask:0xf
    s_nop 1
    v_mfma_f32_16x16x32_bf16 v[28:31], v[12:15], v[216:219], v[28:31]
    s_mov_b32 s68, 557056
    buffer_load_dwordx4 v[236:239], v4, s[36:39], s68 offen offset:3072 nt
    s_waitcnt vmcnt(6)
    v_and_b32_dpp v16, v40, v8 row_newbcast:14 row_mask:0xf bank_mask:0xf
    v_and_b32_dpp v17, v40, v9 row_newbcast:14 row_mask:0xf bank_mask:0xf
    v_and_b32_dpp v18, v40, v10 row_newbcast:14 row_mask:0xf bank_mask:0xf
    v_and_b32_dpp v19, v40, v11 row_newbcast:14 row_mask:0xf bank_mask:0xf
    s_nop 1
    v_mfma_f32_16x16x32_bf16 v[28:31], v[16:19], v[220:223], v[28:31]
    s_mov_b32 s68, 573440
    buffer_load_dwordx4 v[80:83], v4, s[36:39], s68 offen nt
    s_waitcnt vmcnt(6)
    v_and_b32_dpp v12, v40, v8 row_newbcast:1 row_mask:0xf bank_mask:0xf
    v_and_b32_dpp v13, v40, v9 row_newbcast:1 row_mask:0xf bank_mask:0xf
    v_and_b32_dpp v14, v40, v10 row_newbcast:1 row_mask:0xf bank_mask:0xf
    v_and_b32_dpp v15, v40, v11 row_newbcast:1 row_mask:0xf bank_mask:0xf
    s_nop 1
    v_mfma_f32_16x16x32_bf16 v[28:31], v[12:15], v[224:227], v[28:31]
    s_mov_b32 s68, 573440
    buffer_load_dwordx4 v[84:87], v4, s[36:39], s68 offen offset:1024 nt
    s_mov_b32 s68, 147456
    buffer_load_dwordx4 a[144:147], v7, s[52:55], s68 offen
    buffer_load_dwordx4 a[148:151], v7, s[52:55], s68 offen offset:256
    s_waitcnt vmcnt(8)
    v_and_b32_dpp v16, v40, v8 row_newbcast:9 row_mask:0xf bank_mask:0xf
    v_and_b32_dpp v17, v40, v9 row_newbcast:9 row_mask:0xf bank_mask:0xf
    v_and_b32_dpp v18, v40, v10 row_newbcast:9 row_mask:0xf bank_mask:0xf
    v_and_b32_dpp v19, v40, v11 row_newbcast:9 row_mask:0xf bank_mask:0xf
    s_nop 1
    v_mfma_f32_16x16x32_bf16 v[28:31], v[16:19], v[228:231], v[28:31]
    s_mov_b32 s68, 573440
    buffer_load_dwordx4 v[88:91], v4, s[36:39], s68 offen offset:2048 nt
    s_waitcnt vmcnt(6)
    v_and_b32_dpp v12, v40, v8 row_newbcast:5 row_mask:0xf bank_mask:0xf
    v_and_b32_dpp v13, v40, v9 row_newbcast:5 row_mask:0xf bank_mask:0xf
    v_and_b32_dpp v14, v40, v10 row_newbcast:5 row_mask:0xf bank_mask:0xf
    v_and_b32_dpp v15, v40, v11 row_newbcast:5 row_mask:0xf bank_mask:0xf
    s_nop 1
    v_mfma_f32_16x16x32_bf16 v[28:31], v[12:15], v[232:235], v[28:31]
    s_mov_b32 s68, 573440
    buffer_load_dwordx4 v[92:95], v4, s[36:39], s68 offen offset:3072 nt
    s_waitcnt vmcnt(6)
    v_and_b32_dpp v16, v40, v8 row_newbcast:13 row_mask:0xf bank_mask:0xf
    v_and_b32_dpp v17, v40, v9 row_newbcast:13 row_mask:0xf bank_mask:0xf
    v_and_b32_dpp v18, v40, v10 row_newbcast:13 row_mask:0xf bank_mask:0xf
    v_and_b32_dpp v19, v40, v11 row_newbcast:13 row_mask:0xf bank_mask:0xf
    s_nop 1
    v_mfma_f32_16x16x32_bf16 v[28:31], v[16:19], v[236:239], v[28:31]
    s_mov_b32 s68, 589824
    buffer_load_dwordx4 v[96:99], v4, s[36:39], s68 offen nt
    s_waitcnt vmcnt(6)
    v_and_b32_dpp v12, v40, v8 row_newbcast:3 row_mask:0xf bank_mask:0xf
    v_and_b32_dpp v13, v40, v9 row_newbcast:3 row_mask:0xf bank_mask:0xf
    v_and_b32_dpp v14, v40, v10 row_newbcast:3 row_mask:0xf bank_mask:0xf
    v_and_b32_dpp v15, v40, v11 row_newbcast:3 row_mask:0xf bank_mask:0xf
    s_nop 1
    v_mfma_f32_16x16x32_bf16 v[28:31], v[12:15], v[80:83], v[28:31]
    s_mov_b32 s68, 589824
    buffer_load_dwordx4 v[100:103], v4, s[36:39], s68 offen offset:1024 nt
    s_mov_b32 s68, 155648
    buffer_load_dwordx4 a[152:155], v7, s[52:55], s68 offen
    buffer_load_dwordx4 a[156:159], v7, s[52:55], s68 offen offset:256
    s_waitcnt vmcnt(8)
    v_and_b32_dpp v16, v40, v8 row_newbcast:11 row_mask:0xf bank_mask:0xf
    v_and_b32_dpp v17, v40, v9 row_newbcast:11 row_mask:0xf bank_mask:0xf
    v_and_b32_dpp v18, v40, v10 row_newbcast:11 row_mask:0xf bank_mask:0xf
    v_and_b32_dpp v19, v40, v11 row_newbcast:11 row_mask:0xf bank_mask:0xf
    s_nop 1
    v_mfma_f32_16x16x32_bf16 v[28:31], v[16:19], v[84:87], v[28:31]
    s_mov_b32 s68, 589824
    buffer_load_dwordx4 v[104:107], v4, s[36:39], s68 offen offset:2048 nt
    s_waitcnt vmcnt(6)
    v_and_b32_dpp v12, v40, v8 row_newbcast:7 row_mask:0xf bank_mask:0xf
    v_and_b32_dpp v13, v40, v9 row_newbcast:7 row_mask:0xf bank_mask:0xf
    v_and_b32_dpp v14, v40, v10 row_newbcast:7 row_mask:0xf bank_mask:0xf
    v_and_b32_dpp v15, v40, v11 row_newbcast:7 row_mask:0xf bank_mask:0xf
    s_nop 1
    v_mfma_f32_16x16x32_bf16 v[28:31], v[12:15], v[88:91], v[28:31]
    s_mov_b32 s68, 589824
    buffer_load_dwordx4 v[108:111], v4, s[36:39], s68 offen offset:3072 nt
    s_waitcnt vmcnt(6)
    v_and_b32_dpp v16, v40, v8 row_newbcast:15 row_mask:0xf bank_mask:0xf
    v_and_b32_dpp v17, v40, v9 row_newbcast:15 row_mask:0xf bank_mask:0xf
    v_and_b32_dpp v18, v40, v10 row_newbcast:15 row_mask:0xf bank_mask:0xf
    v_and_b32_dpp v19, v40, v11 row_newbcast:15 row_mask:0xf bank_mask:0xf
    s_nop 1
    v_mfma_f32_16x16x32_bf16 v[28:31], v[16:19], v[92:95], v[28:31]
    s_mov_b32 s68, 606208
    buffer_load_dwordx4 v[112:115], v4, s[36:39], s68 offen nt
    s_waitcnt vmcnt(6)
    v_and_b32_dpp v12, v41, v8 row_newbcast:0 row_mask:0xf bank_mask:0xf
    v_and_b32_dpp v13, v41, v9 row_newbcast:0 row_mask:0xf bank_mask:0xf
    v_and_b32_dpp v14, v41, v10 row_newbcast:0 row_mask:0xf bank_mask:0xf
    v_and_b32_dpp v15, v41, v11 row_newbcast:0 row_mask:0xf bank_mask:0xf
    s_nop 1
    v_mfma_f32_16x16x32_bf16 v[28:31], v[12:15], v[96:99], v[28:31]
    s_mov_b32 s68, 606208
    buffer_load_dwordx4 v[116:119], v4, s[36:39], s68 offen offset:1024 nt
    v_sub_f32 v42, v42, v73
    v_mul_f32 v42, 0x3fb8aa3b, v42
    v_exp_f32 v42, v42
    s_nop 0
    v_mul_f32 v42, v42, v75
    v_cvt_pk_bf16_f32 v42, v42, v42
    s_mov_b32 s68, 163840
    buffer_load_dwordx4 a[160:163], v7, s[52:55], s68 offen
    buffer_load_dwordx4 a[164:167], v7, s[52:55], s68 offen offset:256
    s_waitcnt vmcnt(8)
    v_and_b32_dpp v16, v41, v8 row_newbcast:8 row_mask:0xf bank_mask:0xf
    v_and_b32_dpp v17, v41, v9 row_newbcast:8 row_mask:0xf bank_mask:0xf
    v_and_b32_dpp v18, v41, v10 row_newbcast:8 row_mask:0xf bank_mask:0xf
    v_and_b32_dpp v19, v41, v11 row_newbcast:8 row_mask:0xf bank_mask:0xf
    s_nop 1
    v_mfma_f32_16x16x32_bf16 v[28:31], v[16:19], v[100:103], v[28:31]
    s_mov_b32 s68, 606208
    buffer_load_dwordx4 v[120:123], v4, s[36:39], s68 offen offset:2048 nt
    s_waitcnt vmcnt(6)
    v_and_b32_dpp v12, v41, v8 row_newbcast:4 row_mask:0xf bank_mask:0xf
    v_and_b32_dpp v13, v41, v9 row_newbcast:4 row_mask:0xf bank_mask:0xf
    v_and_b32_dpp v14, v41, v10 row_newbcast:4 row_mask:0xf bank_mask:0xf
    v_and_b32_dpp v15, v41, v11 row_newbcast:4 row_mask:0xf bank_mask:0xf
    s_nop 1
    v_mfma_f32_16x16x32_bf16 v[28:31], v[12:15], v[104:107], v[28:31]
    s_mov_b32 s68, 606208
    buffer_load_dwordx4 v[124:127], v4, s[36:39], s68 offen offset:3072 nt
    s_waitcnt vmcnt(6)
    v_and_b32_dpp v16, v41, v8 row_newbcast:12 row_mask:0xf bank_mask:0xf
    v_and_b32_dpp v17, v41, v9 row_newbcast:12 row_mask:0xf bank_mask:0xf
    v_and_b32_dpp v18, v41, v10 row_newbcast:12 row_mask:0xf bank_mask:0xf
    v_and_b32_dpp v19, v41, v11 row_newbcast:12 row_mask:0xf bank_mask:0xf
    s_nop 1
    v_mfma_f32_16x16x32_bf16 v[28:31], v[16:19], v[108:111], v[28:31]
    s_mov_b32 s68, 622592
    buffer_load_dwordx4 v[128:131], v4, s[36:39], s68 offen nt
    s_waitcnt vmcnt(6)
    v_and_b32_dpp v12, v41, v8 row_newbcast:2 row_mask:0xf bank_mask:0xf
    v_and_b32_dpp v13, v41, v9 row_newbcast:2 row_mask:0xf bank_mask:0xf
    v_and_b32_dpp v14, v41, v10 row_newbcast:2 row_mask:0xf bank_mask:0xf
    v_and_b32_dpp v15, v41, v11 row_newbcast:2 row_mask:0xf bank_mask:0xf
    s_nop 1
    v_mfma_f32_16x16x32_bf16 v[28:31], v[12:15], v[112:115], v[28:31]
    s_mov_b32 s68, 622592
    buffer_load_dwordx4 v[132:135], v4, s[36:39], s68 offen offset:1024 nt
    s_mov_b32 s68, 172032
    buffer_load_dwordx4 a[168:171], v7, s[52:55], s68 offen
    buffer_load_dwordx4 a[172:175], v7, s[52:55], s68 offen offset:256
    s_waitcnt vmcnt(8)
    v_and_b32_dpp v16, v41, v8 row_newbcast:10 row_mask:0xf bank_mask:0xf
    v_and_b32_dpp v17, v41, v9 row_newbcast:10 row_mask:0xf bank_mask:0xf
    v_and_b32_dpp v18, v41, v10 row_newbcast:10 row_mask:0xf bank_mask:0xf
    v_and_b32_dpp v19, v41, v11 row_newbcast:10 row_mask:0xf bank_mask:0xf
    s_nop 1
    v_mfma_f32_16x16x32_bf16 v[28:31], v[16:19], v[116:119], v[28:31]
    s_mov_b32 s68, 622592
    buffer_load_dwordx4 v[136:139], v4, s[36:39], s68 offen offset:2048 nt
    s_waitcnt vmcnt(6)
    v_and_b32_dpp v12, v41, v8 row_newbcast:6 row_mask:0xf bank_mask:0xf
    v_and_b32_dpp v13, v41, v9 row_newbcast:6 row_mask:0xf bank_mask:0xf
    v_and_b32_dpp v14, v41, v10 row_newbcast:6 row_mask:0xf bank_mask:0xf
    v_and_b32_dpp v15, v41, v11 row_newbcast:6 row_mask:0xf bank_mask:0xf
    s_nop 1
    v_mfma_f32_16x16x32_bf16 v[28:31], v[12:15], v[120:123], v[28:31]
    s_mov_b32 s68, 622592
    buffer_load_dwordx4 v[140:143], v4, s[36:39], s68 offen offset:3072 nt
    s_waitcnt vmcnt(6)
    v_and_b32_dpp v16, v41, v8 row_newbcast:14 row_mask:0xf bank_mask:0xf
    v_and_b32_dpp v17, v41, v9 row_newbcast:14 row_mask:0xf bank_mask:0xf
    v_and_b32_dpp v18, v41, v10 row_newbcast:14 row_mask:0xf bank_mask:0xf
    v_and_b32_dpp v19, v41, v11 row_newbcast:14 row_mask:0xf bank_mask:0xf
    s_nop 1
    v_mfma_f32_16x16x32_bf16 v[28:31], v[16:19], v[124:127], v[28:31]
    s_mov_b32 s68, 638976
    buffer_load_dwordx4 v[144:147], v4, s[36:39], s68 offen nt
    s_waitcnt vmcnt(6)
    v_and_b32_dpp v12, v41, v8 row_newbcast:1 row_mask:0xf bank_mask:0xf
    v_and_b32_dpp v13, v41, v9 row_newbcast:1 row_mask:0xf bank_mask:0xf
    v_and_b32_dpp v14, v41, v10 row_newbcast:1 row_mask:0xf bank_mask:0xf
    v_and_b32_dpp v15, v41, v11 row_newbcast:1 row_mask:0xf bank_mask:0xf
    s_nop 1
    v_mfma_f32_16x16x32_bf16 v[28:31], v[12:15], v[128:131], v[28:31]
    s_mov_b32 s68, 638976
    buffer_load_dwordx4 v[148:151], v4, s[36:39], s68 offen offset:1024 nt
    s_mov_b32 s68, 180224
    buffer_load_dwordx4 a[176:179], v7, s[52:55], s68 offen
    buffer_load_dwordx4 a[180:183], v7, s[52:55], s68 offen offset:256
    s_waitcnt vmcnt(8)
    v_and_b32_dpp v16, v41, v8 row_newbcast:9 row_mask:0xf bank_mask:0xf
    v_and_b32_dpp v17, v41, v9 row_newbcast:9 row_mask:0xf bank_mask:0xf
    v_and_b32_dpp v18, v41, v10 row_newbcast:9 row_mask:0xf bank_mask:0xf
    v_and_b32_dpp v19, v41, v11 row_newbcast:9 row_mask:0xf bank_mask:0xf
    s_nop 1
    v_mfma_f32_16x16x32_bf16 v[28:31], v[16:19], v[132:135], v[28:31]
    s_mov_b32 s68, 638976
    buffer_load_dwordx4 v[152:155], v4, s[36:39], s68 offen offset:2048 nt
    s_waitcnt vmcnt(6)
    v_and_b32_dpp v12, v41, v8 row_newbcast:5 row_mask:0xf bank_mask:0xf
    v_and_b32_dpp v13, v41, v9 row_newbcast:5 row_mask:0xf bank_mask:0xf
    v_and_b32_dpp v14, v41, v10 row_newbcast:5 row_mask:0xf bank_mask:0xf
    v_and_b32_dpp v15, v41, v11 row_newbcast:5 row_mask:0xf bank_mask:0xf
    s_nop 1
    v_mfma_f32_16x16x32_bf16 v[28:31], v[12:15], v[136:139], v[28:31]
    s_mov_b32 s68, 638976
    buffer_load_dwordx4 v[156:159], v4, s[36:39], s68 offen offset:3072 nt
    s_waitcnt vmcnt(6)
    v_and_b32_dpp v16, v41, v8 row_newbcast:13 row_mask:0xf bank_mask:0xf
    v_and_b32_dpp v17, v41, v9 row_newbcast:13 row_mask:0xf bank_mask:0xf
    v_and_b32_dpp v18, v41, v10 row_newbcast:13 row_mask:0xf bank_mask:0xf
    v_and_b32_dpp v19, v41, v11 row_newbcast:13 row_mask:0xf bank_mask:0xf
    s_nop 1
    v_mfma_f32_16x16x32_bf16 v[28:31], v[16:19], v[140:143], v[28:31]
    s_mov_b32 s68, 655360
    buffer_load_dwordx4 v[160:163], v4, s[36:39], s68 offen nt
    s_waitcnt vmcnt(6)
    v_and_b32_dpp v12, v41, v8 row_newbcast:3 row_mask:0xf bank_mask:0xf
    v_and_b32_dpp v13, v41, v9 row_newbcast:3 row_mask:0xf bank_mask:0xf
    v_and_b32_dpp v14, v41, v10 row_newbcast:3 row_mask:0xf bank_mask:0xf
    v_and_b32_dpp v15, v41, v11 row_newbcast:3 row_mask:0xf bank_mask:0xf
    s_nop 1
    v_mfma_f32_16x16x32_bf16 v[28:31], v[12:15], v[144:147], v[28:31]
    s_mov_b32 s68, 655360
    buffer_load_dwordx4 v[164:167], v4, s[36:39], s68 offen offset:1024 nt
    s_mov_b32 s68, 188416
    buffer_load_dwordx4 a[184:187], v7, s[52:55], s68 offen
    buffer_load_dwordx4 a[188:191], v7, s[52:55], s68 offen offset:256
    s_waitcnt vmcnt(8)
    v_and_b32_dpp v16, v41, v8 row_newbcast:11 row_mask:0xf bank_mask:0xf
    v_and_b32_dpp v17, v41, v9 row_newbcast:11 row_mask:0xf bank_mask:0xf
    v_and_b32_dpp v18, v41, v10 row_newbcast:11 row_mask:0xf bank_mask:0xf
    v_and_b32_dpp v19, v41, v11 row_newbcast:11 row_mask:0xf bank_mask:0xf
    s_nop 1
    v_mfma_f32_16x16x32_bf16 v[28:31], v[16:19], v[148:151], v[28:31]
    s_mov_b32 s68, 655360
    buffer_load_dwordx4 v[168:171], v4, s[36:39], s68 offen offset:2048 nt
    s_waitcnt vmcnt(6)
    v_and_b32_dpp v12, v41, v8 row_newbcast:7 row_mask:0xf bank_mask:0xf
    v_and_b32_dpp v13, v41, v9 row_newbcast:7 row_mask:0xf bank_mask:0xf
    v_and_b32_dpp v14, v41, v10 row_newbcast:7 row_mask:0xf bank_mask:0xf
    v_and_b32_dpp v15, v41, v11 row_newbcast:7 row_mask:0xf bank_mask:0xf
    s_nop 1
    v_mfma_f32_16x16x32_bf16 v[28:31], v[12:15], v[152:155], v[28:31]
    s_mov_b32 s68, 655360
    buffer_load_dwordx4 v[172:175], v4, s[36:39], s68 offen offset:3072 nt
    s_waitcnt vmcnt(6)
    v_and_b32_dpp v16, v41, v8 row_newbcast:15 row_mask:0xf bank_mask:0xf
    v_and_b32_dpp v17, v41, v9 row_newbcast:15 row_mask:0xf bank_mask:0xf
    v_and_b32_dpp v18, v41, v10 row_newbcast:15 row_mask:0xf bank_mask:0xf
    v_and_b32_dpp v19, v41, v11 row_newbcast:15 row_mask:0xf bank_mask:0xf
    s_nop 1
    v_mfma_f32_16x16x32_bf16 v[28:31], v[16:19], v[156:159], v[28:31]
    s_mov_b32 s68, 671744
    buffer_load_dwordx4 v[176:179], v4, s[36:39], s68 offen nt
    s_waitcnt vmcnt(6)
    v_and_b32_dpp v12, v42, v8 row_newbcast:0 row_mask:0xf bank_mask:0xf
    v_and_b32_dpp v13, v42, v9 row_newbcast:0 row_mask:0xf bank_mask:0xf
    v_and_b32_dpp v14, v42, v10 row_newbcast:0 row_mask:0xf bank_mask:0xf
    v_and_b32_dpp v15, v42, v11 row_newbcast:0 row_mask:0xf bank_mask:0xf
    s_nop 1
    v_mfma_f32_16x16x32_bf16 v[28:31], v[12:15], v[160:163], v[28:31]
    s_mov_b32 s68, 671744
    buffer_load_dwordx4 v[180:183], v4, s[36:39], s68 offen offset:1024 nt
    v_sub_f32 v43, v43, v73
    v_mul_f32 v43, 0x3fb8aa3b, v43
    v_exp_f32 v43, v43
    s_nop 0
    v_mul_f32 v43, v43, v75
    v_cvt_pk_bf16_f32 v43, v43, v43
    s_mov_b32 s68, 196608
    buffer_load_dwordx4 a[192:195], v7, s[52:55], s68 offen
    buffer_load_dwordx4 a[196:199], v7, s[52:55], s68 offen offset:256
    s_waitcnt vmcnt(8)
    v_and_b32_dpp v16, v42, v8 row_newbcast:8 row_mask:0xf bank_mask:0xf
    v_and_b32_dpp v17, v42, v9 row_newbcast:8 row_mask:0xf bank_mask:0xf
    v_and_b32_dpp v18, v42, v10 row_newbcast:8 row_mask:0xf bank_mask:0xf
    v_and_b32_dpp v19, v42, v11 row_newbcast:8 row_mask:0xf bank_mask:0xf
    s_nop 1
    v_mfma_f32_16x16x32_bf16 v[28:31], v[16:19], v[164:167], v[28:31]
    s_mov_b32 s68, 671744
    buffer_load_dwordx4 v[184:187], v4, s[36:39], s68 offen offset:2048 nt
    s_waitcnt vmcnt(6)
    v_and_b32_dpp v12, v42, v8 row_newbcast:4 row_mask:0xf bank_mask:0xf
    v_and_b32_dpp v13, v42, v9 row_newbcast:4 row_mask:0xf bank_mask:0xf
    v_and_b32_dpp v14, v42, v10 row_newbcast:4 row_mask:0xf bank_mask:0xf
    v_and_b32_dpp v15, v42, v11 row_newbcast:4 row_mask:0xf bank_mask:0xf
    s_nop 1
    v_mfma_f32_16x16x32_bf16 v[28:31], v[12:15], v[168:171], v[28:31]
    s_mov_b32 s68, 671744
    buffer_load_dwordx4 v[188:191], v4, s[36:39], s68 offen offset:3072 nt
    s_waitcnt vmcnt(6)
    v_and_b32_dpp v16, v42, v8 row_newbcast:12 row_mask:0xf bank_mask:0xf
    v_and_b32_dpp v17, v42, v9 row_newbcast:12 row_mask:0xf bank_mask:0xf
    v_and_b32_dpp v18, v42, v10 row_newbcast:12 row_mask:0xf bank_mask:0xf
    v_and_b32_dpp v19, v42, v11 row_newbcast:12 row_mask:0xf bank_mask:0xf
    s_nop 1
    v_mfma_f32_16x16x32_bf16 v[28:31], v[16:19], v[172:175], v[28:31]
    s_mov_b32 s68, 688128
    buffer_load_dwordx4 v[192:195], v4, s[36:39], s68 offen nt
    s_waitcnt vmcnt(6)
    v_and_b32_dpp v12, v42, v8 row_newbcast:2 row_mask:0xf bank_mask:0xf
    v_and_b32_dpp v13, v42, v9 row_newbcast:2 row_mask:0xf bank_mask:0xf
    v_and_b32_dpp v14, v42, v10 row_newbcast:2 row_mask:0xf bank_mask:0xf
    v_and_b32_dpp v15, v42, v11 row_newbcast:2 row_mask:0xf bank_mask:0xf
    s_nop 1
    v_mfma_f32_16x16x32_bf16 v[28:31], v[12:15], v[176:179], v[28:31]
    s_mov_b32 s68, 688128
    buffer_load_dwordx4 v[196:199], v4, s[36:39], s68 offen offset:1024 nt
    s_mov_b32 s68, 204800
    buffer_load_dwordx4 a[200:203], v7, s[52:55], s68 offen
    buffer_load_dwordx4 a[204:207], v7, s[52:55], s68 offen offset:256
    s_waitcnt vmcnt(8)
    v_and_b32_dpp v16, v42, v8 row_newbcast:10 row_mask:0xf bank_mask:0xf
    v_and_b32_dpp v17, v42, v9 row_newbcast:10 row_mask:0xf bank_mask:0xf
    v_and_b32_dpp v18, v42, v10 row_newbcast:10 row_mask:0xf bank_mask:0xf
    v_and_b32_dpp v19, v42, v11 row_newbcast:10 row_mask:0xf bank_mask:0xf
    s_nop 1
    v_mfma_f32_16x16x32_bf16 v[28:31], v[16:19], v[180:183], v[28:31]
    s_mov_b32 s68, 688128
    buffer_load_dwordx4 v[200:203], v4, s[36:39], s68 offen offset:2048 nt
    s_waitcnt vmcnt(6)
    v_and_b32_dpp v12, v42, v8 row_newbcast:6 row_mask:0xf bank_mask:0xf
    v_and_b32_dpp v13, v42, v9 row_newbcast:6 row_mask:0xf bank_mask:0xf
    v_and_b32_dpp v14, v42, v10 row_newbcast:6 row_mask:0xf bank_mask:0xf
    v_and_b32_dpp v15, v42, v11 row_newbcast:6 row_mask:0xf bank_mask:0xf
    s_nop 1
    v_mfma_f32_16x16x32_bf16 v[28:31], v[12:15], v[184:187], v[28:31]
    s_mov_b32 s68, 688128
    buffer_load_dwordx4 v[204:207], v4, s[36:39], s68 offen offset:3072 nt
    s_waitcnt vmcnt(6)
    v_and_b32_dpp v16, v42, v8 row_newbcast:14 row_mask:0xf bank_mask:0xf
    v_and_b32_dpp v17, v42, v9 row_newbcast:14 row_mask:0xf bank_mask:0xf
    v_and_b32_dpp v18, v42, v10 row_newbcast:14 row_mask:0xf bank_mask:0xf
    v_and_b32_dpp v19, v42, v11 row_newbcast:14 row_mask:0xf bank_mask:0xf
    s_nop 1
    v_mfma_f32_16x16x32_bf16 v[28:31], v[16:19], v[188:191], v[28:31]
    s_mov_b32 s68, 704512
    buffer_load_dwordx4 v[208:211], v4, s[36:39], s68 offen nt
    s_waitcnt vmcnt(6)
    v_and_b32_dpp v12, v42, v8 row_newbcast:1 row_mask:0xf bank_mask:0xf
    v_and_b32_dpp v13, v42, v9 row_newbcast:1 row_mask:0xf bank_mask:0xf
    v_and_b32_dpp v14, v42, v10 row_newbcast:1 row_mask:0xf bank_mask:0xf
    v_and_b32_dpp v15, v42, v11 row_newbcast:1 row_mask:0xf bank_mask:0xf
    s_nop 1
    v_mfma_f32_16x16x32_bf16 v[28:31], v[12:15], v[192:195], v[28:31]
    s_mov_b32 s68, 704512
    buffer_load_dwordx4 v[212:215], v4, s[36:39], s68 offen offset:1024 nt
    s_mov_b32 s68, 212992
    buffer_load_dwordx4 a[208:211], v7, s[52:55], s68 offen
    buffer_load_dwordx4 a[212:215], v7, s[52:55], s68 offen offset:256
    s_waitcnt vmcnt(8)
    v_and_b32_dpp v16, v42, v8 row_newbcast:9 row_mask:0xf bank_mask:0xf
    v_and_b32_dpp v17, v42, v9 row_newbcast:9 row_mask:0xf bank_mask:0xf
    v_and_b32_dpp v18, v42, v10 row_newbcast:9 row_mask:0xf bank_mask:0xf
    v_and_b32_dpp v19, v42, v11 row_newbcast:9 row_mask:0xf bank_mask:0xf
    s_nop 1
    v_mfma_f32_16x16x32_bf16 v[28:31], v[16:19], v[196:199], v[28:31]
    s_mov_b32 s68, 704512
    buffer_load_dwordx4 v[216:219], v4, s[36:39], s68 offen offset:2048 nt
    s_waitcnt vmcnt(6)
    v_and_b32_dpp v12, v42, v8 row_newbcast:5 row_mask:0xf bank_mask:0xf
    v_and_b32_dpp v13, v42, v9 row_newbcast:5 row_mask:0xf bank_mask:0xf
    v_and_b32_dpp v14, v42, v10 row_newbcast:5 row_mask:0xf bank_mask:0xf
    v_and_b32_dpp v15, v42, v11 row_newbcast:5 row_mask:0xf bank_mask:0xf
    s_nop 1
    v_mfma_f32_16x16x32_bf16 v[28:31], v[12:15], v[200:203], v[28:31]
    s_mov_b32 s68, 704512
    buffer_load_dwordx4 v[220:223], v4, s[36:39], s68 offen offset:3072 nt
    s_waitcnt vmcnt(6)
    v_and_b32_dpp v16, v42, v8 row_newbcast:13 row_mask:0xf bank_mask:0xf
    v_and_b32_dpp v17, v42, v9 row_newbcast:13 row_mask:0xf bank_mask:0xf
    v_and_b32_dpp v18, v42, v10 row_newbcast:13 row_mask:0xf bank_mask:0xf
    v_and_b32_dpp v19, v42, v11 row_newbcast:13 row_mask:0xf bank_mask:0xf
    s_nop 1
    v_mfma_f32_16x16x32_bf16 v[28:31], v[16:19], v[204:207], v[28:31]
    s_mov_b32 s68, 720896
    buffer_load_dwordx4 v[224:227], v4, s[36:39], s68 offen nt
    s_waitcnt vmcnt(6)
    v_and_b32_dpp v12, v42, v8 row_newbcast:3 row_mask:0xf bank_mask:0xf
    v_and_b32_dpp v13, v42, v9 row_newbcast:3 row_mask:0xf bank_mask:0xf
    v_and_b32_dpp v14, v42, v10 row_newbcast:3 row_mask:0xf bank_mask:0xf
    v_and_b32_dpp v15, v42, v11 row_newbcast:3 row_mask:0xf bank_mask:0xf
    s_nop 1
    v_mfma_f32_16x16x32_bf16 v[28:31], v[12:15], v[208:211], v[28:31]
    s_mov_b32 s68, 720896
    buffer_load_dwordx4 v[228:231], v4, s[36:39], s68 offen offset:1024 nt
    s_mov_b32 s68, 221184
    buffer_load_dwordx4 a[216:219], v7, s[52:55], s68 offen
    buffer_load_dwordx4 a[220:223], v7, s[52:55], s68 offen offset:256
    s_waitcnt vmcnt(8)
    v_and_b32_dpp v16, v42, v8 row_newbcast:11 row_mask:0xf bank_mask:0xf
    v_and_b32_dpp v17, v42, v9 row_newbcast:11 row_mask:0xf bank_mask:0xf
    v_and_b32_dpp v18, v42, v10 row_newbcast:11 row_mask:0xf bank_mask:0xf
    v_and_b32_dpp v19, v42, v11 row_newbcast:11 row_mask:0xf bank_mask:0xf
    s_nop 1
    v_mfma_f32_16x16x32_bf16 v[28:31], v[16:19], v[212:215], v[28:31]
    s_mov_b32 s68, 720896
    buffer_load_dwordx4 v[232:235], v4, s[36:39], s68 offen offset:2048 nt
    s_waitcnt vmcnt(6)
    v_and_b32_dpp v12, v42, v8 row_newbcast:7 row_mask:0xf bank_mask:0xf
    v_and_b32_dpp v13, v42, v9 row_newbcast:7 row_mask:0xf bank_mask:0xf
    v_and_b32_dpp v14, v42, v10 row_newbcast:7 row_mask:0xf bank_mask:0xf
    v_and_b32_dpp v15, v42, v11 row_newbcast:7 row_mask:0xf bank_mask:0xf
    s_nop 1
    v_mfma_f32_16x16x32_bf16 v[28:31], v[12:15], v[216:219], v[28:31]
    s_mov_b32 s68, 720896
    buffer_load_dwordx4 v[236:239], v4, s[36:39], s68 offen offset:3072 nt
    s_waitcnt vmcnt(6)
    v_and_b32_dpp v16, v42, v8 row_newbcast:15 row_mask:0xf bank_mask:0xf
    v_and_b32_dpp v17, v42, v9 row_newbcast:15 row_mask:0xf bank_mask:0xf
    v_and_b32_dpp v18, v42, v10 row_newbcast:15 row_mask:0xf bank_mask:0xf
    v_and_b32_dpp v19, v42, v11 row_newbcast:15 row_mask:0xf bank_mask:0xf
    s_nop 1
    v_mfma_f32_16x16x32_bf16 v[28:31], v[16:19], v[220:223], v[28:31]
    s_mov_b32 s68, 737280
    buffer_load_dwordx4 v[80:83], v4, s[36:39], s68 offen nt
    s_waitcnt vmcnt(6)
    v_and_b32_dpp v12, v43, v8 row_newbcast:0 row_mask:0xf bank_mask:0xf
    v_and_b32_dpp v13, v43, v9 row_newbcast:0 row_mask:0xf bank_mask:0xf
    v_and_b32_dpp v14, v43, v10 row_newbcast:0 row_mask:0xf bank_mask:0xf
    v_and_b32_dpp v15, v43, v11 row_newbcast:0 row_mask:0xf bank_mask:0xf
    s_nop 1
    v_mfma_f32_16x16x32_bf16 v[28:31], v[12:15], v[224:227], v[28:31]
    s_mov_b32 s68, 737280
    buffer_load_dwordx4 v[84:87], v4, s[36:39], s68 offen offset:1024 nt
    v_sub_f32 v44, v44, v73
    v_mul_f32 v44, 0x3fb8aa3b, v44
    v_exp_f32 v44, v44
    s_nop 0
    v_mul_f32 v44, v44, v75
    v_cvt_pk_bf16_f32 v44, v44, v44
    s_mov_b32 s68, 229376
    buffer_load_dwordx4 a[224:227], v7, s[52:55], s68 offen
    buffer_load_dwordx4 a[228:231], v7, s[52:55], s68 offen offset:256
    s_waitcnt vmcnt(8)
    v_and_b32_dpp v16, v43, v8 row_newbcast:8 row_mask:0xf bank_mask:0xf
    v_and_b32_dpp v17, v43, v9 row_newbcast:8 row_mask:0xf bank_mask:0xf
    v_and_b32_dpp v18, v43, v10 row_newbcast:8 row_mask:0xf bank_mask:0xf
    v_and_b32_dpp v19, v43, v11 row_newbcast:8 row_mask:0xf bank_mask:0xf
    s_nop 1
    v_mfma_f32_16x16x32_bf16 v[28:31], v[16:19], v[228:231], v[28:31]
    s_mov_b32 s68, 737280
    buffer_load_dwordx4 v[88:91], v4, s[36:39], s68 offen offset:2048 nt
    s_waitcnt vmcnt(6)
    v_and_b32_dpp v12, v43, v8 row_newbcast:4 row_mask:0xf bank_mask:0xf
    v_and_b32_dpp v13, v43, v9 row_newbcast:4 row_mask:0xf bank_mask:0xf
    v_and_b32_dpp v14, v43, v10 row_newbcast:4 row_mask:0xf bank_mask:0xf
    v_and_b32_dpp v15, v43, v11 row_newbcast:4 row_mask:0xf bank_mask:0xf
    s_nop 1
    v_mfma_f32_16x16x32_bf16 v[28:31], v[12:15], v[232:235], v[28:31]
    s_mov_b32 s68, 737280
    buffer_load_dwordx4 v[92:95], v4, s[36:39], s68 offen offset:3072 nt
    s_waitcnt vmcnt(6)
    v_and_b32_dpp v16, v43, v8 row_newbcast:12 row_mask:0xf bank_mask:0xf
    v_and_b32_dpp v17, v43, v9 row_newbcast:12 row_mask:0xf bank_mask:0xf
    v_and_b32_dpp v18, v43, v10 row_newbcast:12 row_mask:0xf bank_mask:0xf
    v_and_b32_dpp v19, v43, v11 row_newbcast:12 row_mask:0xf bank_mask:0xf
    s_nop 1
    v_mfma_f32_16x16x32_bf16 v[28:31], v[16:19], v[236:239], v[28:31]
    s_mov_b32 s68, 753664
    buffer_load_dwordx4 v[96:99], v4, s[36:39], s68 offen nt
    s_waitcnt vmcnt(6)
    v_and_b32_dpp v12, v43, v8 row_newbcast:2 row_mask:0xf bank_mask:0xf
    v_and_b32_dpp v13, v43, v9 row_newbcast:2 row_mask:0xf bank_mask:0xf
    v_and_b32_dpp v14, v43, v10 row_newbcast:2 row_mask:0xf bank_mask:0xf
    v_and_b32_dpp v15, v43, v11 row_newbcast:2 row_mask:0xf bank_mask:0xf
    s_nop 1
    v_mfma_f32_16x16x32_bf16 v[28:31], v[12:15], v[80:83], v[28:31]
    s_mov_b32 s68, 753664
    buffer_load_dwordx4 v[100:103], v4, s[36:39], s68 offen offset:1024 nt
    s_mov_b32 s68, 237568
    buffer_load_dwordx4 a[232:235], v7, s[52:55], s68 offen
    buffer_load_dwordx4 a[236:239], v7, s[52:55], s68 offen offset:256
    s_waitcnt vmcnt(8)
    v_and_b32_dpp v16, v43, v8 row_newbcast:10 row_mask:0xf bank_mask:0xf
    v_and_b32_dpp v17, v43, v9 row_newbcast:10 row_mask:0xf bank_mask:0xf
    v_and_b32_dpp v18, v43, v10 row_newbcast:10 row_mask:0xf bank_mask:0xf
    v_and_b32_dpp v19, v43, v11 row_newbcast:10 row_mask:0xf bank_mask:0xf
    s_nop 1
    v_mfma_f32_16x16x32_bf16 v[28:31], v[16:19], v[84:87], v[28:31]
    s_mov_b32 s68, 753664
    buffer_load_dwordx4 v[104:107], v4, s[36:39], s68 offen offset:2048 nt
    s_waitcnt vmcnt(6)
    v_and_b32_dpp v12, v43, v8 row_newbcast:6 row_mask:0xf bank_mask:0xf
    v_and_b32_dpp v13, v43, v9 row_newbcast:6 row_mask:0xf bank_mask:0xf
    v_and_b32_dpp v14, v43, v10 row_newbcast:6 row_mask:0xf bank_mask:0xf
    v_and_b32_dpp v15, v43, v11 row_newbcast:6 row_mask:0xf bank_mask:0xf
    s_nop 1
    v_mfma_f32_16x16x32_bf16 v[28:31], v[12:15], v[88:91], v[28:31]
    s_mov_b32 s68, 753664
    buffer_load_dwordx4 v[108:111], v4, s[36:39], s68 offen offset:3072 nt
    s_waitcnt vmcnt(6)
    v_and_b32_dpp v16, v43, v8 row_newbcast:14 row_mask:0xf bank_mask:0xf
    v_and_b32_dpp v17, v43, v9 row_newbcast:14 row_mask:0xf bank_mask:0xf
    v_and_b32_dpp v18, v43, v10 row_newbcast:14 row_mask:0xf bank_mask:0xf
    v_and_b32_dpp v19, v43, v11 row_newbcast:14 row_mask:0xf bank_mask:0xf
    s_nop 1
    v_mfma_f32_16x16x32_bf16 v[28:31], v[16:19], v[92:95], v[28:31]
    s_mov_b32 s68, 770048
    buffer_load_dwordx4 v[112:115], v4, s[36:39], s68 offen nt
    s_waitcnt vmcnt(6)
    v_and_b32_dpp v12, v43, v8 row_newbcast:1 row_mask:0xf bank_mask:0xf
    v_and_b32_dpp v13, v43, v9 row_newbcast:1 row_mask:0xf bank_mask:0xf
    v_and_b32_dpp v14, v43, v10 row_newbcast:1 row_mask:0xf bank_mask:0xf
    v_and_b32_dpp v15, v43, v11 row_newbcast:1 row_mask:0xf bank_mask:0xf
    s_nop 1
    v_mfma_f32_16x16x32_bf16 v[28:31], v[12:15], v[96:99], v[28:31]
    s_mov_b32 s68, 770048
    buffer_load_dwordx4 v[116:119], v4, s[36:39], s68 offen offset:1024 nt
    s_mov_b32 s68, 245760
    buffer_load_dwordx4 a[240:243], v7, s[52:55], s68 offen
    buffer_load_dwordx4 a[244:247], v7, s[52:55], s68 offen offset:256
    s_waitcnt vmcnt(8)
    v_and_b32_dpp v16, v43, v8 row_newbcast:9 row_mask:0xf bank_mask:0xf
    v_and_b32_dpp v17, v43, v9 row_newbcast:9 row_mask:0xf bank_mask:0xf
    v_and_b32_dpp v18, v43, v10 row_newbcast:9 row_mask:0xf bank_mask:0xf
    v_and_b32_dpp v19, v43, v11 row_newbcast:9 row_mask:0xf bank_mask:0xf
    s_nop 1
    v_mfma_f32_16x16x32_bf16 v[28:31], v[16:19], v[100:103], v[28:31]
    s_mov_b32 s68, 770048
    buffer_load_dwordx4 v[120:123], v4, s[36:39], s68 offen offset:2048 nt
    s_waitcnt vmcnt(6)
    v_and_b32_dpp v12, v43, v8 row_newbcast:5 row_mask:0xf bank_mask:0xf
    v_and_b32_dpp v13, v43, v9 row_newbcast:5 row_mask:0xf bank_mask:0xf
    v_and_b32_dpp v14, v43, v10 row_newbcast:5 row_mask:0xf bank_mask:0xf
    v_and_b32_dpp v15, v43, v11 row_newbcast:5 row_mask:0xf bank_mask:0xf
    s_nop 1
    v_mfma_f32_16x16x32_bf16 v[28:31], v[12:15], v[104:107], v[28:31]
    s_mov_b32 s68, 770048
    buffer_load_dwordx4 v[124:127], v4, s[36:39], s68 offen offset:3072 nt
    s_waitcnt vmcnt(6)
    v_and_b32_dpp v16, v43, v8 row_newbcast:13 row_mask:0xf bank_mask:0xf
    v_and_b32_dpp v17, v43, v9 row_newbcast:13 row_mask:0xf bank_mask:0xf
    v_and_b32_dpp v18, v43, v10 row_newbcast:13 row_mask:0xf bank_mask:0xf
    v_and_b32_dpp v19, v43, v11 row_newbcast:13 row_mask:0xf bank_mask:0xf
    s_nop 1
    v_mfma_f32_16x16x32_bf16 v[28:31], v[16:19], v[108:111], v[28:31]
    s_mov_b32 s68, 786432
    buffer_load_dwordx4 v[128:131], v4, s[36:39], s68 offen nt
    s_waitcnt vmcnt(6)
    v_and_b32_dpp v12, v43, v8 row_newbcast:3 row_mask:0xf bank_mask:0xf
    v_and_b32_dpp v13, v43, v9 row_newbcast:3 row_mask:0xf bank_mask:0xf
    v_and_b32_dpp v14, v43, v10 row_newbcast:3 row_mask:0xf bank_mask:0xf
    v_and_b32_dpp v15, v43, v11 row_newbcast:3 row_mask:0xf bank_mask:0xf
    s_nop 1
    v_mfma_f32_16x16x32_bf16 v[28:31], v[12:15], v[112:115], v[28:31]
    s_mov_b32 s68, 786432
    buffer_load_dwordx4 v[132:135], v4, s[36:39], s68 offen offset:1024 nt
    s_mov_b32 s68, 253952
    buffer_load_dwordx4 a[248:251], v7, s[52:55], s68 offen
    buffer_load_dwordx4 a[252:255], v7, s[52:55], s68 offen offset:256
    s_waitcnt vmcnt(8)
    v_and_b32_dpp v16, v43, v8 row_newbcast:11 row_mask:0xf bank_mask:0xf
    v_and_b32_dpp v17, v43, v9 row_newbcast:11 row_mask:0xf bank_mask:0xf
    v_and_b32_dpp v18, v43, v10 row_newbcast:11 row_mask:0xf bank_mask:0xf
    v_and_b32_dpp v19, v43, v11 row_newbcast:11 row_mask:0xf bank_mask:0xf
    s_nop 1
    v_mfma_f32_16x16x32_bf16 v[28:31], v[16:19], v[116:119], v[28:31]
    s_mov_b32 s68, 786432
    buffer_load_dwordx4 v[136:139], v4, s[36:39], s68 offen offset:2048 nt
    s_waitcnt vmcnt(6)
    v_and_b32_dpp v12, v43, v8 row_newbcast:7 row_mask:0xf bank_mask:0xf
    v_and_b32_dpp v13, v43, v9 row_newbcast:7 row_mask:0xf bank_mask:0xf
    v_and_b32_dpp v14, v43, v10 row_newbcast:7 row_mask:0xf bank_mask:0xf
    v_and_b32_dpp v15, v43, v11 row_newbcast:7 row_mask:0xf bank_mask:0xf
    s_nop 1
    v_mfma_f32_16x16x32_bf16 v[28:31], v[12:15], v[120:123], v[28:31]
    s_mov_b32 s68, 786432
    buffer_load_dwordx4 v[140:143], v4, s[36:39], s68 offen offset:3072 nt
    s_waitcnt vmcnt(6)
    v_and_b32_dpp v16, v43, v8 row_newbcast:15 row_mask:0xf bank_mask:0xf
    v_and_b32_dpp v17, v43, v9 row_newbcast:15 row_mask:0xf bank_mask:0xf
    v_and_b32_dpp v18, v43, v10 row_newbcast:15 row_mask:0xf bank_mask:0xf
    v_and_b32_dpp v19, v43, v11 row_newbcast:15 row_mask:0xf bank_mask:0xf
    s_nop 1
    v_mfma_f32_16x16x32_bf16 v[28:31], v[16:19], v[124:127], v[28:31]
    s_mov_b32 s68, 802816
    buffer_load_dwordx4 v[144:147], v4, s[36:39], s68 offen nt
    s_waitcnt vmcnt(6)
    v_and_b32_dpp v12, v44, v8 row_newbcast:0 row_mask:0xf bank_mask:0xf
    v_and_b32_dpp v13, v44, v9 row_newbcast:0 row_mask:0xf bank_mask:0xf
    v_and_b32_dpp v14, v44, v10 row_newbcast:0 row_mask:0xf bank_mask:0xf
    v_and_b32_dpp v15, v44, v11 row_newbcast:0 row_mask:0xf bank_mask:0xf
    s_nop 1
    v_mfma_f32_16x16x32_bf16 v[28:31], v[12:15], v[128:131], v[28:31]
    s_mov_b32 s68, 802816
    buffer_load_dwordx4 v[148:151], v4, s[36:39], s68 offen offset:1024 nt
    v_sub_f32 v45, v45, v73
    v_mul_f32 v45, 0x3fb8aa3b, v45
    v_exp_f32 v45, v45
    s_nop 0
    v_mul_f32 v45, v45, v75
    v_cvt_pk_bf16_f32 v45, v45, v45
    s_waitcnt vmcnt(6)
    v_and_b32_dpp v16, v44, v8 row_newbcast:8 row_mask:0xf bank_mask:0xf
    v_and_b32_dpp v17, v44, v9 row_newbcast:8 row_mask:0xf bank_mask:0xf
    v_and_b32_dpp v18, v44, v10 row_newbcast:8 row_mask:0xf bank_mask:0xf
    v_and_b32_dpp v19, v44, v11 row_newbcast:8 row_mask:0xf bank_mask:0xf
    s_nop 1
    v_mfma_f32_16x16x32_bf16 v[28:31], v[16:19], v[132:135], v[28:31]
    s_mov_b32 s68, 802816
    buffer_load_dwordx4 v[152:155], v4, s[36:39], s68 offen offset:2048 nt
    s_waitcnt vmcnt(4)
    v_and_b32_dpp v12, v44, v8 row_newbcast:4 row_mask:0xf bank_mask:0xf
    v_and_b32_dpp v13, v44, v9 row_newbcast:4 row_mask:0xf bank_mask:0xf
    v_and_b32_dpp v14, v44, v10 row_newbcast:4 row_mask:0xf bank_mask:0xf
    v_and_b32_dpp v15, v44, v11 row_newbcast:4 row_mask:0xf bank_mask:0xf
    s_nop 1
    v_mfma_f32_16x16x32_bf16 v[28:31], v[12:15], v[136:139], v[28:31]
    s_mov_b32 s68, 802816
    buffer_load_dwordx4 v[156:159], v4, s[36:39], s68 offen offset:3072 nt
    s_waitcnt vmcnt(4)
    v_and_b32_dpp v16, v44, v8 row_newbcast:12 row_mask:0xf bank_mask:0xf
    v_and_b32_dpp v17, v44, v9 row_newbcast:12 row_mask:0xf bank_mask:0xf
    v_and_b32_dpp v18, v44, v10 row_newbcast:12 row_mask:0xf bank_mask:0xf
    v_and_b32_dpp v19, v44, v11 row_newbcast:12 row_mask:0xf bank_mask:0xf
    s_nop 1
    v_mfma_f32_16x16x32_bf16 v[28:31], v[16:19], v[140:143], v[28:31]
    s_mov_b32 s68, 819200
    buffer_load_dwordx4 v[160:163], v4, s[36:39], s68 offen nt
    s_waitcnt vmcnt(4)
    v_and_b32_dpp v12, v44, v8 row_newbcast:2 row_mask:0xf bank_mask:0xf
    v_and_b32_dpp v13, v44, v9 row_newbcast:2 row_mask:0xf bank_mask:0xf
    v_and_b32_dpp v14, v44, v10 row_newbcast:2 row_mask:0xf bank_mask:0xf
    v_and_b32_dpp v15, v44, v11 row_newbcast:2 row_mask:0xf bank_mask:0xf
    s_nop 1
    v_mfma_f32_16x16x32_bf16 v[28:31], v[12:15], v[144:147], v[28:31]
    s_mov_b32 s68, 819200
    buffer_load_dwordx4 v[164:167], v4, s[36:39], s68 offen offset:1024 nt
    s_waitcnt vmcnt(4)
    v_and_b32_dpp v16, v44, v8 row_newbcast:10 row_mask:0xf bank_mask:0xf
    v_and_b32_dpp v17, v44, v9 row_newbcast:10 row_mask:0xf bank_mask:0xf
    v_and_b32_dpp v18, v44, v10 row_newbcast:10 row_mask:0xf bank_mask:0xf
    v_and_b32_dpp v19, v44, v11 row_newbcast:10 row_mask:0xf bank_mask:0xf
    s_nop 1
    v_mfma_f32_16x16x32_bf16 v[28:31], v[16:19], v[148:151], v[28:31]
    s_mov_b32 s68, 819200
    buffer_load_dwordx4 v[168:171], v4, s[36:39], s68 offen offset:2048 nt
    s_waitcnt vmcnt(4)
    v_and_b32_dpp v12, v44, v8 row_newbcast:6 row_mask:0xf bank_mask:0xf
    v_and_b32_dpp v13, v44, v9 row_newbcast:6 row_mask:0xf bank_mask:0xf
    v_and_b32_dpp v14, v44, v10 row_newbcast:6 row_mask:0xf bank_mask:0xf
    v_and_b32_dpp v15, v44, v11 row_newbcast:6 row_mask:0xf bank_mask:0xf
    s_nop 1
    v_mfma_f32_16x16x32_bf16 v[28:31], v[12:15], v[152:155], v[28:31]
    s_mov_b32 s68, 819200
    buffer_load_dwordx4 v[172:175], v4, s[36:39], s68 offen offset:3072 nt
    s_waitcnt vmcnt(4)
    v_and_b32_dpp v16, v44, v8 row_newbcast:14 row_mask:0xf bank_mask:0xf
    v_and_b32_dpp v17, v44, v9 row_newbcast:14 row_mask:0xf bank_mask:0xf
    v_and_b32_dpp v18, v44, v10 row_newbcast:14 row_mask:0xf bank_mask:0xf
    v_and_b32_dpp v19, v44, v11 row_newbcast:14 row_mask:0xf bank_mask:0xf
    s_nop 1
    v_mfma_f32_16x16x32_bf16 v[28:31], v[16:19], v[156:159], v[28:31]
    s_mov_b32 s68, 835584
    buffer_load_dwordx4 v[176:179], v4, s[36:39], s68 offen nt
    s_waitcnt vmcnt(4)
    v_and_b32_dpp v12, v44, v8 row_newbcast:1 row_mask:0xf bank_mask:0xf
    v_and_b32_dpp v13, v44, v9 row_newbcast:1 row_mask:0xf bank_mask:0xf
    v_and_b32_dpp v14, v44, v10 row_newbcast:1 row_mask:0xf bank_mask:0xf
    v_and_b32_dpp v15, v44, v11 row_newbcast:1 row_mask:0xf bank_mask:0xf
    s_nop 1
    v_mfma_f32_16x16x32_bf16 v[28:31], v[12:15], v[160:163], v[28:31]
    s_mov_b32 s68, 835584
    buffer_load_dwordx4 v[180:183], v4, s[36:39], s68 offen offset:1024 nt
    s_waitcnt vmcnt(4)
    v_and_b32_dpp v16, v44, v8 row_newbcast:9 row_mask:0xf bank_mask:0xf
    v_and_b32_dpp v17, v44, v9 row_newbcast:9 row_mask:0xf bank_mask:0xf
    v_and_b32_dpp v18, v44, v10 row_newbcast:9 row_mask:0xf bank_mask:0xf
    v_and_b32_dpp v19, v44, v11 row_newbcast:9 row_mask:0xf bank_mask:0xf
    s_nop 1
    v_mfma_f32_16x16x32_bf16 v[28:31], v[16:19], v[164:167], v[28:31]
    s_mov_b32 s68, 835584
    buffer_load_dwordx4 v[184:187], v4, s[36:39], s68 offen offset:2048 nt
    s_waitcnt vmcnt(4)
    v_and_b32_dpp v12, v44, v8 row_newbcast:5 row_mask:0xf bank_mask:0xf
    v_and_b32_dpp v13, v44, v9 row_newbcast:5 row_mask:0xf bank_mask:0xf
    v_and_b32_dpp v14, v44, v10 row_newbcast:5 row_mask:0xf bank_mask:0xf
    v_and_b32_dpp v15, v44, v11 row_newbcast:5 row_mask:0xf bank_mask:0xf
    s_nop 1
    v_mfma_f32_16x16x32_bf16 v[28:31], v[12:15], v[168:171], v[28:31]
    s_mov_b32 s68, 835584
    buffer_load_dwordx4 v[188:191], v4, s[36:39], s68 offen offset:3072 nt
    s_waitcnt vmcnt(4)
    v_and_b32_dpp v16, v44, v8 row_newbcast:13 row_mask:0xf bank_mask:0xf
    v_and_b32_dpp v17, v44, v9 row_newbcast:13 row_mask:0xf bank_mask:0xf
    v_and_b32_dpp v18, v44, v10 row_newbcast:13 row_mask:0xf bank_mask:0xf
    v_and_b32_dpp v19, v44, v11 row_newbcast:13 row_mask:0xf bank_mask:0xf
    s_nop 1
    v_mfma_f32_16x16x32_bf16 v[28:31], v[16:19], v[172:175], v[28:31]
    s_mov_b32 s68, 851968
    buffer_load_dwordx4 v[192:195], v4, s[36:39], s68 offen nt
    s_waitcnt vmcnt(4)
    v_and_b32_dpp v12, v44, v8 row_newbcast:3 row_mask:0xf bank_mask:0xf
    v_and_b32_dpp v13, v44, v9 row_newbcast:3 row_mask:0xf bank_mask:0xf
    v_and_b32_dpp v14, v44, v10 row_newbcast:3 row_mask:0xf bank_mask:0xf
    v_and_b32_dpp v15, v44, v11 row_newbcast:3 row_mask:0xf bank_mask:0xf
    s_nop 1
    v_mfma_f32_16x16x32_bf16 v[28:31], v[12:15], v[176:179], v[28:31]
    s_mov_b32 s68, 851968
    buffer_load_dwordx4 v[196:199], v4, s[36:39], s68 offen offset:1024 nt
    s_waitcnt vmcnt(4)
    v_and_b32_dpp v16, v44, v8 row_newbcast:11 row_mask:0xf bank_mask:0xf
    v_and_b32_dpp v17, v44, v9 row_newbcast:11 row_mask:0xf bank_mask:0xf
    v_and_b32_dpp v18, v44, v10 row_newbcast:11 row_mask:0xf bank_mask:0xf
    v_and_b32_dpp v19, v44, v11 row_newbcast:11 row_mask:0xf bank_mask:0xf
    s_nop 1
    v_mfma_f32_16x16x32_bf16 v[28:31], v[16:19], v[180:183], v[28:31]
    s_mov_b32 s68, 851968
    buffer_load_dwordx4 v[200:203], v4, s[36:39], s68 offen offset:2048 nt
    s_waitcnt vmcnt(4)
    v_and_b32_dpp v12, v44, v8 row_newbcast:7 row_mask:0xf bank_mask:0xf
    v_and_b32_dpp v13, v44, v9 row_newbcast:7 row_mask:0xf bank_mask:0xf
    v_and_b32_dpp v14, v44, v10 row_newbcast:7 row_mask:0xf bank_mask:0xf
    v_and_b32_dpp v15, v44, v11 row_newbcast:7 row_mask:0xf bank_mask:0xf
    s_nop 1
    v_mfma_f32_16x16x32_bf16 v[28:31], v[12:15], v[184:187], v[28:31]
    s_mov_b32 s68, 851968
    buffer_load_dwordx4 v[204:207], v4, s[36:39], s68 offen offset:3072 nt
    s_waitcnt vmcnt(4)
    v_and_b32_dpp v16, v44, v8 row_newbcast:15 row_mask:0xf bank_mask:0xf
    v_and_b32_dpp v17, v44, v9 row_newbcast:15 row_mask:0xf bank_mask:0xf
    v_and_b32_dpp v18, v44, v10 row_newbcast:15 row_mask:0xf bank_mask:0xf
    v_and_b32_dpp v19, v44, v11 row_newbcast:15 row_mask:0xf bank_mask:0xf
    s_nop 1
    v_mfma_f32_16x16x32_bf16 v[28:31], v[16:19], v[188:191], v[28:31]
    s_mov_b32 s68, 868352
    buffer_load_dwordx4 v[208:211], v4, s[36:39], s68 offen nt
    s_waitcnt vmcnt(4)
    v_and_b32_dpp v12, v45, v8 row_newbcast:0 row_mask:0xf bank_mask:0xf
    v_and_b32_dpp v13, v45, v9 row_newbcast:0 row_mask:0xf bank_mask:0xf
    v_and_b32_dpp v14, v45, v10 row_newbcast:0 row_mask:0xf bank_mask:0xf
    v_and_b32_dpp v15, v45, v11 row_newbcast:0 row_mask:0xf bank_mask:0xf
    s_nop 1
    v_mfma_f32_16x16x32_bf16 v[28:31], v[12:15], v[192:195], v[28:31]
    s_mov_b32 s68, 868352
    buffer_load_dwordx4 v[212:215], v4, s[36:39], s68 offen offset:1024 nt
    v_sub_f32 v46, v46, v73
    v_mul_f32 v46, 0x3fb8aa3b, v46
    v_exp_f32 v46, v46
    s_nop 0
    v_mul_f32 v46, v46, v75
    v_cvt_pk_bf16_f32 v46, v46, v46
    s_waitcnt vmcnt(4)
    v_and_b32_dpp v16, v45, v8 row_newbcast:8 row_mask:0xf bank_mask:0xf
    v_and_b32_dpp v17, v45, v9 row_newbcast:8 row_mask:0xf bank_mask:0xf
    v_and_b32_dpp v18, v45, v10 row_newbcast:8 row_mask:0xf bank_mask:0xf
    v_and_b32_dpp v19, v45, v11 row_newbcast:8 row_mask:0xf bank_mask:0xf
    s_nop 1
    v_mfma_f32_16x16x32_bf16 v[28:31], v[16:19], v[196:199], v[28:31]
    s_mov_b32 s68, 868352
    buffer_load_dwordx4 v[216:219], v4, s[36:39], s68 offen offset:2048 nt
    s_waitcnt vmcnt(4)
    v_and_b32_dpp v12, v45, v8 row_newbcast:4 row_mask:0xf bank_mask:0xf
    v_and_b32_dpp v13, v45, v9 row_newbcast:4 row_mask:0xf bank_mask:0xf
    v_and_b32_dpp v14, v45, v10 row_newbcast:4 row_mask:0xf bank_mask:0xf
    v_and_b32_dpp v15, v45, v11 row_newbcast:4 row_mask:0xf bank_mask:0xf
    s_nop 1
    v_mfma_f32_16x16x32_bf16 v[28:31], v[12:15], v[200:203], v[28:31]
    s_mov_b32 s68, 868352
    buffer_load_dwordx4 v[220:223], v4, s[36:39], s68 offen offset:3072 nt
    s_waitcnt vmcnt(4)
    v_and_b32_dpp v16, v45, v8 row_newbcast:12 row_mask:0xf bank_mask:0xf
    v_and_b32_dpp v17, v45, v9 row_newbcast:12 row_mask:0xf bank_mask:0xf
    v_and_b32_dpp v18, v45, v10 row_newbcast:12 row_mask:0xf bank_mask:0xf
    v_and_b32_dpp v19, v45, v11 row_newbcast:12 row_mask:0xf bank_mask:0xf
    s_nop 1
    v_mfma_f32_16x16x32_bf16 v[28:31], v[16:19], v[204:207], v[28:31]
    s_mov_b32 s68, 884736
    buffer_load_dwordx4 v[224:227], v4, s[36:39], s68 offen nt
    s_waitcnt vmcnt(4)
    v_and_b32_dpp v12, v45, v8 row_newbcast:2 row_mask:0xf bank_mask:0xf
    v_and_b32_dpp v13, v45, v9 row_newbcast:2 row_mask:0xf bank_mask:0xf
    v_and_b32_dpp v14, v45, v10 row_newbcast:2 row_mask:0xf bank_mask:0xf
    v_and_b32_dpp v15, v45, v11 row_newbcast:2 row_mask:0xf bank_mask:0xf
    s_nop 1
    v_mfma_f32_16x16x32_bf16 v[28:31], v[12:15], v[208:211], v[28:31]
    s_mov_b32 s68, 884736
    buffer_load_dwordx4 v[228:231], v4, s[36:39], s68 offen offset:1024 nt
    s_waitcnt vmcnt(4)
    v_and_b32_dpp v16, v45, v8 row_newbcast:10 row_mask:0xf bank_mask:0xf
    v_and_b32_dpp v17, v45, v9 row_newbcast:10 row_mask:0xf bank_mask:0xf
    v_and_b32_dpp v18, v45, v10 row_newbcast:10 row_mask:0xf bank_mask:0xf
    v_and_b32_dpp v19, v45, v11 row_newbcast:10 row_mask:0xf bank_mask:0xf
    s_nop 1
    v_mfma_f32_16x16x32_bf16 v[28:31], v[16:19], v[212:215], v[28:31]
    s_mov_b32 s68, 884736
    buffer_load_dwordx4 v[232:235], v4, s[36:39], s68 offen offset:2048 nt
    s_waitcnt vmcnt(4)
    v_and_b32_dpp v12, v45, v8 row_newbcast:6 row_mask:0xf bank_mask:0xf
    v_and_b32_dpp v13, v45, v9 row_newbcast:6 row_mask:0xf bank_mask:0xf
    v_and_b32_dpp v14, v45, v10 row_newbcast:6 row_mask:0xf bank_mask:0xf
    v_and_b32_dpp v15, v45, v11 row_newbcast:6 row_mask:0xf bank_mask:0xf
    s_nop 1
    v_mfma_f32_16x16x32_bf16 v[28:31], v[12:15], v[216:219], v[28:31]
    s_mov_b32 s68, 884736
    buffer_load_dwordx4 v[236:239], v4, s[36:39], s68 offen offset:3072 nt
    s_waitcnt vmcnt(4)
    v_and_b32_dpp v16, v45, v8 row_newbcast:14 row_mask:0xf bank_mask:0xf
    v_and_b32_dpp v17, v45, v9 row_newbcast:14 row_mask:0xf bank_mask:0xf
    v_and_b32_dpp v18, v45, v10 row_newbcast:14 row_mask:0xf bank_mask:0xf
    v_and_b32_dpp v19, v45, v11 row_newbcast:14 row_mask:0xf bank_mask:0xf
    s_nop 1
    v_mfma_f32_16x16x32_bf16 v[28:31], v[16:19], v[220:223], v[28:31]
    s_mov_b32 s68, 901120
    buffer_load_dwordx4 v[80:83], v4, s[36:39], s68 offen nt
    s_waitcnt vmcnt(4)
    v_and_b32_dpp v12, v45, v8 row_newbcast:1 row_mask:0xf bank_mask:0xf
    v_and_b32_dpp v13, v45, v9 row_newbcast:1 row_mask:0xf bank_mask:0xf
    v_and_b32_dpp v14, v45, v10 row_newbcast:1 row_mask:0xf bank_mask:0xf
    v_and_b32_dpp v15, v45, v11 row_newbcast:1 row_mask:0xf bank_mask:0xf
    s_nop 1
    v_mfma_f32_16x16x32_bf16 v[28:31], v[12:15], v[224:227], v[28:31]
    s_mov_b32 s68, 901120
    buffer_load_dwordx4 v[84:87], v4, s[36:39], s68 offen offset:1024 nt
    s_waitcnt vmcnt(4)
    v_and_b32_dpp v16, v45, v8 row_newbcast:9 row_mask:0xf bank_mask:0xf
    v_and_b32_dpp v17, v45, v9 row_newbcast:9 row_mask:0xf bank_mask:0xf
    v_and_b32_dpp v18, v45, v10 row_newbcast:9 row_mask:0xf bank_mask:0xf
    v_and_b32_dpp v19, v45, v11 row_newbcast:9 row_mask:0xf bank_mask:0xf
    s_nop 1
    v_mfma_f32_16x16x32_bf16 v[28:31], v[16:19], v[228:231], v[28:31]
    s_mov_b32 s68, 901120
    buffer_load_dwordx4 v[88:91], v4, s[36:39], s68 offen offset:2048 nt
    s_waitcnt vmcnt(4)
    v_and_b32_dpp v12, v45, v8 row_newbcast:5 row_mask:0xf bank_mask:0xf
    v_and_b32_dpp v13, v45, v9 row_newbcast:5 row_mask:0xf bank_mask:0xf
    v_and_b32_dpp v14, v45, v10 row_newbcast:5 row_mask:0xf bank_mask:0xf
    v_and_b32_dpp v15, v45, v11 row_newbcast:5 row_mask:0xf bank_mask:0xf
    s_nop 1
    v_mfma_f32_16x16x32_bf16 v[28:31], v[12:15], v[232:235], v[28:31]
    s_mov_b32 s68, 901120
    buffer_load_dwordx4 v[92:95], v4, s[36:39], s68 offen offset:3072 nt
    s_waitcnt vmcnt(4)
    v_and_b32_dpp v16, v45, v8 row_newbcast:13 row_mask:0xf bank_mask:0xf
    v_and_b32_dpp v17, v45, v9 row_newbcast:13 row_mask:0xf bank_mask:0xf
    v_and_b32_dpp v18, v45, v10 row_newbcast:13 row_mask:0xf bank_mask:0xf
    v_and_b32_dpp v19, v45, v11 row_newbcast:13 row_mask:0xf bank_mask:0xf
    s_nop 1
    v_mfma_f32_16x16x32_bf16 v[28:31], v[16:19], v[236:239], v[28:31]
    s_mov_b32 s68, 917504
    buffer_load_dwordx4 v[96:99], v4, s[36:39], s68 offen nt
    s_waitcnt vmcnt(4)
    v_and_b32_dpp v12, v45, v8 row_newbcast:3 row_mask:0xf bank_mask:0xf
    v_and_b32_dpp v13, v45, v9 row_newbcast:3 row_mask:0xf bank_mask:0xf
    v_and_b32_dpp v14, v45, v10 row_newbcast:3 row_mask:0xf bank_mask:0xf
    v_and_b32_dpp v15, v45, v11 row_newbcast:3 row_mask:0xf bank_mask:0xf
    s_nop 1
    v_mfma_f32_16x16x32_bf16 v[28:31], v[12:15], v[80:83], v[28:31]
    s_mov_b32 s68, 917504
    buffer_load_dwordx4 v[100:103], v4, s[36:39], s68 offen offset:1024 nt
    s_waitcnt vmcnt(4)
    v_and_b32_dpp v16, v45, v8 row_newbcast:11 row_mask:0xf bank_mask:0xf
    v_and_b32_dpp v17, v45, v9 row_newbcast:11 row_mask:0xf bank_mask:0xf
    v_and_b32_dpp v18, v45, v10 row_newbcast:11 row_mask:0xf bank_mask:0xf
    v_and_b32_dpp v19, v45, v11 row_newbcast:11 row_mask:0xf bank_mask:0xf
    s_nop 1
    v_mfma_f32_16x16x32_bf16 v[28:31], v[16:19], v[84:87], v[28:31]
    s_mov_b32 s68, 917504
    buffer_load_dwordx4 v[104:107], v4, s[36:39], s68 offen offset:2048 nt
    s_waitcnt vmcnt(4)
    v_and_b32_dpp v12, v45, v8 row_newbcast:7 row_mask:0xf bank_mask:0xf
    v_and_b32_dpp v13, v45, v9 row_newbcast:7 row_mask:0xf bank_mask:0xf
    v_and_b32_dpp v14, v45, v10 row_newbcast:7 row_mask:0xf bank_mask:0xf
    v_and_b32_dpp v15, v45, v11 row_newbcast:7 row_mask:0xf bank_mask:0xf
    s_nop 1
    v_mfma_f32_16x16x32_bf16 v[28:31], v[12:15], v[88:91], v[28:31]
    s_mov_b32 s68, 917504
    buffer_load_dwordx4 v[108:111], v4, s[36:39], s68 offen offset:3072 nt
    s_waitcnt vmcnt(4)
    v_and_b32_dpp v16, v45, v8 row_newbcast:15 row_mask:0xf bank_mask:0xf
    v_and_b32_dpp v17, v45, v9 row_newbcast:15 row_mask:0xf bank_mask:0xf
    v_and_b32_dpp v18, v45, v10 row_newbcast:15 row_mask:0xf bank_mask:0xf
    v_and_b32_dpp v19, v45, v11 row_newbcast:15 row_mask:0xf bank_mask:0xf
    s_nop 1
    v_mfma_f32_16x16x32_bf16 v[28:31], v[16:19], v[92:95], v[28:31]
    s_mov_b32 s68, 933888
    buffer_load_dwordx4 v[112:115], v4, s[36:39], s68 offen nt
    s_waitcnt vmcnt(4)
    v_and_b32_dpp v12, v46, v8 row_newbcast:0 row_mask:0xf bank_mask:0xf
    v_and_b32_dpp v13, v46, v9 row_newbcast:0 row_mask:0xf bank_mask:0xf
    v_and_b32_dpp v14, v46, v10 row_newbcast:0 row_mask:0xf bank_mask:0xf
    v_and_b32_dpp v15, v46, v11 row_newbcast:0 row_mask:0xf bank_mask:0xf
    s_nop 1
    v_mfma_f32_16x16x32_bf16 v[28:31], v[12:15], v[96:99], v[28:31]
    s_mov_b32 s68, 933888
    buffer_load_dwordx4 v[116:119], v4, s[36:39], s68 offen offset:1024 nt
    v_sub_f32 v47, v47, v73
    v_mul_f32 v47, 0x3fb8aa3b, v47
    v_exp_f32 v47, v47
    s_nop 0
    v_mul_f32 v47, v47, v75
    v_cvt_pk_bf16_f32 v47, v47, v47
    s_waitcnt vmcnt(4)
    v_and_b32_dpp v16, v46, v8 row_newbcast:8 row_mask:0xf bank_mask:0xf
    v_and_b32_dpp v17, v46, v9 row_newbcast:8 row_mask:0xf bank_mask:0xf
    v_and_b32_dpp v18, v46, v10 row_newbcast:8 row_mask:0xf bank_mask:0xf
    v_and_b32_dpp v19, v46, v11 row_newbcast:8 row_mask:0xf bank_mask:0xf
    s_nop 1
    v_mfma_f32_16x16x32_bf16 v[28:31], v[16:19], v[100:103], v[28:31]
    s_mov_b32 s68, 933888
    buffer_load_dwordx4 v[120:123], v4, s[36:39], s68 offen offset:2048 nt
    s_waitcnt vmcnt(4)
    v_and_b32_dpp v12, v46, v8 row_newbcast:4 row_mask:0xf bank_mask:0xf
    v_and_b32_dpp v13, v46, v9 row_newbcast:4 row_mask:0xf bank_mask:0xf
    v_and_b32_dpp v14, v46, v10 row_newbcast:4 row_mask:0xf bank_mask:0xf
    v_and_b32_dpp v15, v46, v11 row_newbcast:4 row_mask:0xf bank_mask:0xf
    s_nop 1
    v_mfma_f32_16x16x32_bf16 v[28:31], v[12:15], v[104:107], v[28:31]
    s_mov_b32 s68, 933888
    buffer_load_dwordx4 v[124:127], v4, s[36:39], s68 offen offset:3072 nt
    s_waitcnt vmcnt(4)
    v_and_b32_dpp v16, v46, v8 row_newbcast:12 row_mask:0xf bank_mask:0xf
    v_and_b32_dpp v17, v46, v9 row_newbcast:12 row_mask:0xf bank_mask:0xf
    v_and_b32_dpp v18, v46, v10 row_newbcast:12 row_mask:0xf bank_mask:0xf
    v_and_b32_dpp v19, v46, v11 row_newbcast:12 row_mask:0xf bank_mask:0xf
    s_nop 1
    v_mfma_f32_16x16x32_bf16 v[28:31], v[16:19], v[108:111], v[28:31]
    s_mov_b32 s68, 950272
    buffer_load_dwordx4 v[128:131], v4, s[36:39], s68 offen nt
    s_waitcnt vmcnt(4)
    v_and_b32_dpp v12, v46, v8 row_newbcast:2 row_mask:0xf bank_mask:0xf
    v_and_b32_dpp v13, v46, v9 row_newbcast:2 row_mask:0xf bank_mask:0xf
    v_and_b32_dpp v14, v46, v10 row_newbcast:2 row_mask:0xf bank_mask:0xf
    v_and_b32_dpp v15, v46, v11 row_newbcast:2 row_mask:0xf bank_mask:0xf
    s_nop 1
    v_mfma_f32_16x16x32_bf16 v[28:31], v[12:15], v[112:115], v[28:31]
    s_mov_b32 s68, 950272
    buffer_load_dwordx4 v[132:135], v4, s[36:39], s68 offen offset:1024 nt
    s_waitcnt vmcnt(4)
    v_and_b32_dpp v16, v46, v8 row_newbcast:10 row_mask:0xf bank_mask:0xf
    v_and_b32_dpp v17, v46, v9 row_newbcast:10 row_mask:0xf bank_mask:0xf
    v_and_b32_dpp v18, v46, v10 row_newbcast:10 row_mask:0xf bank_mask:0xf
    v_and_b32_dpp v19, v46, v11 row_newbcast:10 row_mask:0xf bank_mask:0xf
    s_nop 1
    v_mfma_f32_16x16x32_bf16 v[28:31], v[16:19], v[116:119], v[28:31]
    s_mov_b32 s68, 950272
    buffer_load_dwordx4 v[136:139], v4, s[36:39], s68 offen offset:2048 nt
    s_waitcnt vmcnt(4)
    v_and_b32_dpp v12, v46, v8 row_newbcast:6 row_mask:0xf bank_mask:0xf
    v_and_b32_dpp v13, v46, v9 row_newbcast:6 row_mask:0xf bank_mask:0xf
    v_and_b32_dpp v14, v46, v10 row_newbcast:6 row_mask:0xf bank_mask:0xf
    v_and_b32_dpp v15, v46, v11 row_newbcast:6 row_mask:0xf bank_mask:0xf
    s_nop 1
    v_mfma_f32_16x16x32_bf16 v[28:31], v[12:15], v[120:123], v[28:31]
    s_mov_b32 s68, 950272
    buffer_load_dwordx4 v[140:143], v4, s[36:39], s68 offen offset:3072 nt
    s_waitcnt vmcnt(4)
    v_and_b32_dpp v16, v46, v8 row_newbcast:14 row_mask:0xf bank_mask:0xf
    v_and_b32_dpp v17, v46, v9 row_newbcast:14 row_mask:0xf bank_mask:0xf
    v_and_b32_dpp v18, v46, v10 row_newbcast:14 row_mask:0xf bank_mask:0xf
    v_and_b32_dpp v19, v46, v11 row_newbcast:14 row_mask:0xf bank_mask:0xf
    s_nop 1
    v_mfma_f32_16x16x32_bf16 v[28:31], v[16:19], v[124:127], v[28:31]
    s_mov_b32 s68, 966656
    buffer_load_dwordx4 v[144:147], v4, s[36:39], s68 offen nt
    s_waitcnt vmcnt(4)
    v_and_b32_dpp v12, v46, v8 row_newbcast:1 row_mask:0xf bank_mask:0xf
    v_and_b32_dpp v13, v46, v9 row_newbcast:1 row_mask:0xf bank_mask:0xf
    v_and_b32_dpp v14, v46, v10 row_newbcast:1 row_mask:0xf bank_mask:0xf
    v_and_b32_dpp v15, v46, v11 row_newbcast:1 row_mask:0xf bank_mask:0xf
    s_nop 1
    v_mfma_f32_16x16x32_bf16 v[28:31], v[12:15], v[128:131], v[28:31]
    s_mov_b32 s68, 966656
    buffer_load_dwordx4 v[148:151], v4, s[36:39], s68 offen offset:1024 nt
    s_waitcnt vmcnt(4)
    v_and_b32_dpp v16, v46, v8 row_newbcast:9 row_mask:0xf bank_mask:0xf
    v_and_b32_dpp v17, v46, v9 row_newbcast:9 row_mask:0xf bank_mask:0xf
    v_and_b32_dpp v18, v46, v10 row_newbcast:9 row_mask:0xf bank_mask:0xf
    v_and_b32_dpp v19, v46, v11 row_newbcast:9 row_mask:0xf bank_mask:0xf
    s_nop 1
    v_mfma_f32_16x16x32_bf16 v[28:31], v[16:19], v[132:135], v[28:31]
    s_mov_b32 s68, 966656
    buffer_load_dwordx4 v[152:155], v4, s[36:39], s68 offen offset:2048 nt
    s_waitcnt vmcnt(4)
    v_and_b32_dpp v12, v46, v8 row_newbcast:5 row_mask:0xf bank_mask:0xf
    v_and_b32_dpp v13, v46, v9 row_newbcast:5 row_mask:0xf bank_mask:0xf
    v_and_b32_dpp v14, v46, v10 row_newbcast:5 row_mask:0xf bank_mask:0xf
    v_and_b32_dpp v15, v46, v11 row_newbcast:5 row_mask:0xf bank_mask:0xf
    s_nop 1
    v_mfma_f32_16x16x32_bf16 v[28:31], v[12:15], v[136:139], v[28:31]
    s_mov_b32 s68, 966656
    buffer_load_dwordx4 v[156:159], v4, s[36:39], s68 offen offset:3072 nt
    s_waitcnt vmcnt(4)
    v_and_b32_dpp v16, v46, v8 row_newbcast:13 row_mask:0xf bank_mask:0xf
    v_and_b32_dpp v17, v46, v9 row_newbcast:13 row_mask:0xf bank_mask:0xf
    v_and_b32_dpp v18, v46, v10 row_newbcast:13 row_mask:0xf bank_mask:0xf
    v_and_b32_dpp v19, v46, v11 row_newbcast:13 row_mask:0xf bank_mask:0xf
    s_nop 1
    v_mfma_f32_16x16x32_bf16 v[28:31], v[16:19], v[140:143], v[28:31]
    s_mov_b32 s68, 983040
    buffer_load_dwordx4 v[160:163], v4, s[36:39], s68 offen nt
    s_waitcnt vmcnt(4)
    v_and_b32_dpp v12, v46, v8 row_newbcast:3 row_mask:0xf bank_mask:0xf
    v_and_b32_dpp v13, v46, v9 row_newbcast:3 row_mask:0xf bank_mask:0xf
    v_and_b32_dpp v14, v46, v10 row_newbcast:3 row_mask:0xf bank_mask:0xf
    v_and_b32_dpp v15, v46, v11 row_newbcast:3 row_mask:0xf bank_mask:0xf
    s_nop 1
    v_mfma_f32_16x16x32_bf16 v[28:31], v[12:15], v[144:147], v[28:31]
    s_mov_b32 s68, 983040
    buffer_load_dwordx4 v[164:167], v4, s[36:39], s68 offen offset:1024 nt
    s_waitcnt vmcnt(4)
    v_and_b32_dpp v16, v46, v8 row_newbcast:11 row_mask:0xf bank_mask:0xf
    v_and_b32_dpp v17, v46, v9 row_newbcast:11 row_mask:0xf bank_mask:0xf
    v_and_b32_dpp v18, v46, v10 row_newbcast:11 row_mask:0xf bank_mask:0xf
    v_and_b32_dpp v19, v46, v11 row_newbcast:11 row_mask:0xf bank_mask:0xf
    s_nop 1
    v_mfma_f32_16x16x32_bf16 v[28:31], v[16:19], v[148:151], v[28:31]
    s_mov_b32 s68, 983040
    buffer_load_dwordx4 v[168:171], v4, s[36:39], s68 offen offset:2048 nt
    s_waitcnt vmcnt(4)
    v_and_b32_dpp v12, v46, v8 row_newbcast:7 row_mask:0xf bank_mask:0xf
    v_and_b32_dpp v13, v46, v9 row_newbcast:7 row_mask:0xf bank_mask:0xf
    v_and_b32_dpp v14, v46, v10 row_newbcast:7 row_mask:0xf bank_mask:0xf
    v_and_b32_dpp v15, v46, v11 row_newbcast:7 row_mask:0xf bank_mask:0xf
    s_nop 1
    v_mfma_f32_16x16x32_bf16 v[28:31], v[12:15], v[152:155], v[28:31]
    s_mov_b32 s68, 983040
    buffer_load_dwordx4 v[172:175], v4, s[36:39], s68 offen offset:3072 nt
    s_waitcnt vmcnt(4)
    v_and_b32_dpp v16, v46, v8 row_newbcast:15 row_mask:0xf bank_mask:0xf
    v_and_b32_dpp v17, v46, v9 row_newbcast:15 row_mask:0xf bank_mask:0xf
    v_and_b32_dpp v18, v46, v10 row_newbcast:15 row_mask:0xf bank_mask:0xf
    v_and_b32_dpp v19, v46, v11 row_newbcast:15 row_mask:0xf bank_mask:0xf
    s_nop 1
    v_mfma_f32_16x16x32_bf16 v[28:31], v[16:19], v[156:159], v[28:31]
    s_mov_b32 s68, 999424
    buffer_load_dwordx4 v[176:179], v4, s[36:39], s68 offen nt
    s_waitcnt vmcnt(4)
    v_and_b32_dpp v12, v47, v8 row_newbcast:0 row_mask:0xf bank_mask:0xf
    v_and_b32_dpp v13, v47, v9 row_newbcast:0 row_mask:0xf bank_mask:0xf
    v_and_b32_dpp v14, v47, v10 row_newbcast:0 row_mask:0xf bank_mask:0xf
    v_and_b32_dpp v15, v47, v11 row_newbcast:0 row_mask:0xf bank_mask:0xf
    s_nop 1
    v_mfma_f32_16x16x32_bf16 v[28:31], v[12:15], v[160:163], v[28:31]
    s_mov_b32 s68, 999424
    buffer_load_dwordx4 v[180:183], v4, s[36:39], s68 offen offset:1024 nt
    s_waitcnt vmcnt(4)
    v_and_b32_dpp v16, v47, v8 row_newbcast:8 row_mask:0xf bank_mask:0xf
    v_and_b32_dpp v17, v47, v9 row_newbcast:8 row_mask:0xf bank_mask:0xf
    v_and_b32_dpp v18, v47, v10 row_newbcast:8 row_mask:0xf bank_mask:0xf
    v_and_b32_dpp v19, v47, v11 row_newbcast:8 row_mask:0xf bank_mask:0xf
    s_nop 1
    v_mfma_f32_16x16x32_bf16 v[28:31], v[16:19], v[164:167], v[28:31]
    s_mov_b32 s68, 999424
    buffer_load_dwordx4 v[184:187], v4, s[36:39], s68 offen offset:2048 nt
    s_waitcnt vmcnt(4)
    v_and_b32_dpp v12, v47, v8 row_newbcast:4 row_mask:0xf bank_mask:0xf
    v_and_b32_dpp v13, v47, v9 row_newbcast:4 row_mask:0xf bank_mask:0xf
    v_and_b32_dpp v14, v47, v10 row_newbcast:4 row_mask:0xf bank_mask:0xf
    v_and_b32_dpp v15, v47, v11 row_newbcast:4 row_mask:0xf bank_mask:0xf
    s_nop 1
    v_mfma_f32_16x16x32_bf16 v[28:31], v[12:15], v[168:171], v[28:31]
    s_mov_b32 s68, 999424
    buffer_load_dwordx4 v[188:191], v4, s[36:39], s68 offen offset:3072 nt
    s_waitcnt vmcnt(4)
    v_and_b32_dpp v16, v47, v8 row_newbcast:12 row_mask:0xf bank_mask:0xf
    v_and_b32_dpp v17, v47, v9 row_newbcast:12 row_mask:0xf bank_mask:0xf
    v_and_b32_dpp v18, v47, v10 row_newbcast:12 row_mask:0xf bank_mask:0xf
    v_and_b32_dpp v19, v47, v11 row_newbcast:12 row_mask:0xf bank_mask:0xf
    s_nop 1
    v_mfma_f32_16x16x32_bf16 v[28:31], v[16:19], v[172:175], v[28:31]
    s_mov_b32 s68, 1015808
    buffer_load_dwordx4 v[192:195], v4, s[36:39], s68 offen nt
    s_waitcnt vmcnt(4)
    v_and_b32_dpp v12, v47, v8 row_newbcast:2 row_mask:0xf bank_mask:0xf
    v_and_b32_dpp v13, v47, v9 row_newbcast:2 row_mask:0xf bank_mask:0xf
    v_and_b32_dpp v14, v47, v10 row_newbcast:2 row_mask:0xf bank_mask:0xf
    v_and_b32_dpp v15, v47, v11 row_newbcast:2 row_mask:0xf bank_mask:0xf
    s_nop 1
    v_mfma_f32_16x16x32_bf16 v[28:31], v[12:15], v[176:179], v[28:31]
    s_mov_b32 s68, 1015808
    buffer_load_dwordx4 v[196:199], v4, s[36:39], s68 offen offset:1024 nt
    s_waitcnt vmcnt(4)
    v_and_b32_dpp v16, v47, v8 row_newbcast:10 row_mask:0xf bank_mask:0xf
    v_and_b32_dpp v17, v47, v9 row_newbcast:10 row_mask:0xf bank_mask:0xf
    v_and_b32_dpp v18, v47, v10 row_newbcast:10 row_mask:0xf bank_mask:0xf
    v_and_b32_dpp v19, v47, v11 row_newbcast:10 row_mask:0xf bank_mask:0xf
    s_nop 1
    v_mfma_f32_16x16x32_bf16 v[28:31], v[16:19], v[180:183], v[28:31]
    s_mov_b32 s68, 1015808
    buffer_load_dwordx4 v[200:203], v4, s[36:39], s68 offen offset:2048 nt
    s_waitcnt vmcnt(4)
    v_and_b32_dpp v12, v47, v8 row_newbcast:6 row_mask:0xf bank_mask:0xf
    v_and_b32_dpp v13, v47, v9 row_newbcast:6 row_mask:0xf bank_mask:0xf
    v_and_b32_dpp v14, v47, v10 row_newbcast:6 row_mask:0xf bank_mask:0xf
    v_and_b32_dpp v15, v47, v11 row_newbcast:6 row_mask:0xf bank_mask:0xf
    s_nop 1
    v_mfma_f32_16x16x32_bf16 v[28:31], v[12:15], v[184:187], v[28:31]
    s_mov_b32 s68, 1015808
    buffer_load_dwordx4 v[204:207], v4, s[36:39], s68 offen offset:3072 nt
    s_waitcnt vmcnt(4)
    v_and_b32_dpp v16, v47, v8 row_newbcast:14 row_mask:0xf bank_mask:0xf
    v_and_b32_dpp v17, v47, v9 row_newbcast:14 row_mask:0xf bank_mask:0xf
    v_and_b32_dpp v18, v47, v10 row_newbcast:14 row_mask:0xf bank_mask:0xf
    v_and_b32_dpp v19, v47, v11 row_newbcast:14 row_mask:0xf bank_mask:0xf
    s_nop 1
    v_mfma_f32_16x16x32_bf16 v[28:31], v[16:19], v[188:191], v[28:31]
    s_mov_b32 s68, 1032192
    buffer_load_dwordx4 v[208:211], v4, s[36:39], s68 offen nt
    s_waitcnt vmcnt(4)
    v_and_b32_dpp v12, v47, v8 row_newbcast:1 row_mask:0xf bank_mask:0xf
    v_and_b32_dpp v13, v47, v9 row_newbcast:1 row_mask:0xf bank_mask:0xf
    v_and_b32_dpp v14, v47, v10 row_newbcast:1 row_mask:0xf bank_mask:0xf
    v_and_b32_dpp v15, v47, v11 row_newbcast:1 row_mask:0xf bank_mask:0xf
    s_nop 1
    v_mfma_f32_16x16x32_bf16 v[28:31], v[12:15], v[192:195], v[28:31]
    s_mov_b32 s68, 1032192
    buffer_load_dwordx4 v[212:215], v4, s[36:39], s68 offen offset:1024 nt
    s_waitcnt vmcnt(4)
    v_and_b32_dpp v16, v47, v8 row_newbcast:9 row_mask:0xf bank_mask:0xf
    v_and_b32_dpp v17, v47, v9 row_newbcast:9 row_mask:0xf bank_mask:0xf
    v_and_b32_dpp v18, v47, v10 row_newbcast:9 row_mask:0xf bank_mask:0xf
    v_and_b32_dpp v19, v47, v11 row_newbcast:9 row_mask:0xf bank_mask:0xf
    s_nop 1
    v_mfma_f32_16x16x32_bf16 v[28:31], v[16:19], v[196:199], v[28:31]
    s_mov_b32 s68, 1032192
    buffer_load_dwordx4 v[216:219], v4, s[36:39], s68 offen offset:2048 nt
    s_waitcnt vmcnt(4)
    v_and_b32_dpp v12, v47, v8 row_newbcast:5 row_mask:0xf bank_mask:0xf
    v_and_b32_dpp v13, v47, v9 row_newbcast:5 row_mask:0xf bank_mask:0xf
    v_and_b32_dpp v14, v47, v10 row_newbcast:5 row_mask:0xf bank_mask:0xf
    v_and_b32_dpp v15, v47, v11 row_newbcast:5 row_mask:0xf bank_mask:0xf
    s_nop 1
    v_mfma_f32_16x16x32_bf16 v[28:31], v[12:15], v[200:203], v[28:31]
    s_mov_b32 s68, 1032192
    buffer_load_dwordx4 v[220:223], v4, s[36:39], s68 offen offset:3072 nt
    s_waitcnt vmcnt(4)
    v_and_b32_dpp v16, v47, v8 row_newbcast:13 row_mask:0xf bank_mask:0xf
    v_and_b32_dpp v17, v47, v9 row_newbcast:13 row_mask:0xf bank_mask:0xf
    v_and_b32_dpp v18, v47, v10 row_newbcast:13 row_mask:0xf bank_mask:0xf
    v_and_b32_dpp v19, v47, v11 row_newbcast:13 row_mask:0xf bank_mask:0xf
    s_nop 1
    v_mfma_f32_16x16x32_bf16 v[28:31], v[16:19], v[204:207], v[28:31]
    s_waitcnt vmcnt(3)
    v_and_b32_dpp v12, v47, v8 row_newbcast:3 row_mask:0xf bank_mask:0xf
    v_and_b32_dpp v13, v47, v9 row_newbcast:3 row_mask:0xf bank_mask:0xf
    v_and_b32_dpp v14, v47, v10 row_newbcast:3 row_mask:0xf bank_mask:0xf
    v_and_b32_dpp v15, v47, v11 row_newbcast:3 row_mask:0xf bank_mask:0xf
    s_nop 1
    v_mfma_f32_16x16x32_bf16 v[28:31], v[12:15], v[208:211], v[28:31]
    s_waitcnt vmcnt(2)
    v_and_b32_dpp v16, v47, v8 row_newbcast:11 row_mask:0xf bank_mask:0xf
    v_and_b32_dpp v17, v47, v9 row_newbcast:11 row_mask:0xf bank_mask:0xf
    v_and_b32_dpp v18, v47, v10 row_newbcast:11 row_mask:0xf bank_mask:0xf
    v_and_b32_dpp v19, v47, v11 row_newbcast:11 row_mask:0xf bank_mask:0xf
    s_nop 1
    v_mfma_f32_16x16x32_bf16 v[28:31], v[16:19], v[212:215], v[28:31]
    s_waitcnt vmcnt(1)
    v_and_b32_dpp v12, v47, v8 row_newbcast:7 row_mask:0xf bank_mask:0xf
    v_and_b32_dpp v13, v47, v9 row_newbcast:7 row_mask:0xf bank_mask:0xf
    v_and_b32_dpp v14, v47, v10 row_newbcast:7 row_mask:0xf bank_mask:0xf
    v_and_b32_dpp v15, v47, v11 row_newbcast:7 row_mask:0xf bank_mask:0xf
    s_nop 1
    v_mfma_f32_16x16x32_bf16 v[28:31], v[12:15], v[216:219], v[28:31]
    s_waitcnt vmcnt(0)
    v_and_b32_dpp v16, v47, v8 row_newbcast:15 row_mask:0xf bank_mask:0xf
    v_and_b32_dpp v17, v47, v9 row_newbcast:15 row_mask:0xf bank_mask:0xf
    v_and_b32_dpp v18, v47, v10 row_newbcast:15 row_mask:0xf bank_mask:0xf
    v_and_b32_dpp v19, v47, v11 row_newbcast:15 row_mask:0xf bank_mask:0xf
    s_nop 1
    v_mfma_f32_16x16x32_bf16 v[28:31], v[16:19], v[220:223], v[28:31]
    v_and_b32 v65, 1, v3
    v_lshlrev_b32 v65, 6, v65
    v_lshl_add_u32 v65, v2, 7, v65
    s_lshl_b32 s72, s3, 2
    v_add_u32 v65, s72, v65
    s_mov_b32 exec_hi, 0
    s_nop 1
    ds_write_b32 v65, v28 offset:4096
    ds_write_b32 v65, v29 offset:4112
    ds_write_b32 v65, v30 offset:4128
    ds_write_b32 v65, v31 offset:4144
    s_mov_b32 exec_hi, -1
    s_waitcnt lgkmcnt(0)
    s_barrier
    ds_read_b128 v[12:15], v66 offset:4096
    ds_read_b128 v[16:19], v66 offset:5120
    s_waitcnt lgkmcnt(0)
    v_add_f32 v12, v12, v13
    v_add_f32 v14, v14, v15
    v_add_f32 v56, v12, v14
    v_cvt_pk_bf16_f32 v56, v56, v56
    v_add_f32 v16, v16, v17
    v_add_f32 v18, v18, v19
    v_add_f32 v57, v16, v18
    v_cvt_pk_bf16_f32 v57, v57, v57
    v_and_b32_dpp v12, v56, v8 row_newbcast:0 row_mask:0xf bank_mask:0xf
    v_and_b32_dpp v13, v56, v9 row_newbcast:0 row_mask:0xf bank_mask:0xf
    v_and_b32_dpp v14, v56, v10 row_newbcast:0 row_mask:0xf bank_mask:0xf
    v_and_b32_dpp v15, v56, v11 row_newbcast:0 row_mask:0xf bank_mask:0xf
    s_nop 1
    v_mfma_f32_16x16x32_bf16 v[20:23], v[12:15], a[0:3], 0
    v_mfma_f32_16x16x32_bf16 v[24:27], v[12:15], a[4:7], 0
    v_and_b32_dpp v16, v56, v8 row_newbcast:1 row_mask:0xf bank_mask:0xf
    v_and_b32_dpp v17, v56, v9 row_newbcast:1 row_mask:0xf bank_mask:0xf
    v_and_b32_dpp v18, v56, v10 row_newbcast:1 row_mask:0xf bank_mask:0xf
    v_and_b32_dpp v19, v56, v11 row_newbcast:1 row_mask:0xf bank_mask:0xf
    s_nop 1
    v_mfma_f32_16x16x32_bf16 v[20:23], v[16:19], a[8:11], v[20:23]
    v_mfma_f32_16x16x32_bf16 v[24:27], v[16:19], a[12:15], v[24:27]
    v_and_b32_dpp v12, v56, v8 row_newbcast:2 row_mask:0xf bank_mask:0xf
    v_and_b32_dpp v13, v56, v9 row_newbcast:2 row_mask:0xf bank_mask:0xf
    v_and_b32_dpp v14, v56, v10 row_newbcast:2 row_mask:0xf bank_mask:0xf
    v_and_b32_dpp v15, v56, v11 row_newbcast:2 row_mask:0xf bank_mask:0xf
    s_nop 1
    v_mfma_f32_16x16x32_bf16 v[20:23], v[12:15], a[16:19], v[20:23]
    v_mfma_f32_16x16x32_bf16 v[24:27], v[12:15], a[20:23], v[24:27]
    v_and_b32_dpp v16, v56, v8 row_newbcast:3 row_mask:0xf bank_mask:0xf
    v_and_b32_dpp v17, v56, v9 row_newbcast:3 row_mask:0xf bank_mask:0xf
    v_and_b32_dpp v18, v56, v10 row_newbcast:3 row_mask:0xf bank_mask:0xf
    v_and_b32_dpp v19, v56, v11 row_newbcast:3 row_mask:0xf bank_mask:0xf
    s_nop 1
    v_mfma_f32_16x16x32_bf16 v[20:23], v[16:19], a[24:27], v[20:23]
    v_mfma_f32_16x16x32_bf16 v[24:27], v[16:19], a[28:31], v[24:27]
    v_and_b32_dpp v12, v56, v8 row_newbcast:4 row_mask:0xf bank_mask:0xf
    v_and_b32_dpp v13, v56, v9 row_newbcast:4 row_mask:0xf bank_mask:0xf
    v_and_b32_dpp v14, v56, v10 row_newbcast:4 row_mask:0xf bank_mask:0xf
    v_and_b32_dpp v15, v56, v11 row_newbcast:4 row_mask:0xf bank_mask:0xf
    s_nop 1
    v_mfma_f32_16x16x32_bf16 v[20:23], v[12:15], a[32:35], v[20:23]
    v_mfma_f32_16x16x32_bf16 v[24:27], v[12:15], a[36:39], v[24:27]
    v_and_b32_dpp v16, v56, v8 row_newbcast:5 row_mask:0xf bank_mask:0xf
    v_and_b32_dpp v17, v56, v9 row_newbcast:5 row_mask:0xf bank_mask:0xf
    v_and_b32_dpp v18, v56, v10 row_newbcast:5 row_mask:0xf bank_mask:0xf
    v_and_b32_dpp v19, v56, v11 row_newbcast:5 row_mask:0xf bank_mask:0xf
    s_nop 1
    v_mfma_f32_16x16x32_bf16 v[20:23], v[16:19], a[40:43], v[20:23]
    v_mfma_f32_16x16x32_bf16 v[24:27], v[16:19], a[44:47], v[24:27]
    v_and_b32_dpp v12, v56, v8 row_newbcast:6 row_mask:0xf bank_mask:0xf
    v_and_b32_dpp v13, v56, v9 row_newbcast:6 row_mask:0xf bank_mask:0xf
    v_and_b32_dpp v14, v56, v10 row_newbcast:6 row_mask:0xf bank_mask:0xf
    v_and_b32_dpp v15, v56, v11 row_newbcast:6 row_mask:0xf bank_mask:0xf
    s_nop 1
    v_mfma_f32_16x16x32_bf16 v[20:23], v[12:15], a[48:51], v[20:23]
    v_mfma_f32_16x16x32_bf16 v[24:27], v[12:15], a[52:55], v[24:27]
    v_and_b32_dpp v16, v56, v8 row_newbcast:7 row_mask:0xf bank_mask:0xf
    v_and_b32_dpp v17, v56, v9 row_newbcast:7 row_mask:0xf bank_mask:0xf
    v_and_b32_dpp v18, v56, v10 row_newbcast:7 row_mask:0xf bank_mask:0xf
    v_and_b32_dpp v19, v56, v11 row_newbcast:7 row_mask:0xf bank_mask:0xf
    s_nop 1
    v_mfma_f32_16x16x32_bf16 v[20:23], v[16:19], a[56:59], v[20:23]
    v_mfma_f32_16x16x32_bf16 v[24:27], v[16:19], a[60:63], v[24:27]
    v_and_b32_dpp v12, v56, v8 row_newbcast:8 row_mask:0xf bank_mask:0xf
    v_and_b32_dpp v13, v56, v9 row_newbcast:8 row_mask:0xf bank_mask:0xf
    v_and_b32_dpp v14, v56, v10 row_newbcast:8 row_mask:0xf bank_mask:0xf
    v_and_b32_dpp v15, v56, v11 row_newbcast:8 row_mask:0xf bank_mask:0xf
    s_nop 1
    v_mfma_f32_16x16x32_bf16 v[20:23], v[12:15], a[64:67], v[20:23]
    v_mfma_f32_16x16x32_bf16 v[24:27], v[12:15], a[68:71], v[24:27]
    v_and_b32_dpp v16, v56, v8 row_newbcast:9 row_mask:0xf bank_mask:0xf
    v_and_b32_dpp v17, v56, v9 row_newbcast:9 row_mask:0xf bank_mask:0xf
    v_and_b32_dpp v18, v56, v10 row_newbcast:9 row_mask:0xf bank_mask:0xf
    v_and_b32_dpp v19, v56, v11 row_newbcast:9 row_mask:0xf bank_mask:0xf
    s_nop 1
    v_mfma_f32_16x16x32_bf16 v[20:23], v[16:19], a[72:75], v[20:23]
    v_mfma_f32_16x16x32_bf16 v[24:27], v[16:19], a[76:79], v[24:27]
    v_and_b32_dpp v12, v56, v8 row_newbcast:10 row_mask:0xf bank_mask:0xf
    v_and_b32_dpp v13, v56, v9 row_newbcast:10 row_mask:0xf bank_mask:0xf
    v_and_b32_dpp v14, v56, v10 row_newbcast:10 row_mask:0xf bank_mask:0xf
    v_and_b32_dpp v15, v56, v11 row_newbcast:10 row_mask:0xf bank_mask:0xf
    s_nop 1
    v_mfma_f32_16x16x32_bf16 v[20:23], v[12:15], a[80:83], v[20:23]
    v_mfma_f32_16x16x32_bf16 v[24:27], v[12:15], a[84:87], v[24:27]
    v_and_b32_dpp v16, v56, v8 row_newbcast:11 row_mask:0xf bank_mask:0xf
    v_and_b32_dpp v17, v56, v9 row_newbcast:11 row_mask:0xf bank_mask:0xf
    v_and_b32_dpp v18, v56, v10 row_newbcast:11 row_mask:0xf bank_mask:0xf
    v_and_b32_dpp v19, v56, v11 row_newbcast:11 row_mask:0xf bank_mask:0xf
    s_nop 1
    v_mfma_f32_16x16x32_bf16 v[20:23], v[16:19], a[88:91], v[20:23]
    v_mfma_f32_16x16x32_bf16 v[24:27], v[16:19], a[92:95], v[24:27]
    v_and_b32_dpp v12, v56, v8 row_newbcast:12 row_mask:0xf bank_mask:0xf
    v_and_b32_dpp v13, v56, v9 row_newbcast:12 row_mask:0xf bank_mask:0xf
    v_and_b32_dpp v14, v56, v10 row_newbcast:12 row_mask:0xf bank_mask:0xf
    v_and_b32_dpp v15, v56, v11 row_newbcast:12 row_mask:0xf bank_mask:0xf
    s_nop 1
    v_mfma_f32_16x16x32_bf16 v[20:23], v[12:15], a[96:99], v[20:23]
    v_mfma_f32_16x16x32_bf16 v[24:27], v[12:15], a[100:103], v[24:27]
    v_and_b32_dpp v16, v56, v8 row_newbcast:13 row_mask:0xf bank_mask:0xf
    v_and_b32_dpp v17, v56, v9 row_newbcast:13 row_mask:0xf bank_mask:0xf
    v_and_b32_dpp v18, v56, v10 row_newbcast:13 row_mask:0xf bank_mask:0xf
    v_and_b32_dpp v19, v56, v11 row_newbcast:13 row_mask:0xf bank_mask:0xf
    s_nop 1
    v_mfma_f32_16x16x32_bf16 v[20:23], v[16:19], a[104:107], v[20:23]
    v_mfma_f32_16x16x32_bf16 v[24:27], v[16:19], a[108:111], v[24:27]
    v_and_b32_dpp v12, v56, v8 row_newbcast:14 row_mask:0xf bank_mask:0xf
    v_and_b32_dpp v13, v56, v9 row_newbcast:14 row_mask:0xf bank_mask:0xf
    v_and_b32_dpp v14, v56, v10 row_newbcast:14 row_mask:0xf bank_mask:0xf
    v_and_b32_dpp v15, v56, v11 row_newbcast:14 row_mask:0xf bank_mask:0xf
    s_nop 1
    v_mfma_f32_16x16x32_bf16 v[20:23], v[12:15], a[112:115], v[20:23]
    v_mfma_f32_16x16x32_bf16 v[24:27], v[12:15], a[116:119], v[24:27]
    v_and_b32_dpp v16, v56, v8 row_newbcast:15 row_mask:0xf bank_mask:0xf
    v_and_b32_dpp v17, v56, v9 row_newbcast:15 row_mask:0xf bank_mask:0xf
    v_and_b32_dpp v18, v56, v10 row_newbcast:15 row_mask:0xf bank_mask:0xf
    v_and_b32_dpp v19, v56, v11 row_newbcast:15 row_mask:0xf bank_mask:0xf
    s_nop 1
    v_mfma_f32_16x16x32_bf16 v[20:23], v[16:19], a[120:123], v[20:23]
    v_mfma_f32_16x16x32_bf16 v[24:27], v[16:19], a[124:127], v[24:27]
    v_and_b32_dpp v12, v57, v8 row_newbcast:0 row_mask:0xf bank_mask:0xf
    v_and_b32_dpp v13, v57, v9 row_newbcast:0 row_mask:0xf bank_mask:0xf
    v_and_b32_dpp v14, v57, v10 row_newbcast:0 row_mask:0xf bank_mask:0xf
    v_and_b32_dpp v15, v57, v11 row_newbcast:0 row_mask:0xf bank_mask:0xf
    s_nop 1
    v_mfma_f32_16x16x32_bf16 v[20:23], v[12:15], a[128:131], v[20:23]
    v_mfma_f32_16x16x32_bf16 v[24:27], v[12:15], a[132:135], v[24:27]
    v_and_b32_dpp v16, v57, v8 row_newbcast:1 row_mask:0xf bank_mask:0xf
    v_and_b32_dpp v17, v57, v9 row_newbcast:1 row_mask:0xf bank_mask:0xf
    v_and_b32_dpp v18, v57, v10 row_newbcast:1 row_mask:0xf bank_mask:0xf
    v_and_b32_dpp v19, v57, v11 row_newbcast:1 row_mask:0xf bank_mask:0xf
    s_nop 1
    v_mfma_f32_16x16x32_bf16 v[20:23], v[16:19], a[136:139], v[20:23]
    v_mfma_f32_16x16x32_bf16 v[24:27], v[16:19], a[140:143], v[24:27]
    v_and_b32_dpp v12, v57, v8 row_newbcast:2 row_mask:0xf bank_mask:0xf
    v_and_b32_dpp v13, v57, v9 row_newbcast:2 row_mask:0xf bank_mask:0xf
    v_and_b32_dpp v14, v57, v10 row_newbcast:2 row_mask:0xf bank_mask:0xf
    v_and_b32_dpp v15, v57, v11 row_newbcast:2 row_mask:0xf bank_mask:0xf
    s_nop 1
    v_mfma_f32_16x16x32_bf16 v[20:23], v[12:15], a[144:147], v[20:23]
    v_mfma_f32_16x16x32_bf16 v[24:27], v[12:15], a[148:151], v[24:27]
    v_and_b32_dpp v16, v57, v8 row_newbcast:3 row_mask:0xf bank_mask:0xf
    v_and_b32_dpp v17, v57, v9 row_newbcast:3 row_mask:0xf bank_mask:0xf
    v_and_b32_dpp v18, v57, v10 row_newbcast:3 row_mask:0xf bank_mask:0xf
    v_and_b32_dpp v19, v57, v11 row_newbcast:3 row_mask:0xf bank_mask:0xf
    s_nop 1
    v_mfma_f32_16x16x32_bf16 v[20:23], v[16:19], a[152:155], v[20:23]
    v_mfma_f32_16x16x32_bf16 v[24:27], v[16:19], a[156:159], v[24:27]
    v_and_b32_dpp v12, v57, v8 row_newbcast:4 row_mask:0xf bank_mask:0xf
    v_and_b32_dpp v13, v57, v9 row_newbcast:4 row_mask:0xf bank_mask:0xf
    v_and_b32_dpp v14, v57, v10 row_newbcast:4 row_mask:0xf bank_mask:0xf
    v_and_b32_dpp v15, v57, v11 row_newbcast:4 row_mask:0xf bank_mask:0xf
    s_nop 1
    v_mfma_f32_16x16x32_bf16 v[20:23], v[12:15], a[160:163], v[20:23]
    v_mfma_f32_16x16x32_bf16 v[24:27], v[12:15], a[164:167], v[24:27]
    v_and_b32_dpp v16, v57, v8 row_newbcast:5 row_mask:0xf bank_mask:0xf
    v_and_b32_dpp v17, v57, v9 row_newbcast:5 row_mask:0xf bank_mask:0xf
    v_and_b32_dpp v18, v57, v10 row_newbcast:5 row_mask:0xf bank_mask:0xf
    v_and_b32_dpp v19, v57, v11 row_newbcast:5 row_mask:0xf bank_mask:0xf
    s_nop 1
    v_mfma_f32_16x16x32_bf16 v[20:23], v[16:19], a[168:171], v[20:23]
    v_mfma_f32_16x16x32_bf16 v[24:27], v[16:19], a[172:175], v[24:27]
    v_and_b32_dpp v12, v57, v8 row_newbcast:6 row_mask:0xf bank_mask:0xf
    v_and_b32_dpp v13, v57, v9 row_newbcast:6 row_mask:0xf bank_mask:0xf
    v_and_b32_dpp v14, v57, v10 row_newbcast:6 row_mask:0xf bank_mask:0xf
    v_and_b32_dpp v15, v57, v11 row_newbcast:6 row_mask:0xf bank_mask:0xf
    s_nop 1
    v_mfma_f32_16x16x32_bf16 v[20:23], v[12:15], a[176:179], v[20:23]
    v_mfma_f32_16x16x32_bf16 v[24:27], v[12:15], a[180:183], v[24:27]
    v_and_b32_dpp v16, v57, v8 row_newbcast:7 row_mask:0xf bank_mask:0xf
    v_and_b32_dpp v17, v57, v9 row_newbcast:7 row_mask:0xf bank_mask:0xf
    v_and_b32_dpp v18, v57, v10 row_newbcast:7 row_mask:0xf bank_mask:0xf
    v_and_b32_dpp v19, v57, v11 row_newbcast:7 row_mask:0xf bank_mask:0xf
    s_nop 1
    v_mfma_f32_16x16x32_bf16 v[20:23], v[16:19], a[184:187], v[20:23]
    v_mfma_f32_16x16x32_bf16 v[24:27], v[16:19], a[188:191], v[24:27]
    v_and_b32_dpp v12, v57, v8 row_newbcast:8 row_mask:0xf bank_mask:0xf
    v_and_b32_dpp v13, v57, v9 row_newbcast:8 row_mask:0xf bank_mask:0xf
    v_and_b32_dpp v14, v57, v10 row_newbcast:8 row_mask:0xf bank_mask:0xf
    v_and_b32_dpp v15, v57, v11 row_newbcast:8 row_mask:0xf bank_mask:0xf
    s_nop 1
    v_mfma_f32_16x16x32_bf16 v[20:23], v[12:15], a[192:195], v[20:23]
    v_mfma_f32_16x16x32_bf16 v[24:27], v[12:15], a[196:199], v[24:27]
    v_and_b32_dpp v16, v57, v8 row_newbcast:9 row_mask:0xf bank_mask:0xf
    v_and_b32_dpp v17, v57, v9 row_newbcast:9 row_mask:0xf bank_mask:0xf
    v_and_b32_dpp v18, v57, v10 row_newbcast:9 row_mask:0xf bank_mask:0xf
    v_and_b32_dpp v19, v57, v11 row_newbcast:9 row_mask:0xf bank_mask:0xf
    s_nop 1
    v_mfma_f32_16x16x32_bf16 v[20:23], v[16:19], a[200:203], v[20:23]
    v_mfma_f32_16x16x32_bf16 v[24:27], v[16:19], a[204:207], v[24:27]
    v_and_b32_dpp v12, v57, v8 row_newbcast:10 row_mask:0xf bank_mask:0xf
    v_and_b32_dpp v13, v57, v9 row_newbcast:10 row_mask:0xf bank_mask:0xf
    v_and_b32_dpp v14, v57, v10 row_newbcast:10 row_mask:0xf bank_mask:0xf
    v_and_b32_dpp v15, v57, v11 row_newbcast:10 row_mask:0xf bank_mask:0xf
    s_nop 1
    v_mfma_f32_16x16x32_bf16 v[20:23], v[12:15], a[208:211], v[20:23]
    v_mfma_f32_16x16x32_bf16 v[24:27], v[12:15], a[212:215], v[24:27]
    v_and_b32_dpp v16, v57, v8 row_newbcast:11 row_mask:0xf bank_mask:0xf
    v_and_b32_dpp v17, v57, v9 row_newbcast:11 row_mask:0xf bank_mask:0xf
    v_and_b32_dpp v18, v57, v10 row_newbcast:11 row_mask:0xf bank_mask:0xf
    v_and_b32_dpp v19, v57, v11 row_newbcast:11 row_mask:0xf bank_mask:0xf
    s_nop 1
    v_mfma_f32_16x16x32_bf16 v[20:23], v[16:19], a[216:219], v[20:23]
    v_mfma_f32_16x16x32_bf16 v[24:27], v[16:19], a[220:223], v[24:27]
    v_and_b32_dpp v12, v57, v8 row_newbcast:12 row_mask:0xf bank_mask:0xf
    v_and_b32_dpp v13, v57, v9 row_newbcast:12 row_mask:0xf bank_mask:0xf
    v_and_b32_dpp v14, v57, v10 row_newbcast:12 row_mask:0xf bank_mask:0xf
    v_and_b32_dpp v15, v57, v11 row_newbcast:12 row_mask:0xf bank_mask:0xf
    s_nop 1
    v_mfma_f32_16x16x32_bf16 v[20:23], v[12:15], a[224:227], v[20:23]
    v_mfma_f32_16x16x32_bf16 v[24:27], v[12:15], a[228:231], v[24:27]
    v_and_b32_dpp v16, v57, v8 row_newbcast:13 row_mask:0xf bank_mask:0xf
    v_and_b32_dpp v17, v57, v9 row_newbcast:13 row_mask:0xf bank_mask:0xf
    v_and_b32_dpp v18, v57, v10 row_newbcast:13 row_mask:0xf bank_mask:0xf
    v_and_b32_dpp v19, v57, v11 row_newbcast:13 row_mask:0xf bank_mask:0xf
    s_nop 1
    v_mfma_f32_16x16x32_bf16 v[20:23], v[16:19], a[232:235], v[20:23]
    v_mfma_f32_16x16x32_bf16 v[24:27], v[16:19], a[236:239], v[24:27]
    v_and_b32_dpp v12, v57, v8 row_newbcast:14 row_mask:0xf bank_mask:0xf
    v_and_b32_dpp v13, v57, v9 row_newbcast:14 row_mask:0xf bank_mask:0xf
    v_and_b32_dpp v14, v57, v10 row_newbcast:14 row_mask:0xf bank_mask:0xf
    v_and_b32_dpp v15, v57, v11 row_newbcast:14 row_mask:0xf bank_mask:0xf
    s_nop 1
    v_mfma_f32_16x16x32_bf16 v[20:23], v[12:15], a[240:243], v[20:23]
    v_mfma_f32_16x16x32_bf16 v[24:27], v[12:15], a[244:247], v[24:27]
    v_and_b32_dpp v16, v57, v8 row_newbcast:15 row_mask:0xf bank_mask:0xf
    v_and_b32_dpp v17, v57, v9 row_newbcast:15 row_mask:0xf bank_mask:0xf
    v_and_b32_dpp v18, v57, v10 row_newbcast:15 row_mask:0xf bank_mask:0xf
    v_and_b32_dpp v19, v57, v11 row_newbcast:15 row_mask:0xf bank_mask:0xf
    s_nop 1
    v_mfma_f32_16x16x32_bf16 v[20:23], v[16:19], a[248:251], v[20:23]
    v_mfma_f32_16x16x32_bf16 v[24:27], v[16:19], a[252:255], v[24:27]
    s_mov_b32 exec_hi, 0
    s_nop 5
    buffer_store_dwordx4 v[20:23], v67, s[64:67], s73 offen sc1
    buffer_store_dwordx4 v[24:27], v67, s[64:67], s73 offen offset:512 sc1
    s_mov_b32 exec_hi, -1
    s_waitcnt vmcnt(0)
    s_barrier
    v_lshrrev_b32 v22, 3, v1
    v_and_b32 v23, 7, v1
    v_lshlrev_b32 v20, 4, v23
    v_lshl_add_u32 v20, v22, 12, v20
    v_lshlrev_b32 v21, 3, v23
    s_mov_b32 s60, s22
    s_mov_b32 s61, s23
    s_mov_b32 s62, 2048
    s_mov_b32 s63, 0x00020000
    s_lshl_b32 s72, s30, 11
    s_add_u32 s44, s24, s72
    s_addc_u32 s45, s25, 0
    s_mov_b32 s46, 2048
    s_mov_b32 s47, 0x00020000
    s_lshl_b32 s78, s30, 17
    s_cmp_lg_u32 s3, 0
    s_cbranch_scc1 L_join
    s_lshl_b32 s72, s30, 2
    v_mov_b32 v12, s72
    v_mov_b32 v16, 1
    s_mov_b64 exec, 1
    global_atomic_add v14, v12, v16, s[26:27] sc0 sc1
    s_waitcnt vmcnt(0)
    v_readfirstlane_b32 s72, v14
    s_mov_b32 s79, 0
    s_nop 0
    s_and_b32 s74, s72, 63
    s_cmp_lt_u32 s74, 28
    s_cbranch_scc1 L_publish
    s_cmp_gt_u32 s74, 31
    s_cbranch_scc1 L_publish
    s_sub_u32 s77, s74, 28
    s_lshl_b32 s79, 1, s77
    s_cmp_eq_u32 s74, 31
    s_cbranch_scc0 L_wait
    s_lshr_b32 s72, s72, 8
    s_or_b32 s79, s79, s72
    s_branch L_publish
L_wait:
    s_nop 7
    s_movk_i32 s75, 48
L_poll:
    s_sleep 8
    global_load_dword v14, v12, s[26:27] sc1
    s_waitcnt vmcnt(0)
    v_readfirstlane_b32 s72, v14
    s_nop 1
    s_and_b32 s72, s72, 63
    s_cmp_eq_u32 s72, 32
    s_cbranch_scc1 L_publish
    s_sub_u32 s75, s75, 1
    s_cmp_lg_u32 s75, 0
    s_cbranch_scc1 L_poll
    s_lshl_b32 s72, s79, 8
    v_mov_b32 v16, s72
    global_atomic_or v14, v12, v16, s[26:27] sc0 sc1
    s_waitcnt vmcnt(0)
    v_readfirstlane_b32 s72, v14
    s_nop 1
    s_and_b32 s72, s72, 63
    s_cmp_eq_u32 s72, 32
    s_cselect_b32 s79, s79, 0
L_publish:
    s_nop 7
    v_mov_b32 v12, 0
    v_mov_b32 v14, s79
    ds_write_b32 v12, v14 offset:7232
    s_waitcnt lgkmcnt(0)
    s_mov_b64 exec, -1
L_join:
    s_nop 7
    s_barrier
    v_mov_b32 v12, 0
    ds_read_b32 v13, v12 offset:7232
    s_waitcnt lgkmcnt(0)
    v_readfirstlane_b32 s79, v13
    s_cmp_eq_u32 s79, 0
    s_cbranch_scc1 L_end
L_jobs:
    s_nop 7
    s_mov_b64 exec, -1
    s_ff1_i32_b32 s74, s79
    s_bitset0_b32 s79, s74
    s_mul_i32 s74, s74, 8
    s_mul_i32 s75, s3, 2
    s_add_u32 s74, s74, s75
    s_lshl_b32 s75, s74, 7
    s_add_u32 s75, s75, s78
    s_lshl_b32 s76, s74, 6
    s_add_u32 s68, s75, 0
    buffer_load_dwordx4 v[80:83], v20, s[64:67], s68 offen sc1
    s_add_u32 s68, s75, 1048576
    buffer_load_dwordx4 v[84:87], v20, s[64:67], s68 offen sc1
    s_add_u32 s68, s75, 32768
    buffer_load_dwordx4 v[88:91], v20, s[64:67], s68 offen sc1
    s_add_u32 s68, s75, 1081344
    buffer_load_dwordx4 v[92:95], v20, s[64:67], s68 offen sc1
    s_add_u32 s68, s75, 65536
    buffer_load_dwordx4 v[96:99], v20, s[64:67], s68 offen sc1
    s_add_u32 s68, s75, 1114112
    buffer_load_dwordx4 v[100:103], v20, s[64:67], s68 offen sc1
    s_add_u32 s68, s75, 98304
    buffer_load_dwordx4 v[104:107], v20, s[64:67], s68 offen sc1
    s_add_u32 s68, s75, 1146880
    buffer_load_dwordx4 v[108:111], v20, s[64:67], s68 offen sc1
    s_add_u32 s68, s75, 128
    buffer_load_dwordx4 v[112:115], v20, s[64:67], s68 offen sc1
    s_add_u32 s68, s75, 1048704
    buffer_load_dwordx4 v[116:119], v20, s[64:67], s68 offen sc1
    s_add_u32 s68, s75, 32896
    buffer_load_dwordx4 v[120:123], v20, s[64:67], s68 offen sc1
    s_add_u32 s68, s75, 1081472
    buffer_load_dwordx4 v[124:127], v20, s[64:67], s68 offen sc1
    s_add_u32 s68, s75, 65664
    buffer_load_dwordx4 v[128:131], v20, s[64:67], s68 offen sc1
    s_add_u32 s68, s75, 1114240
    buffer_load_dwordx4 v[132:135], v20, s[64:67], s68 offen sc1
    s_add_u32 s68, s75, 98432
    buffer_load_dwordx4 v[136:139], v20, s[64:67], s68 offen sc1
    s_add_u32 s68, s75, 1147008
    buffer_load_dwordx4 v[140:143], v20, s[64:67], s68 offen sc1
    buffer_load_dwordx2 v[32:33], v21, s[56:59], s76 offen
    buffer_load_dwordx2 v[34:35], v21, s[60:63], s76 offen
    buffer_load_dwordx2 v[36:37], v21, s[56:59], s76 offen offset:64
    buffer_load_dwordx2 v[38:39], v21, s[60:63], s76 offen offset:64
    s_waitcnt vmcnt(17)
    v_add_f32 v80, v80, v88
    v_add_f32 v81, v81, v89
    v_add_f32 v82, v82, v90
    v_add_f32 v83, v83, v91
    s_waitcnt vmcnt(16)
    v_add_f32 v84, v84, v92
    v_add_f32 v85, v85, v93
    v_add_f32 v86, v86, v94
    v_add_f32 v87, v87, v95
    s_waitcnt vmcnt(15)
    v_add_f32 v80, v80, v96
    v_add_f32 v81, v81, v97
    v_add_f32 v82, v82, v98
    v_add_f32 v83, v83, v99
    s_waitcnt vmcnt(14)
    v_add_f32 v84, v84, v100
    v_add_f32 v85, v85, v101
    v_add_f32 v86, v86, v102
    v_add_f32 v87, v87, v103
    s_waitcnt vmcnt(13)
    v_add_f32 v80, v80, v104
    v_add_f32 v81, v81, v105
    v_add_f32 v82, v82, v106
    v_add_f32 v83, v83, v107
    s_waitcnt vmcnt(12)
    v_add_f32 v84, v84, v108
    v_add_f32 v85, v85, v109
    v_add_f32 v86, v86, v110
    v_add_f32 v87, v87, v111
    v_add_f32_dpp v80, v80, v80 row_ror:8 row_mask:0xf bank_mask:0xf
    v_add_f32_dpp v81, v81, v81 row_ror:8 row_mask:0xf bank_mask:0xf
    v_add_f32_dpp v82, v82, v82 row_ror:8 row_mask:0xf bank_mask:0xf
    v_add_f32_dpp v83, v83, v83 row_ror:8 row_mask:0xf bank_mask:0xf
    v_add_f32_dpp v84, v84, v84 row_ror:8 row_mask:0xf bank_mask:0xf
    v_add_f32_dpp v85, v85, v85 row_ror:8 row_mask:0xf bank_mask:0xf
    v_add_f32_dpp v86, v86, v86 row_ror:8 row_mask:0xf bank_mask:0xf
    v_add_f32_dpp v87, v87, v87 row_ror:8 row_mask:0xf bank_mask:0xf
    v_mov_b32 v88, v80
    v_mov_b32 v89, v81
    v_mov_b32 v90, v82
    v_mov_b32 v91, v83
    v_mov_b32 v92, v84
    v_mov_b32 v93, v85
    v_mov_b32 v94, v86
    v_mov_b32 v95, v87
    v_permlane16_swap_b32 v80, v88
    v_permlane16_swap_b32 v81, v89
    v_permlane16_swap_b32 v82, v90
    v_permlane16_swap_b32 v83, v91
    v_permlane16_swap_b32 v84, v92
    v_permlane16_swap_b32 v85, v93
    v_permlane16_swap_b32 v86, v94
    v_permlane16_swap_b32 v87, v95
    v_add_f32 v80, v80, v88
    v_add_f32 v81, v81, v89
    v_add_f32 v82, v82, v90
    v_add_f32 v83, v83, v91
    v_add_f32 v84, v84, v92
    v_add_f32 v85, v85, v93
    v_add_f32 v86, v86, v94
    v_add_f32 v87, v87, v95
    v_mov_b32 v88, v80
    v_mov_b32 v89, v81
    v_mov_b32 v90, v82
    v_mov_b32 v91, v83
    v_mov_b32 v92, v84
    v_mov_b32 v93, v85
    v_mov_b32 v94, v86
    v_mov_b32 v95, v87
    v_permlane32_swap_b32 v80, v88
    v_permlane32_swap_b32 v81, v89
    v_permlane32_swap_b32 v82, v90
    v_permlane32_swap_b32 v83, v91
    v_permlane32_swap_b32 v84, v92
    v_permlane32_swap_b32 v85, v93
    v_permlane32_swap_b32 v86, v94
    v_permlane32_swap_b32 v87, v95
    v_add_f32 v80, v80, v88
    v_add_f32 v81, v81, v89
    v_add_f32 v82, v82, v90
    v_add_f32 v83, v83, v91
    v_add_f32 v84, v84, v92
    v_add_f32 v85, v85, v93
    v_add_f32 v86, v86, v94
    v_add_f32 v87, v87, v95
    s_waitcnt vmcnt(9)
    v_add_f32 v112, v112, v120
    v_add_f32 v113, v113, v121
    v_add_f32 v114, v114, v122
    v_add_f32 v115, v115, v123
    s_waitcnt vmcnt(8)
    v_add_f32 v116, v116, v124
    v_add_f32 v117, v117, v125
    v_add_f32 v118, v118, v126
    v_add_f32 v119, v119, v127
    s_waitcnt vmcnt(7)
    v_add_f32 v112, v112, v128
    v_add_f32 v113, v113, v129
    v_add_f32 v114, v114, v130
    v_add_f32 v115, v115, v131
    s_waitcnt vmcnt(6)
    v_add_f32 v116, v116, v132
    v_add_f32 v117, v117, v133
    v_add_f32 v118, v118, v134
    v_add_f32 v119, v119, v135
    s_waitcnt vmcnt(5)
    v_add_f32 v112, v112, v136
    v_add_f32 v113, v113, v137
    v_add_f32 v114, v114, v138
    v_add_f32 v115, v115, v139
    s_waitcnt vmcnt(4)
    v_add_f32 v116, v116, v140
    v_add_f32 v117, v117, v141
    v_add_f32 v118, v118, v142
    v_add_f32 v119, v119, v143
    v_add_f32_dpp v112, v112, v112 row_ror:8 row_mask:0xf bank_mask:0xf
    v_add_f32_dpp v113, v113, v113 row_ror:8 row_mask:0xf bank_mask:0xf
    v_add_f32_dpp v114, v114, v114 row_ror:8 row_mask:0xf bank_mask:0xf
    v_add_f32_dpp v115, v115, v115 row_ror:8 row_mask:0xf bank_mask:0xf
    v_add_f32_dpp v116, v116, v116 row_ror:8 row_mask:0xf bank_mask:0xf
    v_add_f32_dpp v117, v117, v117 row_ror:8 row_mask:0xf bank_mask:0xf
    v_add_f32_dpp v118, v118, v118 row_ror:8 row_mask:0xf bank_mask:0xf
    v_add_f32_dpp v119, v119, v119 row_ror:8 row_mask:0xf bank_mask:0xf
    v_mov_b32 v120, v112
    v_mov_b32 v121, v113
    v_mov_b32 v122, v114
    v_mov_b32 v123, v115
    v_mov_b32 v124, v116
    v_mov_b32 v125, v117
    v_mov_b32 v126, v118
    v_mov_b32 v127, v119
    v_permlane16_swap_b32 v112, v120
    v_permlane16_swap_b32 v113, v121
    v_permlane16_swap_b32 v114, v122
    v_permlane16_swap_b32 v115, v123
    v_permlane16_swap_b32 v116, v124
    v_permlane16_swap_b32 v117, v125
    v_permlane16_swap_b32 v118, v126
    v_permlane16_swap_b32 v119, v127
    v_add_f32 v112, v112, v120
    v_add_f32 v113, v113, v121
    v_add_f32 v114, v114, v122
    v_add_f32 v115, v115, v123
    v_add_f32 v116, v116, v124
    v_add_f32 v117, v117, v125
    v_add_f32 v118, v118, v126
    v_add_f32 v119, v119, v127
    v_mov_b32 v120, v112
    v_mov_b32 v121, v113
    v_mov_b32 v122, v114
    v_mov_b32 v123, v115
    v_mov_b32 v124, v116
    v_mov_b32 v125, v117
    v_mov_b32 v126, v118
    v_mov_b32 v127, v119
    v_permlane32_swap_b32 v112, v120
    v_permlane32_swap_b32 v113, v121
    v_permlane32_swap_b32 v114, v122
    v_permlane32_swap_b32 v115, v123
    v_permlane32_swap_b32 v116, v124
    v_permlane32_swap_b32 v117, v125
    v_permlane32_swap_b32 v118, v126
    v_permlane32_swap_b32 v119, v127
    v_add_f32 v112, v112, v120
    v_add_f32 v113, v113, v121
    v_add_f32 v114, v114, v122
    v_add_f32 v115, v115, v123
    v_add_f32 v116, v116, v124
    v_add_f32 v117, v117, v125
    v_add_f32 v118, v118, v126
    v_add_f32 v119, v119, v127
    s_waitcnt vmcnt(2)
    v_lshlrev_b32 v28, 16, v32
    v_lshlrev_b32 v29, 16, v34
    v_cvt_pk_bf16_f32 v80, 0, v80
    v_cvt_pk_bf16_f32 v84, 0, v84
    v_add_f32 v84, v84, v29
    v_cvt_pk_bf16_f32 v84, 0, v84
    v_add_f32 v80, v28, v80
    v_cvt_pk_bf16_f32 v80, 0, v80
    v_add_f32 v80, v80, v84
    v_and_b32 v28, 0xffff0000, v32
    v_and_b32 v29, 0xffff0000, v34
    v_cvt_pk_bf16_f32 v81, 0, v81
    v_cvt_pk_bf16_f32 v85, 0, v85
    v_add_f32 v85, v85, v29
    v_cvt_pk_bf16_f32 v85, 0, v85
    v_add_f32 v81, v28, v81
    v_cvt_pk_bf16_f32 v81, 0, v81
    v_add_f32 v81, v81, v85
    v_lshlrev_b32 v28, 16, v33
    v_lshlrev_b32 v29, 16, v35
    v_cvt_pk_bf16_f32 v82, 0, v82
    v_cvt_pk_bf16_f32 v86, 0, v86
    v_add_f32 v86, v86, v29
    v_cvt_pk_bf16_f32 v86, 0, v86
    v_add_f32 v82, v28, v82
    v_cvt_pk_bf16_f32 v82, 0, v82
    v_add_f32 v82, v82, v86
    v_and_b32 v28, 0xffff0000, v33
    v_and_b32 v29, 0xffff0000, v35
    v_cvt_pk_bf16_f32 v83, 0, v83
    v_cvt_pk_bf16_f32 v87, 0, v87
    v_add_f32 v87, v87, v29
    v_cvt_pk_bf16_f32 v87, 0, v87
    v_add_f32 v83, v28, v83
    v_cvt_pk_bf16_f32 v83, 0, v83
    v_add_f32 v83, v83, v87
    v_cvt_pk_bf16_f32 v88, v80, v81
    v_cvt_pk_bf16_f32 v89, v82, v83
    s_waitcnt vmcnt(0)
    v_lshlrev_b32 v28, 16, v36
    v_lshlrev_b32 v29, 16, v38
    v_cvt_pk_bf16_f32 v112, 0, v112
    v_cvt_pk_bf16_f32 v116, 0, v116
    v_add_f32 v116, v116, v29
    v_cvt_pk_bf16_f32 v116, 0, v116
    v_add_f32 v112, v28, v112
    v_cvt_pk_bf16_f32 v112, 0, v112
    v_add_f32 v112, v112, v116
    v_and_b32 v28, 0xffff0000, v36
    v_and_b32 v29, 0xffff0000, v38
    v_cvt_pk_bf16_f32 v113, 0, v113
    v_cvt_pk_bf16_f32 v117, 0, v117
    v_add_f32 v117, v117, v29
    v_cvt_pk_bf16_f32 v117, 0, v117
    v_add_f32 v113, v28, v113
    v_cvt_pk_bf16_f32 v113, 0, v113
    v_add_f32 v113, v113, v117
    v_lshlrev_b32 v28, 16, v37
    v_lshlrev_b32 v29, 16, v39
    v_cvt_pk_bf16_f32 v114, 0, v114
    v_cvt_pk_bf16_f32 v118, 0, v118
    v_add_f32 v118, v118, v29
    v_cvt_pk_bf16_f32 v118, 0, v118
    v_add_f32 v114, v28, v114
    v_cvt_pk_bf16_f32 v114, 0, v114
    v_add_f32 v114, v114, v118
    v_and_b32 v28, 0xffff0000, v37
    v_and_b32 v29, 0xffff0000, v39
    v_cvt_pk_bf16_f32 v115, 0, v115
    v_cvt_pk_bf16_f32 v119, 0, v119
    v_add_f32 v119, v119, v29
    v_cvt_pk_bf16_f32 v119, 0, v119
    v_add_f32 v115, v28, v115
    v_cvt_pk_bf16_f32 v115, 0, v115
    v_add_f32 v115, v115, v119
    v_cvt_pk_bf16_f32 v120, v112, v113
    v_cvt_pk_bf16_f32 v121, v114, v115
    s_mov_b64 exec, 0xff
    buffer_store_dwordx2 v[88:89], v21, s[44:47], s76 offen
    buffer_store_dwordx2 v[120:121], v21, s[44:47], s76 offen offset:64
    s_cmp_eq_u32 s79, 0
    s_cbranch_scc1 L_fin
    s_waitcnt vmcnt(0)
    s_branch L_jobs
L_fin:
    s_nop 7
L_end:
    s_endpgm
.section .rodata,"a"
.p2align 6
.amdhsa_kernel parallel_sum__mha_block_cached__mixer_channel_mlp__decode_kernel
  .amdhsa_next_free_vgpr 512
  .amdhsa_next_free_sgpr 96
  .amdhsa_accum_offset 256
  .amdhsa_group_segment_fixed_size 0
  .amdhsa_kernarg_size 104
  .amdhsa_user_sgpr_count 2
  .amdhsa_user_sgpr_kernarg_segment_ptr 1
  .amdhsa_system_sgpr_workgroup_id_x 1
.end_amdhsa_kernel
```
